```python
import torch

def _softmax(x, axis=-1):
    return torch.softmax(x, dim=axis)
def _gelu(x):
    return torch.nn.functional.gelu(x, approximate="tanh")
def _silu(x):
    return torch.nn.functional.silu(x)
def _sigmoid(x):
    return torch.sigmoid(x)
def _layernorm(x, axis=-1, eps=1e-5):
    m = x.mean(dim=axis, keepdim=True)
    v = x.var(dim=axis, keepdim=True, unbiased=False)
    return (x - m) / torch.sqrt(v + eps)
def _scatter_add(tgt, idx, src, axis=0):
    return tgt.clone().index_add_(axis, idx, src)
def _segment_sum(src, seg, n):
    out = torch.zeros((n,) + src.shape[1:], dtype=src.dtype)
    return out.index_add_(0, seg, src)
def _pad(x, pw):
    flat = tuple(v for pair in reversed(pw) for v in pair)
    return torch.nn.functional.pad(x, flat)

kernel_name = 'concat_heads__gqa_block_cached__mha_block_cached__near_ridge'

def setup_inputs():

    _w = (lambda a: (lambda t: t.to(torch.bfloat16) if t.is_floating_point() else t)(torch.as_tensor(a)))
    def _A_setup():
        B, Sq, D = 16, 96, 576
        Hq, Hkv, Sk, Dh = 32, 16, 1024, 128
        assert Hq % Hkv == 0, (Hq, Hkv)
        return {
            "x": _w((lambda *s: torch.randn(*s, dtype=torch.bfloat16) * 0.8)(B, Sq, D)),
            "k_cache": _w((lambda *s: torch.randn(*s, dtype=torch.bfloat16) * 0.8)(B, Hkv, Sk, Dh)),
            "v_cache": _w((lambda *s: torch.randn(*s, dtype=torch.bfloat16) * 0.05)(B, Hkv, Sk, Dh)),
            "wq": _w((lambda *s: torch.randn(*s, dtype=torch.bfloat16) * 0.8)(D, Hq * Dh) * (D ** -0.5)),
            "wo": _w((lambda *s: torch.randn(*s, dtype=torch.bfloat16) * 0.05)(Hq * Dh, D) * ((Hq * Dh) ** -0.5)),
        }
    _A_in = _A_setup()

    def _B_setup():
        B, Sq, D = 16, 96, 576
        H, Sk, Dh = 32, 1024, 128
        return {
            "x": _w((lambda *s: torch.randn(*s, dtype=torch.bfloat16) * 0.8)(B, Sq, D)),
            "k_cache": _w((lambda *s: torch.randn(*s, dtype=torch.bfloat16) * 0.8)(B, H, Sk, Dh)),
            "v_cache": _w((lambda *s: torch.randn(*s, dtype=torch.bfloat16) * 0.05)(B, H, Sk, Dh)),
            "wq": _w((lambda *s: torch.randn(*s, dtype=torch.bfloat16) * 0.8)(D, H * Dh) * (D ** -0.5)),
            "wo": _w((lambda *s: torch.randn(*s, dtype=torch.bfloat16) * 0.05)(H * Dh, D) * ((H * Dh) ** -0.5)),
        }
    _B_in = _B_setup()

    return {
        "A_x": _A_in["x"],
        "A_k_cache": _A_in["k_cache"],
        "A_v_cache": _A_in["v_cache"],
        "A_wq": _A_in["wq"],
        "A_wo": _A_in["wo"],
        "B_x": _B_in["x"],
        "B_k_cache": _B_in["k_cache"],
        "B_v_cache": _B_in["v_cache"],
        "B_wq": _B_in["wq"],
        "B_wo": _B_in["wo"],
    }

def reference(A_x, A_k_cache, A_v_cache, A_wq, A_wo, B_x, B_k_cache, B_v_cache, B_wq, B_wo):
    def _A_ref(x, k_cache, v_cache, wq, wo):
        B, Sq, D = x.shape
        Hq, Dh = 32, 128
        Hkv = k_cache.shape[1]
        rep = Hq // Hkv
        q = (lambda x, *d: x.permute(*d))((x @ wq).reshape(B, Sq, Hq, Dh), 0, 2, 1, 3)
        k = (lambda x, n, axis: torch.repeat_interleave(x, n, dim=axis))(k_cache, rep, axis=1)
        v = (lambda x, n, axis: torch.repeat_interleave(x, n, dim=axis))(v_cache, rep, axis=1)
        scores = torch.einsum("bhqd,bhkd->bhqk", q, k) * (Dh ** -0.5)
        p = _softmax(scores, axis=-1)
        o = torch.einsum("bhqk,bhkd->bhqd", p, v)
        return (lambda x, *d: x.permute(*d))(o, 0, 2, 1, 3).reshape(B, Sq, Hq * Dh) @ wo

    def _B_ref(x, k_cache, v_cache, wq, wo):
        B, Sq, D = x.shape
        H, Dh = 32, 128
        q = (lambda x, *d: x.permute(*d))((x @ wq).reshape(B, Sq, H, Dh), 0, 2, 1, 3)
        scores = torch.einsum("bhqd,bhkd->bhqk", q, k_cache) * (Dh ** -0.5)
        p = _softmax(scores, axis=-1)
        o = torch.einsum("bhqk,bhkd->bhqd", p, v_cache)
        return (lambda x, *d: x.permute(*d))(o, 0, 2, 1, 3).reshape(B, Sq, H * Dh) @ wo

    a = _A_ref(A_x, A_k_cache, A_v_cache, A_wq, A_wo)
    b = _B_ref(B_x, B_k_cache, B_v_cache, B_wq, B_wo)
    return torch.concatenate([a, b], axis=-1)
```

```asm
; @launch grid=(256,1,1) block=(256,1,1) lds=163840
.amdgcn_target "amdgcn-amd-amdhsa--gfx950"
.text
.globl concat_heads__gqa_block_cached__mha_block_cached__near_ridge_kernel
.p2align 8
.type concat_heads__gqa_block_cached__mha_block_cached__near_ridge_kernel,@function
concat_heads__gqa_block_cached__mha_block_cached__near_ridge_kernel:
s_cmp_ge_u32 s2, 256
s_cbranch_scc1 L_end
s_load_dwordx16 s[64:79], s[0:1], 0
s_load_dwordx4 s[80:83], s[0:1], 64
s_load_dwordx2 s[96:97], s[0:1], 96
s_load_dwordx2 s[98:99], s[0:1], 88
s_load_dwordx2 s[100:101], s[0:1], 80
v_lshrrev_b32 v1, 6, v0
v_and_b32 v7, 63, v0
v_readfirstlane_b32 s3, v1
s_and_b32 s25, s2, 7
s_lshr_b32 s35, s2, 3
s_and_b32 s24, s35, 1
s_lshr_b32 s27, s35, 1
s_lshl_b32 s95, s24, 4
s_and_b32 s95, s95, 0
s_add_u32 s95, s95, s27
s_lshl_b32 s28, s25, 2
s_add_u32 s28, s28, s3
s_mul_i32 s29, s27, 9
s_lshr_b32 s29, s29, 4
s_and_b32 s51, s27, 0
s_mul_i32 s36, s25, 1
s_add_u32 s29, s29, s36
s_sub_u32 s36, s29, 9
s_cmp_ge_u32 s29, 9
s_cselect_b32 s29, s36, s29
s_mov_b32 s43, s29
s_lshl_b32 s32, s28, 8
s_lshl_b32 s36, s51, 18
s_add_u32 s32, s32, s36
s_mul_i32 s33, s27, 96
s_mul_i32 s36, s3, 24
s_add_u32 s33, s33, s36
s_mul_i32 s33, s33, 1152
s_mul_i32 s38, s3, 34816
s_mul_i32 s39, s3, 3072
s_add_u32 s39, s39, 139264
v_lshrrev_b32 v1, 4, v7
v_and_b32 v2, 15, v7
v_lshlrev_b32 v33, 2, v1
v_xor_b32 v33, v2, v33
v_lshlrev_b32 v33, 4, v33
v_lshl_add_u32 v40, v1, 13, v33
v_add_u32 v41, 31744, v40
v_xor_b32 v34, 32, v40
v_add_u32 v42, 63488, v34
v_add_u32 v43, 95232, v34
v_lshl_add_u32 v9, v1, 8, v33
v_xor_b32 v33, v2, v1
v_lshlrev_b32 v33, 4, v33
v_lshl_add_u32 v8, v1, 8, v33
v_lshrrev_b32 v1, 3, v7
v_and_b32 v2, 7, v7
v_lshrrev_b32 v33, 1, v1
v_xor_b32 v34, v2, v33
s_and_b32 s34, s3, 1
s_lshl_b32 s34, s34, 2
v_xor_b32 v34, s34, v34
v_lshlrev_b32 v34, 4, v34
v_mul_u32_u24 v1, 1152, v1
v_add_u32 v44, v1, v34
v_add_u32 v46, 16384, v44
v_xor_b32 v34, 64, v34
v_add_u32 v45, v1, v34
v_add_u32 v45, 8192, v45
v_and_b32 v33, 1, v33
v_lshlrev_b32 v33, 2, v33
v_xor_b32 v2, v2, v33
v_lshl_add_u32 v47, v2, 4, v1
s_waitcnt lgkmcnt(0)
s_cmp_eq_u32 s24, 0
s_cselect_b32 s4, s64, s74
s_cselect_b32 s5, s65, s75
s_cselect_b32 s8, s70, s80
s_cselect_b32 s9, s71, s81
s_cselect_b32 s12, s66, s76
s_cselect_b32 s13, s67, s77
s_cselect_b32 s16, s68, s78
s_cselect_b32 s17, s69, s79
s_mov_b32 s6, 1769472
s_mov_b32 s7, 0x20000
s_mov_b32 s10, 4718592
s_mov_b32 s11, 0x20000
s_cmp_eq_u32 s24, 0
s_cbranch_scc1 L_helpA
L_noapf:
s_lshl_b32 s42, s43, 7
s_add_u32 s42, s42, s33
s_add_u32 s43, s43, 1
s_cmp_eq_u32 s43, 9
s_cselect_b32 s43, 0, s43
s_add_u32 m0, s39, 0
s_nop 0
buffer_load_dwordx4 v44, s[4:7], s42 offen offset:0  lds
buffer_load_dwordx4 v45, s[4:7], s42 offen offset:1024  lds
buffer_load_dwordx4 v46, s[4:7], s42 offen offset:2048  lds
s_lshl_b32 s41, s29, 19
s_add_u32 s41, s41, s32
s_add_u32 s29, s29, 1
s_cmp_eq_u32 s29, 9
s_cselect_b32 s29, 0, s29
s_add_u32 m0, s38, 0
s_xor_b32 s36, s41, 0
buffer_load_dwordx4 v40, s[8:11], s36 offen offset:0  lds
buffer_load_dwordx4 v41, s[8:11], s36 offen offset:1024  lds
buffer_load_dwordx4 v42, s[8:11], s36 offen offset:2048  lds
buffer_load_dwordx4 v43, s[8:11], s36 offen offset:3072  lds
s_add_u32 m0, s38, 4096
s_xor_b32 s36, s41, 131072
buffer_load_dwordx4 v40, s[8:11], s36 offen offset:0  lds
buffer_load_dwordx4 v41, s[8:11], s36 offen offset:1024  lds
buffer_load_dwordx4 v42, s[8:11], s36 offen offset:2048  lds
buffer_load_dwordx4 v43, s[8:11], s36 offen offset:3072  lds
s_lshl_b32 s35, s27, 5
s_add_u32 s35, s35, s28
s_lshr_b32 s34, s35, 1
s_cmp_eq_u32 s24, 0
s_cselect_b32 s34, s34, s35
s_add_u32 s44, s34, s27
s_and_b32 s44, s44, 63
s_lshl_b32 s44, s44, 12
s_add_u32 s45, s44, 4096
s_and_b32 s45, s45, 0x3ffff
s_lshl_b32 s34, s34, 18
s_add_u32 s12, s12, s34
s_addc_u32 s13, s13, 0
s_add_u32 s16, s16, s34
s_addc_u32 s17, s17, 0
s_mov_b32 s14, 262144
s_mov_b32 s15, 0x20000
s_mov_b32 s18, 262144
s_mov_b32 s19, 0x20000
s_and_b32 s34, s3, 1
s_lshl_b32 s35, s24, 1
s_or_b32 s34, s34, s35
s_cmp_eq_u32 s34, 0
s_cselect_b32 s40, 0, s14
s_cmp_eq_u32 s34, 1
s_cselect_b32 s14, 0, s14
s_mov_b32 s18, s14
s_lshl_b32 s34, s24, 4
s_add_u32 s34, s34, s27
s_mul_i32 s34, s34, 884736
s_add_u32 s20, s96, s34
s_addc_u32 s21, s97, 0
s_mov_b32 s22, 884736
s_mov_b32 s23, 0x20000
s_mov_b32 s46, 1132462080
s_mov_b32 s84, 1040356334
s_mov_b32 s85, 1040356334
v_bfe_u32 v1, v7, 4, 1
v_lshrrev_b32 v2, 5, v7
v_bfe_u32 v3, v7, 2, 2
v_and_b32 v4, 3, v7
v_lshl_add_u32 v30, v2, 2, v3
v_lshlrev_b32 v30, 8, v30
v_lshl_add_u32 v30, v1, 5, v30
v_lshl_add_u32 v30, v4, 3, v30
s_and_b32 s34, s3, 2
s_cmp_eq_u32 s24, 0
s_cselect_b32 s34, s34, s3
s_mul_i32 s50, s34, 34816
s_add_u32 s34, s50, 8704
v_add_u32 v30, s34, v30
v_xor_b32 v31, 0, v3
v_lshl_add_u32 v12, v31, 6, v30
v_xor_b32 v31, 1, v3
v_lshl_add_u32 v13, v31, 6, v30
v_xor_b32 v31, 2, v3
v_lshl_add_u32 v14, v31, 6, v30
v_xor_b32 v31, 3, v3
v_lshl_add_u32 v15, v31, 6, v30
v_and_b32 v1, 31, v7
v_lshrrev_b32 v3, 2, v1
v_mul_u32_u24 v3, 1088, v3
v_lshl_add_u32 v3, v4, 8, v3
v_add_u32 v3, s50, v3
v_xor_b32 v30, v2, v4
v_lshl_add_u32 v10, v30, 4, v3
v_xor_b32 v30, 2, v30
v_lshl_add_u32 v11, v30, 4, v3
v_lshrrev_b32 v1, 4, v7
v_bfe_u32 v2, v7, 2, 2
v_lshl_add_u32 v30, v1, 3, v2
v_lshlrev_b32 v30, 8, v30
v_and_b32 v31, 1, v7
v_lshl_add_u32 v30, v31, 3, v30
v_add_u32 v30, s38, v30
v_bfe_u32 v31, v7, 1, 1
v_lshl_add_u32 v31, v2, 2, v31
v_and_b32 v2, 1, v1
v_lshl_add_u32 v31, v2, 1, v31
v_xor_b32 v2, 0, v31
v_lshl_add_u32 v16, v2, 4, v30
v_xor_b32 v2, 2, v31
v_lshl_add_u32 v17, v2, 4, v30
v_xor_b32 v2, 4, v31
v_lshl_add_u32 v18, v2, 4, v30
v_xor_b32 v2, 6, v31
v_lshl_add_u32 v19, v2, 4, v30
v_xor_b32 v2, 8, v31
v_lshl_add_u32 v20, v2, 4, v30
v_xor_b32 v2, 10, v31
v_lshl_add_u32 v21, v2, 4, v30
v_xor_b32 v2, 12, v31
v_lshl_add_u32 v22, v2, 4, v30
v_xor_b32 v2, 14, v31
v_lshl_add_u32 v23, v2, 4, v30
v_and_b32 v2, 15, v7
v_lshlrev_b32 v30, 7, v2
v_add_u32 v30, 139264, v30
v_lshrrev_b32 v2, 1, v2
v_xor_b32 v2, v2, v1
v_lshl_add_u32 v24, v2, 4, v30
v_xor_b32 v2, 4, v2
v_lshl_add_u32 v25, v2, 4, v30
s_and_b32 s34, s27, 1
s_lshl_b32 s34, s34, 7
v_add_u32 v47, s34, v47
v_add_u32 v3, 0, v47
v_add_u32 v4, 8192, v47
v_add_u32 v5, 16384, v47
v_add_u32 v6, 24576, v47
s_add_u32 m0, s38, 8192
s_xor_b32 s36, s41, 262144
buffer_load_dwordx4 v40, s[8:11], s36 offen offset:0  lds
buffer_load_dwordx4 v41, s[8:11], s36 offen offset:1024  lds
buffer_load_dwordx4 v42, s[8:11], s36 offen offset:2048  lds
buffer_load_dwordx4 v43, s[8:11], s36 offen offset:3072  lds
s_lshl_b32 s94, s24, 4
s_add_u32 s94, s94, s27
s_or_b32 s34, s24, s3
s_cmp_lg_u32 s34, 0
s_cbranch_scc1 L_noinit
s_lshl_b32 s34, s94, 3
s_add_u32 s34, s34, s25
s_lshl_b32 s34, s34, 8
s_add_u32 s34, s34, 50331648
v_lshlrev_b32 v48, 2, v7
v_add_u32 v48, s34, v48
v_mov_b32 v49, 0
global_store_dword v48, v49, s[96:97] sc1
L_noinit:
s_add_u32 m0, s38, 12288
s_xor_b32 s36, s41, 393216
buffer_load_dwordx4 v40, s[8:11], s36 offen offset:0  lds
buffer_load_dwordx4 v41, s[8:11], s36 offen offset:1024  lds
buffer_load_dwordx4 v42, s[8:11], s36 offen offset:2048  lds
buffer_load_dwordx4 v43, s[8:11], s36 offen offset:3072  lds
s_waitcnt vmcnt(8)
s_barrier
ds_read_b64_tr_b16 a[128:129], v16 offset:0
ds_read_b64_tr_b16 a[130:131], v16 offset:1024
ds_read_b128 a[192:195], v24 offset:0
ds_read_b128 a[196:199], v24 offset:2048
ds_read_b128 a[200:203], v24 offset:4096
ds_read_b128 a[204:207], v24 offset:6144
ds_read_b128 a[208:211], v24 offset:8192
ds_read_b128 a[212:215], v24 offset:10240
ds_read_b64_tr_b16 a[132:133], v17 offset:0
ds_read_b64_tr_b16 a[134:135], v17 offset:1024
ds_read_b64_tr_b16 a[136:137], v18 offset:0
ds_read_b64_tr_b16 a[138:139], v18 offset:1024
ds_read_b64_tr_b16 a[140:141], v19 offset:0
ds_read_b64_tr_b16 a[142:143], v19 offset:1024
ds_read_b64_tr_b16 a[144:145], v20 offset:0
ds_read_b64_tr_b16 a[146:147], v20 offset:1024
ds_read_b64_tr_b16 a[148:149], v21 offset:0
ds_read_b64_tr_b16 a[150:151], v21 offset:1024
ds_read_b64_tr_b16 a[152:153], v22 offset:0
ds_read_b64_tr_b16 a[154:155], v22 offset:1024
ds_read_b64_tr_b16 a[156:157], v23 offset:0
ds_read_b64_tr_b16 a[158:159], v23 offset:1024
s_waitcnt lgkmcnt(0)
v_mfma_f32_16x16x32_bf16 v[64:67], a[128:131], a[192:195], 0
v_mfma_f32_16x16x32_bf16 v[68:71], a[128:131], a[196:199], 0
v_mfma_f32_16x16x32_bf16 v[128:131], a[128:131], a[200:203], 0
v_mfma_f32_16x16x32_bf16 v[132:135], a[128:131], a[204:207], 0
v_mfma_f32_16x16x32_bf16 v[192:195], a[128:131], a[208:211], 0
v_mfma_f32_16x16x32_bf16 v[196:199], a[128:131], a[212:215], 0
v_mfma_f32_16x16x32_bf16 v[72:75], a[132:135], a[192:195], 0
v_mfma_f32_16x16x32_bf16 v[76:79], a[132:135], a[196:199], 0
v_mfma_f32_16x16x32_bf16 v[136:139], a[132:135], a[200:203], 0
v_mfma_f32_16x16x32_bf16 v[140:143], a[132:135], a[204:207], 0
v_mfma_f32_16x16x32_bf16 v[200:203], a[132:135], a[208:211], 0
v_mfma_f32_16x16x32_bf16 v[204:207], a[132:135], a[212:215], 0
v_mfma_f32_16x16x32_bf16 v[80:83], a[136:139], a[192:195], 0
v_mfma_f32_16x16x32_bf16 v[84:87], a[136:139], a[196:199], 0
v_mfma_f32_16x16x32_bf16 v[144:147], a[136:139], a[200:203], 0
v_mfma_f32_16x16x32_bf16 v[148:151], a[136:139], a[204:207], 0
v_mfma_f32_16x16x32_bf16 v[208:211], a[136:139], a[208:211], 0
v_mfma_f32_16x16x32_bf16 v[212:215], a[136:139], a[212:215], 0
v_mfma_f32_16x16x32_bf16 v[88:91], a[140:143], a[192:195], 0
v_mfma_f32_16x16x32_bf16 v[92:95], a[140:143], a[196:199], 0
v_mfma_f32_16x16x32_bf16 v[152:155], a[140:143], a[200:203], 0
v_mfma_f32_16x16x32_bf16 v[156:159], a[140:143], a[204:207], 0
v_mfma_f32_16x16x32_bf16 v[216:219], a[140:143], a[208:211], 0
v_mfma_f32_16x16x32_bf16 v[220:223], a[140:143], a[212:215], 0
v_mfma_f32_16x16x32_bf16 v[96:99], a[144:147], a[192:195], 0
v_mfma_f32_16x16x32_bf16 v[100:103], a[144:147], a[196:199], 0
v_mfma_f32_16x16x32_bf16 v[160:163], a[144:147], a[200:203], 0
v_mfma_f32_16x16x32_bf16 v[164:167], a[144:147], a[204:207], 0
v_mfma_f32_16x16x32_bf16 v[224:227], a[144:147], a[208:211], 0
v_mfma_f32_16x16x32_bf16 v[228:231], a[144:147], a[212:215], 0
v_mfma_f32_16x16x32_bf16 v[104:107], a[148:151], a[192:195], 0
v_mfma_f32_16x16x32_bf16 v[108:111], a[148:151], a[196:199], 0
v_mfma_f32_16x16x32_bf16 v[168:171], a[148:151], a[200:203], 0
v_mfma_f32_16x16x32_bf16 v[172:175], a[148:151], a[204:207], 0
v_mfma_f32_16x16x32_bf16 v[232:235], a[148:151], a[208:211], 0
v_mfma_f32_16x16x32_bf16 v[236:239], a[148:151], a[212:215], 0
v_mfma_f32_16x16x32_bf16 v[112:115], a[152:155], a[192:195], 0
s_waitcnt vmcnt(0)
ds_read_b64_tr_b16 a[160:161], v16 offset:8192
ds_read_b64_tr_b16 a[162:163], v16 offset:9216
v_mfma_f32_16x16x32_bf16 v[116:119], a[152:155], a[196:199], 0
ds_read_b128 a[216:219], v25 offset:0
ds_read_b128 a[220:223], v25 offset:2048
s_lshl_b32 s42, s43, 7
s_add_u32 s42, s42, s33
s_add_u32 s43, s43, 1
s_cmp_eq_u32 s43, 9
s_cselect_b32 s43, 0, s43
s_add_u32 m0, s39, 12288
s_nop 0
buffer_load_dwordx4 v44, s[4:7], s42 offen offset:0  lds
buffer_load_dwordx4 v45, s[4:7], s42 offen offset:1024  lds
v_mfma_f32_16x16x32_bf16 v[176:179], a[152:155], a[200:203], 0
ds_read_b128 a[224:227], v25 offset:4096
ds_read_b128 a[228:231], v25 offset:6144
buffer_load_dwordx4 v46, s[4:7], s42 offen offset:2048  lds
v_mfma_f32_16x16x32_bf16 v[180:183], a[152:155], a[204:207], 0
ds_read_b128 a[232:235], v25 offset:8192
ds_read_b128 a[236:239], v25 offset:10240
s_lshl_b32 s41, s29, 19
s_add_u32 s41, s41, s32
s_add_u32 s29, s29, 1
s_cmp_eq_u32 s29, 9
s_cselect_b32 s29, 0, s29
s_add_u32 m0, s38, 16384
s_xor_b32 s36, s41, 0
buffer_load_dwordx4 v40, s[8:11], s36 offen offset:0  lds
v_mfma_f32_16x16x32_bf16 v[240:243], a[152:155], a[208:211], 0
ds_read_b64_tr_b16 a[164:165], v17 offset:8192
ds_read_b64_tr_b16 a[166:167], v17 offset:9216
buffer_load_dwordx4 v41, s[8:11], s36 offen offset:1024  lds
v_mfma_f32_16x16x32_bf16 v[244:247], a[152:155], a[212:215], 0
ds_read_b64_tr_b16 a[168:169], v18 offset:8192
ds_read_b64_tr_b16 a[170:171], v18 offset:9216
buffer_load_dwordx4 v42, s[8:11], s36 offen offset:2048  lds
v_mfma_f32_16x16x32_bf16 v[120:123], a[156:159], a[192:195], 0
ds_read_b64_tr_b16 a[172:173], v19 offset:8192
ds_read_b64_tr_b16 a[174:175], v19 offset:9216
buffer_load_dwordx4 v43, s[8:11], s36 offen offset:3072  lds
v_mfma_f32_16x16x32_bf16 v[124:127], a[156:159], a[196:199], 0
ds_read_b64_tr_b16 a[176:177], v20 offset:8192
ds_read_b64_tr_b16 a[178:179], v20 offset:9216
s_add_u32 m0, s38, 20480
s_xor_b32 s36, s41, 131072
buffer_load_dwordx4 v40, s[8:11], s36 offen offset:0  lds
v_mfma_f32_16x16x32_bf16 v[184:187], a[156:159], a[200:203], 0
ds_read_b64_tr_b16 a[180:181], v21 offset:8192
ds_read_b64_tr_b16 a[182:183], v21 offset:9216
buffer_load_dwordx4 v41, s[8:11], s36 offen offset:1024  lds
v_mfma_f32_16x16x32_bf16 v[188:191], a[156:159], a[204:207], 0
ds_read_b64_tr_b16 a[184:185], v22 offset:8192
ds_read_b64_tr_b16 a[186:187], v22 offset:9216
buffer_load_dwordx4 v42, s[8:11], s36 offen offset:2048  lds
v_mfma_f32_16x16x32_bf16 v[248:251], a[156:159], a[208:211], 0
ds_read_b64_tr_b16 a[188:189], v23 offset:8192
ds_read_b64_tr_b16 a[190:191], v23 offset:9216
buffer_load_dwordx4 v43, s[8:11], s36 offen offset:3072  lds
v_mfma_f32_16x16x32_bf16 v[252:255], a[156:159], a[212:215], 0
s_add_u32 m0, s38, 24576
s_xor_b32 s36, s41, 262144
buffer_load_dwordx4 v40, s[8:11], s36 offen offset:0  lds
s_waitcnt vmcnt(1) lgkmcnt(0)
s_barrier
v_mfma_f32_16x16x32_bf16 v[64:67], a[160:163], a[216:219], v[64:67]
ds_read_b64_tr_b16 a[128:129], v16 offset:16384
v_mfma_f32_16x16x32_bf16 v[68:71], a[160:163], a[220:223], v[68:71]
ds_read_b64_tr_b16 a[130:131], v16 offset:17408
s_lshl_b32 s42, s43, 7
s_add_u32 s42, s42, s33
v_mfma_f32_16x16x32_bf16 v[128:131], a[160:163], a[224:227], v[128:131]
s_add_u32 s43, s43, 1
s_cmp_eq_u32 s43, 9
v_mfma_f32_16x16x32_bf16 v[132:135], a[160:163], a[228:231], v[132:135]
ds_read_b128 a[192:195], v24 offset:12288
s_cselect_b32 s43, 0, s43
s_add_u32 m0, s39, 0
v_mfma_f32_16x16x32_bf16 v[192:195], a[160:163], a[232:235], v[192:195]
ds_read_b128 a[196:199], v24 offset:14336
buffer_load_dwordx4 v44, s[4:7], s42 offen offset:0  lds
buffer_load_dwordx4 v45, s[4:7], s42 offen offset:1024  lds
v_mfma_f32_16x16x32_bf16 v[196:199], a[160:163], a[236:239], v[196:199]
v_mfma_f32_16x16x32_bf16 v[72:75], a[164:167], a[216:219], v[72:75]
ds_read_b128 a[200:203], v24 offset:16384
v_mfma_f32_16x16x32_bf16 v[76:79], a[164:167], a[220:223], v[76:79]
v_mfma_f32_16x16x32_bf16 v[136:139], a[164:167], a[224:227], v[136:139]
ds_read_b128 a[204:207], v24 offset:18432
buffer_load_dwordx4 v46, s[4:7], s42 offen offset:2048  lds
v_mfma_f32_16x16x32_bf16 v[140:143], a[164:167], a[228:231], v[140:143]
ds_read_b128 a[208:211], v24 offset:20480
v_mfma_f32_16x16x32_bf16 v[200:203], a[164:167], a[232:235], v[200:203]
v_mfma_f32_16x16x32_bf16 v[204:207], a[164:167], a[236:239], v[204:207]
ds_read_b128 a[212:215], v24 offset:22528
s_add_u32 m0, s38, 24576
s_xor_b32 s36, s41, 262144
v_mfma_f32_16x16x32_bf16 v[80:83], a[168:171], a[216:219], v[80:83]
buffer_load_dwordx4 v41, s[8:11], s36 offen offset:1024  lds
v_mfma_f32_16x16x32_bf16 v[84:87], a[168:171], a[220:223], v[84:87]
ds_read_b64_tr_b16 a[132:133], v17 offset:16384
v_mfma_f32_16x16x32_bf16 v[144:147], a[168:171], a[224:227], v[144:147]
ds_read_b64_tr_b16 a[134:135], v17 offset:17408
v_mfma_f32_16x16x32_bf16 v[148:151], a[168:171], a[228:231], v[148:151]
v_mfma_f32_16x16x32_bf16 v[208:211], a[168:171], a[232:235], v[208:211]
ds_read_b64_tr_b16 a[136:137], v18 offset:16384
buffer_load_dwordx4 v42, s[8:11], s36 offen offset:2048  lds
v_mfma_f32_16x16x32_bf16 v[212:215], a[168:171], a[236:239], v[212:215]
v_mfma_f32_16x16x32_bf16 v[88:91], a[172:175], a[216:219], v[88:91]
ds_read_b64_tr_b16 a[138:139], v18 offset:17408
v_mfma_f32_16x16x32_bf16 v[92:95], a[172:175], a[220:223], v[92:95]
ds_read_b64_tr_b16 a[140:141], v19 offset:16384
v_mfma_f32_16x16x32_bf16 v[152:155], a[172:175], a[224:227], v[152:155]
buffer_load_dwordx4 v43, s[8:11], s36 offen offset:3072  lds
v_mfma_f32_16x16x32_bf16 v[156:159], a[172:175], a[228:231], v[156:159]
ds_read_b64_tr_b16 a[142:143], v19 offset:17408
v_mfma_f32_16x16x32_bf16 v[216:219], a[172:175], a[232:235], v[216:219]
ds_read_b64_tr_b16 a[144:145], v20 offset:16384
v_mfma_f32_16x16x32_bf16 v[220:223], a[172:175], a[236:239], v[220:223]
s_add_u32 m0, s38, 28672
s_xor_b32 s36, s41, 393216
v_mfma_f32_16x16x32_bf16 v[96:99], a[176:179], a[216:219], v[96:99]
ds_read_b64_tr_b16 a[146:147], v20 offset:17408
buffer_load_dwordx4 v40, s[8:11], s36 offen offset:0  lds
v_mfma_f32_16x16x32_bf16 v[100:103], a[176:179], a[220:223], v[100:103]
v_mfma_f32_16x16x32_bf16 v[160:163], a[176:179], a[224:227], v[160:163]
ds_read_b64_tr_b16 a[148:149], v21 offset:16384
v_mfma_f32_16x16x32_bf16 v[164:167], a[176:179], a[228:231], v[164:167]
ds_read_b64_tr_b16 a[150:151], v21 offset:17408
v_mfma_f32_16x16x32_bf16 v[224:227], a[176:179], a[232:235], v[224:227]
buffer_load_dwordx4 v41, s[8:11], s36 offen offset:1024  lds
v_mfma_f32_16x16x32_bf16 v[228:231], a[176:179], a[236:239], v[228:231]
ds_read_b64_tr_b16 a[152:153], v22 offset:16384
v_mfma_f32_16x16x32_bf16 v[104:107], a[180:183], a[216:219], v[104:107]
v_mfma_f32_16x16x32_bf16 v[108:111], a[180:183], a[220:223], v[108:111]
ds_read_b64_tr_b16 a[154:155], v22 offset:17408
v_mfma_f32_16x16x32_bf16 v[168:171], a[180:183], a[224:227], v[168:171]
ds_read_b64_tr_b16 a[156:157], v23 offset:16384
buffer_load_dwordx4 v42, s[8:11], s36 offen offset:2048  lds
v_mfma_f32_16x16x32_bf16 v[172:175], a[180:183], a[228:231], v[172:175]
v_mfma_f32_16x16x32_bf16 v[232:235], a[180:183], a[232:235], v[232:235]
ds_read_b64_tr_b16 a[158:159], v23 offset:17408
v_mfma_f32_16x16x32_bf16 v[236:239], a[180:183], a[236:239], v[236:239]
v_mfma_f32_16x16x32_bf16 v[112:115], a[184:187], a[216:219], v[112:115]
buffer_load_dwordx4 v43, s[8:11], s36 offen offset:3072  lds
v_mfma_f32_16x16x32_bf16 v[116:119], a[184:187], a[220:223], v[116:119]
s_lshl_b32 s41, s29, 19
v_mfma_f32_16x16x32_bf16 v[176:179], a[184:187], a[224:227], v[176:179]
s_add_u32 s41, s41, s32
s_add_u32 s29, s29, 1
v_mfma_f32_16x16x32_bf16 v[180:183], a[184:187], a[228:231], v[180:183]
s_cmp_eq_u32 s29, 9
s_cselect_b32 s29, 0, s29
v_mfma_f32_16x16x32_bf16 v[240:243], a[184:187], a[232:235], v[240:243]
s_add_u32 m0, s38, 0
s_xor_b32 s36, s41, 0
v_mfma_f32_16x16x32_bf16 v[244:247], a[184:187], a[236:239], v[244:247]
buffer_load_dwordx4 v40, s[8:11], s36 offen offset:0  lds
v_mfma_f32_16x16x32_bf16 v[120:123], a[188:191], a[216:219], v[120:123]
v_mfma_f32_16x16x32_bf16 v[124:127], a[188:191], a[220:223], v[124:127]
v_mfma_f32_16x16x32_bf16 v[184:187], a[188:191], a[224:227], v[184:187]
buffer_load_dwordx4 v41, s[8:11], s36 offen offset:1024  lds
v_mfma_f32_16x16x32_bf16 v[188:191], a[188:191], a[228:231], v[188:191]
v_mfma_f32_16x16x32_bf16 v[248:251], a[188:191], a[232:235], v[248:251]
v_mfma_f32_16x16x32_bf16 v[252:255], a[188:191], a[236:239], v[252:255]
s_waitcnt vmcnt(2) lgkmcnt(0)
v_mfma_f32_16x16x32_bf16 v[64:67], a[128:131], a[192:195], v[64:67]
ds_read_b64_tr_b16 a[160:161], v16 offset:24576
v_mfma_f32_16x16x32_bf16 v[68:71], a[128:131], a[196:199], v[68:71]
ds_read_b64_tr_b16 a[162:163], v16 offset:25600
s_add_u32 m0, s38, 0
s_xor_b32 s36, s41, 0
v_mfma_f32_16x16x32_bf16 v[128:131], a[128:131], a[200:203], v[128:131]
buffer_load_dwordx4 v42, s[8:11], s36 offen offset:2048  lds
v_mfma_f32_16x16x32_bf16 v[132:135], a[128:131], a[204:207], v[132:135]
ds_read_b128 a[216:219], v25 offset:12288
v_mfma_f32_16x16x32_bf16 v[192:195], a[128:131], a[208:211], v[192:195]
ds_read_b128 a[220:223], v25 offset:14336
buffer_load_dwordx4 v43, s[8:11], s36 offen offset:3072  lds
v_mfma_f32_16x16x32_bf16 v[196:199], a[128:131], a[212:215], v[196:199]
v_mfma_f32_16x16x32_bf16 v[72:75], a[132:135], a[192:195], v[72:75]
ds_read_b128 a[224:227], v25 offset:16384
v_mfma_f32_16x16x32_bf16 v[76:79], a[132:135], a[196:199], v[76:79]
s_add_u32 m0, s38, 4096
s_xor_b32 s36, s41, 131072
v_mfma_f32_16x16x32_bf16 v[136:139], a[132:135], a[200:203], v[136:139]
ds_read_b128 a[228:231], v25 offset:18432
buffer_load_dwordx4 v40, s[8:11], s36 offen offset:0  lds
v_mfma_f32_16x16x32_bf16 v[140:143], a[132:135], a[204:207], v[140:143]
ds_read_b128 a[232:235], v25 offset:20480
v_mfma_f32_16x16x32_bf16 v[200:203], a[132:135], a[208:211], v[200:203]
v_mfma_f32_16x16x32_bf16 v[204:207], a[132:135], a[212:215], v[204:207]
ds_read_b128 a[236:239], v25 offset:22528
v_mfma_f32_16x16x32_bf16 v[80:83], a[136:139], a[192:195], v[80:83]
buffer_load_dwordx4 v41, s[8:11], s36 offen offset:1024  lds
v_mfma_f32_16x16x32_bf16 v[84:87], a[136:139], a[196:199], v[84:87]
ds_read_b64_tr_b16 a[164:165], v17 offset:24576
v_mfma_f32_16x16x32_bf16 v[144:147], a[136:139], a[200:203], v[144:147]
ds_read_b64_tr_b16 a[166:167], v17 offset:25600
v_mfma_f32_16x16x32_bf16 v[148:151], a[136:139], a[204:207], v[148:151]
v_mfma_f32_16x16x32_bf16 v[208:211], a[136:139], a[208:211], v[208:211]
ds_read_b64_tr_b16 a[168:169], v18 offset:24576
buffer_load_dwordx4 v42, s[8:11], s36 offen offset:2048  lds
v_mfma_f32_16x16x32_bf16 v[212:215], a[136:139], a[212:215], v[212:215]
v_mfma_f32_16x16x32_bf16 v[88:91], a[140:143], a[192:195], v[88:91]
ds_read_b64_tr_b16 a[170:171], v18 offset:25600
v_mfma_f32_16x16x32_bf16 v[92:95], a[140:143], a[196:199], v[92:95]
ds_read_b64_tr_b16 a[172:173], v19 offset:24576
v_mfma_f32_16x16x32_bf16 v[152:155], a[140:143], a[200:203], v[152:155]
buffer_load_dwordx4 v43, s[8:11], s36 offen offset:3072  lds
v_mfma_f32_16x16x32_bf16 v[156:159], a[140:143], a[204:207], v[156:159]
ds_read_b64_tr_b16 a[174:175], v19 offset:25600
v_mfma_f32_16x16x32_bf16 v[216:219], a[140:143], a[208:211], v[216:219]
ds_read_b64_tr_b16 a[176:177], v20 offset:24576
v_mfma_f32_16x16x32_bf16 v[220:223], a[140:143], a[212:215], v[220:223]
s_add_u32 m0, s38, 8192
s_xor_b32 s36, s41, 262144
v_mfma_f32_16x16x32_bf16 v[96:99], a[144:147], a[192:195], v[96:99]
ds_read_b64_tr_b16 a[178:179], v20 offset:25600
buffer_load_dwordx4 v40, s[8:11], s36 offen offset:0  lds
v_mfma_f32_16x16x32_bf16 v[100:103], a[144:147], a[196:199], v[100:103]
v_mfma_f32_16x16x32_bf16 v[160:163], a[144:147], a[200:203], v[160:163]
ds_read_b64_tr_b16 a[180:181], v21 offset:24576
v_mfma_f32_16x16x32_bf16 v[164:167], a[144:147], a[204:207], v[164:167]
ds_read_b64_tr_b16 a[182:183], v21 offset:25600
v_mfma_f32_16x16x32_bf16 v[224:227], a[144:147], a[208:211], v[224:227]
buffer_load_dwordx4 v41, s[8:11], s36 offen offset:1024  lds
v_mfma_f32_16x16x32_bf16 v[228:231], a[144:147], a[212:215], v[228:231]
ds_read_b64_tr_b16 a[184:185], v22 offset:24576
v_mfma_f32_16x16x32_bf16 v[104:107], a[148:151], a[192:195], v[104:107]
v_mfma_f32_16x16x32_bf16 v[108:111], a[148:151], a[196:199], v[108:111]
ds_read_b64_tr_b16 a[186:187], v22 offset:25600
v_mfma_f32_16x16x32_bf16 v[168:171], a[148:151], a[200:203], v[168:171]
ds_read_b64_tr_b16 a[188:189], v23 offset:24576
buffer_load_dwordx4 v42, s[8:11], s36 offen offset:2048  lds
v_mfma_f32_16x16x32_bf16 v[172:175], a[148:151], a[204:207], v[172:175]
v_mfma_f32_16x16x32_bf16 v[232:235], a[148:151], a[208:211], v[232:235]
ds_read_b64_tr_b16 a[190:191], v23 offset:25600
v_mfma_f32_16x16x32_bf16 v[236:239], a[148:151], a[212:215], v[236:239]
v_mfma_f32_16x16x32_bf16 v[112:115], a[152:155], a[192:195], v[112:115]
buffer_load_dwordx4 v43, s[8:11], s36 offen offset:3072  lds
v_mfma_f32_16x16x32_bf16 v[116:119], a[152:155], a[196:199], v[116:119]
v_mfma_f32_16x16x32_bf16 v[176:179], a[152:155], a[200:203], v[176:179]
v_mfma_f32_16x16x32_bf16 v[180:183], a[152:155], a[204:207], v[180:183]
s_add_u32 m0, s38, 12288
s_xor_b32 s36, s41, 393216
v_mfma_f32_16x16x32_bf16 v[240:243], a[152:155], a[208:211], v[240:243]
buffer_load_dwordx4 v40, s[8:11], s36 offen offset:0  lds
v_mfma_f32_16x16x32_bf16 v[244:247], a[152:155], a[212:215], v[244:247]
v_mfma_f32_16x16x32_bf16 v[120:123], a[156:159], a[192:195], v[120:123]
v_mfma_f32_16x16x32_bf16 v[124:127], a[156:159], a[196:199], v[124:127]
v_mfma_f32_16x16x32_bf16 v[184:187], a[156:159], a[200:203], v[184:187]
buffer_load_dwordx4 v41, s[8:11], s36 offen offset:1024  lds
v_mfma_f32_16x16x32_bf16 v[188:191], a[156:159], a[204:207], v[188:191]
v_mfma_f32_16x16x32_bf16 v[248:251], a[156:159], a[208:211], v[248:251]
v_mfma_f32_16x16x32_bf16 v[252:255], a[156:159], a[212:215], v[252:255]
s_waitcnt vmcnt(6) lgkmcnt(0)
s_barrier
v_mfma_f32_16x16x32_bf16 v[64:67], a[160:163], a[216:219], v[64:67]
ds_read_b64_tr_b16 a[128:129], v16 offset:0
v_mfma_f32_16x16x32_bf16 v[68:71], a[160:163], a[220:223], v[68:71]
ds_read_b64_tr_b16 a[130:131], v16 offset:1024
s_lshl_b32 s42, s43, 7
s_add_u32 s42, s42, s33
v_mfma_f32_16x16x32_bf16 v[128:131], a[160:163], a[224:227], v[128:131]
s_add_u32 s43, s43, 1
s_cmp_eq_u32 s43, 9
v_mfma_f32_16x16x32_bf16 v[132:135], a[160:163], a[228:231], v[132:135]
ds_read_b128 a[192:195], v24 offset:0
s_cselect_b32 s43, 0, s43
s_add_u32 m0, s39, 12288
v_mfma_f32_16x16x32_bf16 v[192:195], a[160:163], a[232:235], v[192:195]
ds_read_b128 a[196:199], v24 offset:2048
buffer_load_dwordx4 v44, s[4:7], s42 offen offset:0  lds
buffer_load_dwordx4 v45, s[4:7], s42 offen offset:1024  lds
v_mfma_f32_16x16x32_bf16 v[196:199], a[160:163], a[236:239], v[196:199]
v_mfma_f32_16x16x32_bf16 v[72:75], a[164:167], a[216:219], v[72:75]
ds_read_b128 a[200:203], v24 offset:4096
v_mfma_f32_16x16x32_bf16 v[76:79], a[164:167], a[220:223], v[76:79]
v_mfma_f32_16x16x32_bf16 v[136:139], a[164:167], a[224:227], v[136:139]
ds_read_b128 a[204:207], v24 offset:6144
buffer_load_dwordx4 v46, s[4:7], s42 offen offset:2048  lds
v_mfma_f32_16x16x32_bf16 v[140:143], a[164:167], a[228:231], v[140:143]
ds_read_b128 a[208:211], v24 offset:8192
v_mfma_f32_16x16x32_bf16 v[200:203], a[164:167], a[232:235], v[200:203]
v_mfma_f32_16x16x32_bf16 v[204:207], a[164:167], a[236:239], v[204:207]
ds_read_b128 a[212:215], v24 offset:10240
s_add_u32 m0, s38, 12288
s_xor_b32 s36, s41, 393216
v_mfma_f32_16x16x32_bf16 v[80:83], a[168:171], a[216:219], v[80:83]
buffer_load_dwordx4 v42, s[8:11], s36 offen offset:2048  lds
v_mfma_f32_16x16x32_bf16 v[84:87], a[168:171], a[220:223], v[84:87]
ds_read_b64_tr_b16 a[132:133], v17 offset:0
v_mfma_f32_16x16x32_bf16 v[144:147], a[168:171], a[224:227], v[144:147]
ds_read_b64_tr_b16 a[134:135], v17 offset:1024
v_mfma_f32_16x16x32_bf16 v[148:151], a[168:171], a[228:231], v[148:151]
v_mfma_f32_16x16x32_bf16 v[208:211], a[168:171], a[232:235], v[208:211]
ds_read_b64_tr_b16 a[136:137], v18 offset:0
buffer_load_dwordx4 v43, s[8:11], s36 offen offset:3072  lds
v_mfma_f32_16x16x32_bf16 v[212:215], a[168:171], a[236:239], v[212:215]
s_lshl_b32 s41, s29, 19
v_mfma_f32_16x16x32_bf16 v[88:91], a[172:175], a[216:219], v[88:91]
ds_read_b64_tr_b16 a[138:139], v18 offset:1024
s_add_u32 s41, s41, s32
s_add_u32 s29, s29, 1
v_mfma_f32_16x16x32_bf16 v[92:95], a[172:175], a[220:223], v[92:95]
ds_read_b64_tr_b16 a[140:141], v19 offset:0
s_cmp_eq_u32 s29, 9
s_cselect_b32 s29, 0, s29
v_mfma_f32_16x16x32_bf16 v[152:155], a[172:175], a[224:227], v[152:155]
s_add_u32 m0, s38, 16384
s_xor_b32 s36, s41, 0
v_mfma_f32_16x16x32_bf16 v[156:159], a[172:175], a[228:231], v[156:159]
ds_read_b64_tr_b16 a[142:143], v19 offset:1024
buffer_load_dwordx4 v40, s[8:11], s36 offen offset:0  lds
v_mfma_f32_16x16x32_bf16 v[216:219], a[172:175], a[232:235], v[216:219]
ds_read_b64_tr_b16 a[144:145], v20 offset:0
v_mfma_f32_16x16x32_bf16 v[220:223], a[172:175], a[236:239], v[220:223]
v_mfma_f32_16x16x32_bf16 v[96:99], a[176:179], a[216:219], v[96:99]
ds_read_b64_tr_b16 a[146:147], v20 offset:1024
buffer_load_dwordx4 v41, s[8:11], s36 offen offset:1024  lds
v_mfma_f32_16x16x32_bf16 v[100:103], a[176:179], a[220:223], v[100:103]
v_mfma_f32_16x16x32_bf16 v[160:163], a[176:179], a[224:227], v[160:163]
ds_read_b64_tr_b16 a[148:149], v21 offset:0
v_mfma_f32_16x16x32_bf16 v[164:167], a[176:179], a[228:231], v[164:167]
ds_read_b64_tr_b16 a[150:151], v21 offset:1024
v_mfma_f32_16x16x32_bf16 v[224:227], a[176:179], a[232:235], v[224:227]
buffer_load_dwordx4 v42, s[8:11], s36 offen offset:2048  lds
v_mfma_f32_16x16x32_bf16 v[228:231], a[176:179], a[236:239], v[228:231]
ds_read_b64_tr_b16 a[152:153], v22 offset:0
v_mfma_f32_16x16x32_bf16 v[104:107], a[180:183], a[216:219], v[104:107]
v_mfma_f32_16x16x32_bf16 v[108:111], a[180:183], a[220:223], v[108:111]
ds_read_b64_tr_b16 a[154:155], v22 offset:1024
v_mfma_f32_16x16x32_bf16 v[168:171], a[180:183], a[224:227], v[168:171]
ds_read_b64_tr_b16 a[156:157], v23 offset:0
buffer_load_dwordx4 v43, s[8:11], s36 offen offset:3072  lds
v_mfma_f32_16x16x32_bf16 v[172:175], a[180:183], a[228:231], v[172:175]
v_mfma_f32_16x16x32_bf16 v[232:235], a[180:183], a[232:235], v[232:235]
ds_read_b64_tr_b16 a[158:159], v23 offset:1024
v_mfma_f32_16x16x32_bf16 v[236:239], a[180:183], a[236:239], v[236:239]
s_add_u32 m0, s38, 20480
s_xor_b32 s36, s41, 131072
v_mfma_f32_16x16x32_bf16 v[112:115], a[184:187], a[216:219], v[112:115]
buffer_load_dwordx4 v40, s[8:11], s36 offen offset:0  lds
v_mfma_f32_16x16x32_bf16 v[116:119], a[184:187], a[220:223], v[116:119]
v_mfma_f32_16x16x32_bf16 v[176:179], a[184:187], a[224:227], v[176:179]
v_mfma_f32_16x16x32_bf16 v[180:183], a[184:187], a[228:231], v[180:183]
v_mfma_f32_16x16x32_bf16 v[240:243], a[184:187], a[232:235], v[240:243]
buffer_load_dwordx4 v41, s[8:11], s36 offen offset:1024  lds
v_mfma_f32_16x16x32_bf16 v[244:247], a[184:187], a[236:239], v[244:247]
v_mfma_f32_16x16x32_bf16 v[120:123], a[188:191], a[216:219], v[120:123]
v_mfma_f32_16x16x32_bf16 v[124:127], a[188:191], a[220:223], v[124:127]
v_mfma_f32_16x16x32_bf16 v[184:187], a[188:191], a[224:227], v[184:187]
buffer_load_dwordx4 v42, s[8:11], s36 offen offset:2048  lds
v_mfma_f32_16x16x32_bf16 v[188:191], a[188:191], a[228:231], v[188:191]
v_mfma_f32_16x16x32_bf16 v[248:251], a[188:191], a[232:235], v[248:251]
v_mfma_f32_16x16x32_bf16 v[252:255], a[188:191], a[236:239], v[252:255]
s_or_b32 s34, s24, s3
s_cmp_lg_u32 s34, 0
s_cbranch_scc1 L_noinit2
s_waitcnt vmcnt(0)
s_lshl_b32 s34, s94, 3
v_mov_b32 v48, s34
v_mov_b32 v49, 1
s_mov_b64 exec, 1
global_atomic_add v48, v49, s[98:99] sc1
s_mov_b64 exec, -1
L_noinit2:
s_waitcnt vmcnt(7) lgkmcnt(0)
v_mfma_f32_16x16x32_bf16 v[64:67], a[128:131], a[192:195], v[64:67]
ds_read_b64_tr_b16 a[160:161], v16 offset:8192
v_accvgpr_write_b32 a0, 0
v_mfma_f32_16x16x32_bf16 v[68:71], a[128:131], a[196:199], v[68:71]
ds_read_b64_tr_b16 a[162:163], v16 offset:9216
s_add_u32 m0, s38, 20480
s_xor_b32 s36, s41, 131072
v_mfma_f32_16x16x32_bf16 v[128:131], a[128:131], a[200:203], v[128:131]
buffer_load_dwordx4 v43, s[8:11], s36 offen offset:3072  lds
v_mfma_f32_16x16x32_bf16 v[132:135], a[128:131], a[204:207], v[132:135]
ds_read_b128 a[216:219], v25 offset:0
s_add_u32 m0, s38, 24576
s_xor_b32 s36, s41, 262144
v_mfma_f32_16x16x32_bf16 v[192:195], a[128:131], a[208:211], v[192:195]
ds_read_b128 a[220:223], v25 offset:2048
buffer_load_dwordx4 v40, s[8:11], s36 offen offset:0  lds
v_mfma_f32_16x16x32_bf16 v[196:199], a[128:131], a[212:215], v[196:199]
v_accvgpr_write_b32 a1, 0
v_mfma_f32_16x16x32_bf16 v[72:75], a[132:135], a[192:195], v[72:75]
ds_read_b128 a[224:227], v25 offset:4096
v_accvgpr_write_b32 a2, 0
v_mfma_f32_16x16x32_bf16 v[76:79], a[132:135], a[196:199], v[76:79]
v_accvgpr_write_b32 a3, 0
v_mfma_f32_16x16x32_bf16 v[136:139], a[132:135], a[200:203], v[136:139]
ds_read_b128 a[228:231], v25 offset:6144
buffer_load_dwordx4 v41, s[8:11], s36 offen offset:1024  lds
v_mfma_f32_16x16x32_bf16 v[140:143], a[132:135], a[204:207], v[140:143]
ds_read_b128 a[232:235], v25 offset:8192
v_accvgpr_write_b32 a4, 0
v_mfma_f32_16x16x32_bf16 v[200:203], a[132:135], a[208:211], v[200:203]
v_accvgpr_write_b32 a5, 0
v_mfma_f32_16x16x32_bf16 v[204:207], a[132:135], a[212:215], v[204:207]
ds_read_b128 a[236:239], v25 offset:10240
v_mfma_f32_16x16x32_bf16 v[80:83], a[136:139], a[192:195], v[80:83]
buffer_load_dwordx4 v42, s[8:11], s36 offen offset:2048  lds
v_accvgpr_write_b32 a6, 0
v_mfma_f32_16x16x32_bf16 v[84:87], a[136:139], a[196:199], v[84:87]
ds_read_b64_tr_b16 a[164:165], v17 offset:8192
v_mfma_f32_16x16x32_bf16 v[144:147], a[136:139], a[200:203], v[144:147]
ds_read_b64_tr_b16 a[166:167], v17 offset:9216
v_mfma_f32_16x16x32_bf16 v[148:151], a[136:139], a[204:207], v[148:151]
v_accvgpr_write_b32 a7, 0
v_mfma_f32_16x16x32_bf16 v[208:211], a[136:139], a[208:211], v[208:211]
ds_read_b64_tr_b16 a[168:169], v18 offset:8192
buffer_load_dwordx4 v43, s[8:11], s36 offen offset:3072  lds
v_mfma_f32_16x16x32_bf16 v[212:215], a[136:139], a[212:215], v[212:215]
v_accvgpr_write_b32 a8, 0
v_mfma_f32_16x16x32_bf16 v[88:91], a[140:143], a[192:195], v[88:91]
ds_read_b64_tr_b16 a[170:171], v18 offset:9216
v_accvgpr_write_b32 a9, 0
v_mfma_f32_16x16x32_bf16 v[92:95], a[140:143], a[196:199], v[92:95]
ds_read_b64_tr_b16 a[172:173], v19 offset:8192
s_add_u32 m0, s38, 28672
s_xor_b32 s36, s41, 393216
v_mfma_f32_16x16x32_bf16 v[152:155], a[140:143], a[200:203], v[152:155]
buffer_load_dwordx4 v40, s[8:11], s36 offen offset:0  lds
v_mfma_f32_16x16x32_bf16 v[156:159], a[140:143], a[204:207], v[156:159]
ds_read_b64_tr_b16 a[174:175], v19 offset:9216
v_accvgpr_write_b32 a10, 0
v_mfma_f32_16x16x32_bf16 v[216:219], a[140:143], a[208:211], v[216:219]
ds_read_b64_tr_b16 a[176:177], v20 offset:8192
v_mfma_f32_16x16x32_bf16 v[220:223], a[140:143], a[212:215], v[220:223]
v_accvgpr_write_b32 a11, 0
v_mfma_f32_16x16x32_bf16 v[96:99], a[144:147], a[192:195], v[96:99]
ds_read_b64_tr_b16 a[178:179], v20 offset:9216
buffer_load_dwordx4 v41, s[8:11], s36 offen offset:1024  lds
v_mfma_f32_16x16x32_bf16 v[100:103], a[144:147], a[196:199], v[100:103]
v_accvgpr_write_b32 a12, 0
v_mfma_f32_16x16x32_bf16 v[160:163], a[144:147], a[200:203], v[160:163]
ds_read_b64_tr_b16 a[180:181], v21 offset:8192
v_mfma_f32_16x16x32_bf16 v[164:167], a[144:147], a[204:207], v[164:167]
ds_read_b64_tr_b16 a[182:183], v21 offset:9216
v_accvgpr_write_b32 a13, 0
v_mfma_f32_16x16x32_bf16 v[224:227], a[144:147], a[208:211], v[224:227]
buffer_load_dwordx4 v42, s[8:11], s36 offen offset:2048  lds
v_mfma_f32_16x16x32_bf16 v[228:231], a[144:147], a[212:215], v[228:231]
ds_read_b64_tr_b16 a[184:185], v22 offset:8192
v_mfma_f32_16x16x32_bf16 v[104:107], a[148:151], a[192:195], v[104:107]
v_accvgpr_write_b32 a14, 0
v_mfma_f32_16x16x32_bf16 v[108:111], a[148:151], a[196:199], v[108:111]
ds_read_b64_tr_b16 a[186:187], v22 offset:9216
v_mfma_f32_16x16x32_bf16 v[168:171], a[148:151], a[200:203], v[168:171]
ds_read_b64_tr_b16 a[188:189], v23 offset:8192
buffer_load_dwordx4 v43, s[8:11], s36 offen offset:3072  lds
v_mfma_f32_16x16x32_bf16 v[172:175], a[148:151], a[204:207], v[172:175]
s_lshl_b32 s41, s29, 19
v_accvgpr_write_b32 a15, 0
v_mfma_f32_16x16x32_bf16 v[232:235], a[148:151], a[208:211], v[232:235]
ds_read_b64_tr_b16 a[190:191], v23 offset:9216
s_add_u32 s41, s41, s32
s_add_u32 s29, s29, 1
v_mfma_f32_16x16x32_bf16 v[236:239], a[148:151], a[212:215], v[236:239]
s_cmp_eq_u32 s29, 9
s_cselect_b32 s29, 0, s29
v_mfma_f32_16x16x32_bf16 v[112:115], a[152:155], a[192:195], v[112:115]
s_add_u32 m0, s38, 0
s_xor_b32 s36, s41, 0
v_mfma_f32_16x16x32_bf16 v[116:119], a[152:155], a[196:199], v[116:119]
buffer_load_dwordx4 v40, s[8:11], s36 offen offset:0  lds
v_mfma_f32_16x16x32_bf16 v[176:179], a[152:155], a[200:203], v[176:179]
v_accvgpr_write_b32 a16, 0
v_mfma_f32_16x16x32_bf16 v[180:183], a[152:155], a[204:207], v[180:183]
v_accvgpr_write_b32 a17, 0
v_mfma_f32_16x16x32_bf16 v[240:243], a[152:155], a[208:211], v[240:243]
buffer_load_dwordx4 v41, s[8:11], s36 offen offset:1024  lds
v_mfma_f32_16x16x32_bf16 v[244:247], a[152:155], a[212:215], v[244:247]
v_accvgpr_write_b32 a18, 0
v_mfma_f32_16x16x32_bf16 v[120:123], a[156:159], a[192:195], v[120:123]
v_accvgpr_write_b32 a19, 0
v_mfma_f32_16x16x32_bf16 v[124:127], a[156:159], a[196:199], v[124:127]
v_accvgpr_write_b32 a20, 0
v_mfma_f32_16x16x32_bf16 v[184:187], a[156:159], a[200:203], v[184:187]
buffer_load_dwordx4 v42, s[8:11], s36 offen offset:2048  lds
v_mfma_f32_16x16x32_bf16 v[188:191], a[156:159], a[204:207], v[188:191]
v_accvgpr_write_b32 a21, 0
v_mfma_f32_16x16x32_bf16 v[248:251], a[156:159], a[208:211], v[248:251]
v_accvgpr_write_b32 a22, 0
v_mfma_f32_16x16x32_bf16 v[252:255], a[156:159], a[212:215], v[252:255]
v_accvgpr_write_b32 a23, 0
s_waitcnt vmcnt(11) lgkmcnt(0)
s_barrier
v_mfma_f32_16x16x32_bf16 v[64:67], a[160:163], a[216:219], v[64:67]
ds_read_b64_tr_b16 a[128:129], v16 offset:16384
v_accvgpr_write_b32 a24, 0
v_mfma_f32_16x16x32_bf16 v[68:71], a[160:163], a[220:223], v[68:71]
ds_read_b64_tr_b16 a[130:131], v16 offset:17408
s_lshl_b32 s42, s43, 7
s_add_u32 s42, s42, s33
v_mfma_f32_16x16x32_bf16 v[128:131], a[160:163], a[224:227], v[128:131]
s_add_u32 s43, s43, 1
s_cmp_eq_u32 s43, 9
v_mfma_f32_16x16x32_bf16 v[132:135], a[160:163], a[228:231], v[132:135]
ds_read_b128 a[192:195], v24 offset:12288
s_cselect_b32 s43, 0, s43
s_add_u32 m0, s39, 0
v_mfma_f32_16x16x32_bf16 v[192:195], a[160:163], a[232:235], v[192:195]
ds_read_b128 a[196:199], v24 offset:14336
buffer_load_dwordx4 v44, s[4:7], s42 offen offset:0  lds
buffer_load_dwordx4 v45, s[4:7], s42 offen offset:1024  lds
v_mfma_f32_16x16x32_bf16 v[196:199], a[160:163], a[236:239], v[196:199]
v_accvgpr_write_b32 a25, 0
v_mfma_f32_16x16x32_bf16 v[72:75], a[164:167], a[216:219], v[72:75]
ds_read_b128 a[200:203], v24 offset:16384
v_accvgpr_write_b32 a26, 0
v_mfma_f32_16x16x32_bf16 v[76:79], a[164:167], a[220:223], v[76:79]
v_accvgpr_write_b32 a27, 0
v_mfma_f32_16x16x32_bf16 v[136:139], a[164:167], a[224:227], v[136:139]
ds_read_b128 a[204:207], v24 offset:18432
buffer_load_dwordx4 v46, s[4:7], s42 offen offset:2048  lds
v_mfma_f32_16x16x32_bf16 v[140:143], a[164:167], a[228:231], v[140:143]
ds_read_b128 a[208:211], v24 offset:20480
v_accvgpr_write_b32 a28, 0
v_mfma_f32_16x16x32_bf16 v[200:203], a[164:167], a[232:235], v[200:203]
v_accvgpr_write_b32 a29, 0
v_mfma_f32_16x16x32_bf16 v[204:207], a[164:167], a[236:239], v[204:207]
ds_read_b128 a[212:215], v24 offset:22528
s_add_u32 m0, s38, 0
s_xor_b32 s36, s41, 0
v_mfma_f32_16x16x32_bf16 v[80:83], a[168:171], a[216:219], v[80:83]
buffer_load_dwordx4 v43, s[8:11], s36 offen offset:3072  lds
v_accvgpr_write_b32 a30, 0
v_mfma_f32_16x16x32_bf16 v[84:87], a[168:171], a[220:223], v[84:87]
ds_read_b64_tr_b16 a[132:133], v17 offset:16384
v_mfma_f32_16x16x32_bf16 v[144:147], a[168:171], a[224:227], v[144:147]
ds_read_b64_tr_b16 a[134:135], v17 offset:17408
v_mfma_f32_16x16x32_bf16 v[148:151], a[168:171], a[228:231], v[148:151]
s_add_u32 m0, s38, 4096
s_xor_b32 s36, s41, 131072
v_mfma_f32_16x16x32_bf16 v[208:211], a[168:171], a[232:235], v[208:211]
ds_read_b64_tr_b16 a[136:137], v18 offset:16384
buffer_load_dwordx4 v40, s[8:11], s36 offen offset:0  lds
v_mfma_f32_16x16x32_bf16 v[212:215], a[168:171], a[236:239], v[212:215]
v_accvgpr_write_b32 a31, 0
v_mfma_f32_16x16x32_bf16 v[88:91], a[172:175], a[216:219], v[88:91]
ds_read_b64_tr_b16 a[138:139], v18 offset:17408
v_accvgpr_write_b32 a32, 0
v_mfma_f32_16x16x32_bf16 v[92:95], a[172:175], a[220:223], v[92:95]
ds_read_b64_tr_b16 a[140:141], v19 offset:16384
v_mfma_f32_16x16x32_bf16 v[152:155], a[172:175], a[224:227], v[152:155]
buffer_load_dwordx4 v41, s[8:11], s36 offen offset:1024  lds
v_mfma_f32_16x16x32_bf16 v[156:159], a[172:175], a[228:231], v[156:159]
ds_read_b64_tr_b16 a[142:143], v19 offset:17408
v_accvgpr_write_b32 a33, 0
v_mfma_f32_16x16x32_bf16 v[216:219], a[172:175], a[232:235], v[216:219]
ds_read_b64_tr_b16 a[144:145], v20 offset:16384
v_mfma_f32_16x16x32_bf16 v[220:223], a[172:175], a[236:239], v[220:223]
v_accvgpr_write_b32 a34, 0
v_mfma_f32_16x16x32_bf16 v[96:99], a[176:179], a[216:219], v[96:99]
ds_read_b64_tr_b16 a[146:147], v20 offset:17408
buffer_load_dwordx4 v42, s[8:11], s36 offen offset:2048  lds
v_mfma_f32_16x16x32_bf16 v[100:103], a[176:179], a[220:223], v[100:103]
v_accvgpr_write_b32 a35, 0
v_mfma_f32_16x16x32_bf16 v[160:163], a[176:179], a[224:227], v[160:163]
ds_read_b64_tr_b16 a[148:149], v21 offset:16384
v_mfma_f32_16x16x32_bf16 v[164:167], a[176:179], a[228:231], v[164:167]
ds_read_b64_tr_b16 a[150:151], v21 offset:17408
v_accvgpr_write_b32 a36, 0
v_mfma_f32_16x16x32_bf16 v[224:227], a[176:179], a[232:235], v[224:227]
buffer_load_dwordx4 v43, s[8:11], s36 offen offset:3072  lds
v_mfma_f32_16x16x32_bf16 v[228:231], a[176:179], a[236:239], v[228:231]
ds_read_b64_tr_b16 a[152:153], v22 offset:16384
v_mfma_f32_16x16x32_bf16 v[104:107], a[180:183], a[216:219], v[104:107]
v_accvgpr_write_b32 a37, 0
v_mfma_f32_16x16x32_bf16 v[108:111], a[180:183], a[220:223], v[108:111]
ds_read_b64_tr_b16 a[154:155], v22 offset:17408
s_add_u32 m0, s38, 8192
s_xor_b32 s36, s41, 262144
v_mfma_f32_16x16x32_bf16 v[168:171], a[180:183], a[224:227], v[168:171]
ds_read_b64_tr_b16 a[156:157], v23 offset:16384
buffer_load_dwordx4 v40, s[8:11], s36 offen offset:0  lds
v_mfma_f32_16x16x32_bf16 v[172:175], a[180:183], a[228:231], v[172:175]
v_accvgpr_write_b32 a38, 0
v_mfma_f32_16x16x32_bf16 v[232:235], a[180:183], a[232:235], v[232:235]
ds_read_b64_tr_b16 a[158:159], v23 offset:17408
v_mfma_f32_16x16x32_bf16 v[236:239], a[180:183], a[236:239], v[236:239]
v_accvgpr_write_b32 a39, 0
v_mfma_f32_16x16x32_bf16 v[112:115], a[184:187], a[216:219], v[112:115]
buffer_load_dwordx4 v41, s[8:11], s36 offen offset:1024  lds
v_accvgpr_write_b32 a40, 0
v_mfma_f32_16x16x32_bf16 v[116:119], a[184:187], a[220:223], v[116:119]
v_accvgpr_write_b32 a41, 0
v_mfma_f32_16x16x32_bf16 v[176:179], a[184:187], a[224:227], v[176:179]
v_accvgpr_write_b32 a42, 0
v_mfma_f32_16x16x32_bf16 v[180:183], a[184:187], a[228:231], v[180:183]
v_accvgpr_write_b32 a43, 0
v_mfma_f32_16x16x32_bf16 v[240:243], a[184:187], a[232:235], v[240:243]
buffer_load_dwordx4 v42, s[8:11], s36 offen offset:2048  lds
v_mfma_f32_16x16x32_bf16 v[244:247], a[184:187], a[236:239], v[244:247]
v_accvgpr_write_b32 a44, 0
v_mfma_f32_16x16x32_bf16 v[120:123], a[188:191], a[216:219], v[120:123]
v_accvgpr_write_b32 a45, 0
v_mfma_f32_16x16x32_bf16 v[124:127], a[188:191], a[220:223], v[124:127]
v_accvgpr_write_b32 a46, 0
v_mfma_f32_16x16x32_bf16 v[184:187], a[188:191], a[224:227], v[184:187]
buffer_load_dwordx4 v43, s[8:11], s36 offen offset:3072  lds
v_mfma_f32_16x16x32_bf16 v[188:191], a[188:191], a[228:231], v[188:191]
v_accvgpr_write_b32 a47, 0
v_mfma_f32_16x16x32_bf16 v[248:251], a[188:191], a[232:235], v[248:251]
v_accvgpr_write_b32 a48, 0
v_mfma_f32_16x16x32_bf16 v[252:255], a[188:191], a[236:239], v[252:255]
v_accvgpr_write_b32 a49, 0
s_waitcnt vmcnt(15) lgkmcnt(0)
v_mfma_f32_16x16x32_bf16 v[64:67], a[128:131], a[192:195], v[64:67]
ds_read_b64_tr_b16 a[160:161], v16 offset:24576
v_accvgpr_write_b32 a50, 0
v_mfma_f32_16x16x32_bf16 v[68:71], a[128:131], a[196:199], v[68:71]
ds_read_b64_tr_b16 a[162:163], v16 offset:25600
s_add_u32 m0, s38, 12288
s_xor_b32 s36, s41, 393216
v_mfma_f32_16x16x32_bf16 v[128:131], a[128:131], a[200:203], v[128:131]
buffer_load_dwordx4 v40, s[8:11], s36 offen offset:0  lds
v_mfma_f32_16x16x32_bf16 v[132:135], a[128:131], a[204:207], v[132:135]
ds_read_b128 a[216:219], v25 offset:12288
v_accvgpr_write_b32 a51, 0
v_mfma_f32_16x16x32_bf16 v[192:195], a[128:131], a[208:211], v[192:195]
ds_read_b128 a[220:223], v25 offset:14336
buffer_load_dwordx4 v41, s[8:11], s36 offen offset:1024  lds
v_mfma_f32_16x16x32_bf16 v[196:199], a[128:131], a[212:215], v[196:199]
v_accvgpr_write_b32 a52, 0
v_mfma_f32_16x16x32_bf16 v[72:75], a[132:135], a[192:195], v[72:75]
ds_read_b128 a[224:227], v25 offset:16384
v_accvgpr_write_b32 a53, 0
v_mfma_f32_16x16x32_bf16 v[76:79], a[132:135], a[196:199], v[76:79]
v_accvgpr_write_b32 a54, 0
v_mfma_f32_16x16x32_bf16 v[136:139], a[132:135], a[200:203], v[136:139]
ds_read_b128 a[228:231], v25 offset:18432
buffer_load_dwordx4 v42, s[8:11], s36 offen offset:2048  lds
v_mfma_f32_16x16x32_bf16 v[140:143], a[132:135], a[204:207], v[140:143]
ds_read_b128 a[232:235], v25 offset:20480
v_accvgpr_write_b32 a55, 0
v_mfma_f32_16x16x32_bf16 v[200:203], a[132:135], a[208:211], v[200:203]
v_accvgpr_write_b32 a56, 0
v_mfma_f32_16x16x32_bf16 v[204:207], a[132:135], a[212:215], v[204:207]
ds_read_b128 a[236:239], v25 offset:22528
v_mfma_f32_16x16x32_bf16 v[80:83], a[136:139], a[192:195], v[80:83]
buffer_load_dwordx4 v43, s[8:11], s36 offen offset:3072  lds
v_accvgpr_write_b32 a57, 0
v_mfma_f32_16x16x32_bf16 v[84:87], a[136:139], a[196:199], v[84:87]
ds_read_b64_tr_b16 a[164:165], v17 offset:24576
s_lshl_b32 s41, s29, 19
v_mfma_f32_16x16x32_bf16 v[144:147], a[136:139], a[200:203], v[144:147]
ds_read_b64_tr_b16 a[166:167], v17 offset:25600
s_add_u32 s41, s41, s32
s_add_u32 s29, s29, 1
v_mfma_f32_16x16x32_bf16 v[148:151], a[136:139], a[204:207], v[148:151]
s_cmp_eq_u32 s29, 9
s_cselect_b32 s29, 0, s29
v_mfma_f32_16x16x32_bf16 v[208:211], a[136:139], a[208:211], v[208:211]
ds_read_b64_tr_b16 a[168:169], v18 offset:24576
s_add_u32 m0, s38, 16384
s_xor_b32 s36, s41, 0
v_mfma_f32_16x16x32_bf16 v[212:215], a[136:139], a[212:215], v[212:215]
buffer_load_dwordx4 v40, s[8:11], s36 offen offset:0  lds
v_mfma_f32_16x16x32_bf16 v[88:91], a[140:143], a[192:195], v[88:91]
ds_read_b64_tr_b16 a[170:171], v18 offset:25600
v_accvgpr_write_b32 a58, 0
v_mfma_f32_16x16x32_bf16 v[92:95], a[140:143], a[196:199], v[92:95]
ds_read_b64_tr_b16 a[172:173], v19 offset:24576
v_mfma_f32_16x16x32_bf16 v[152:155], a[140:143], a[200:203], v[152:155]
buffer_load_dwordx4 v41, s[8:11], s36 offen offset:1024  lds
v_mfma_f32_16x16x32_bf16 v[156:159], a[140:143], a[204:207], v[156:159]
ds_read_b64_tr_b16 a[174:175], v19 offset:25600
v_accvgpr_write_b32 a59, 0
v_mfma_f32_16x16x32_bf16 v[216:219], a[140:143], a[208:211], v[216:219]
ds_read_b64_tr_b16 a[176:177], v20 offset:24576
v_mfma_f32_16x16x32_bf16 v[220:223], a[140:143], a[212:215], v[220:223]
v_accvgpr_write_b32 a60, 0
v_mfma_f32_16x16x32_bf16 v[96:99], a[144:147], a[192:195], v[96:99]
ds_read_b64_tr_b16 a[178:179], v20 offset:25600
buffer_load_dwordx4 v42, s[8:11], s36 offen offset:2048  lds
v_mfma_f32_16x16x32_bf16 v[100:103], a[144:147], a[196:199], v[100:103]
v_accvgpr_write_b32 a61, 0
v_mfma_f32_16x16x32_bf16 v[160:163], a[144:147], a[200:203], v[160:163]
ds_read_b64_tr_b16 a[180:181], v21 offset:24576
v_mfma_f32_16x16x32_bf16 v[164:167], a[144:147], a[204:207], v[164:167]
ds_read_b64_tr_b16 a[182:183], v21 offset:25600
v_accvgpr_write_b32 a62, 0
v_mfma_f32_16x16x32_bf16 v[224:227], a[144:147], a[208:211], v[224:227]
buffer_load_dwordx4 v43, s[8:11], s36 offen offset:3072  lds
v_mfma_f32_16x16x32_bf16 v[228:231], a[144:147], a[212:215], v[228:231]
ds_read_b64_tr_b16 a[184:185], v22 offset:24576
v_mfma_f32_16x16x32_bf16 v[104:107], a[148:151], a[192:195], v[104:107]
v_accvgpr_write_b32 a63, 0
v_mfma_f32_16x16x32_bf16 v[108:111], a[148:151], a[196:199], v[108:111]
ds_read_b64_tr_b16 a[186:187], v22 offset:25600
s_add_u32 m0, s38, 20480
s_xor_b32 s36, s41, 131072
v_mfma_f32_16x16x32_bf16 v[168:171], a[148:151], a[200:203], v[168:171]
ds_read_b64_tr_b16 a[188:189], v23 offset:24576
buffer_load_dwordx4 v40, s[8:11], s36 offen offset:0  lds
v_mfma_f32_16x16x32_bf16 v[172:175], a[148:151], a[204:207], v[172:175]
v_accvgpr_write_b32 a64, 0
v_mfma_f32_16x16x32_bf16 v[232:235], a[148:151], a[208:211], v[232:235]
ds_read_b64_tr_b16 a[190:191], v23 offset:25600
v_mfma_f32_16x16x32_bf16 v[236:239], a[148:151], a[212:215], v[236:239]
v_accvgpr_write_b32 a65, 0
v_mfma_f32_16x16x32_bf16 v[112:115], a[152:155], a[192:195], v[112:115]
buffer_load_dwordx4 v41, s[8:11], s36 offen offset:1024  lds
v_accvgpr_write_b32 a66, 0
v_mfma_f32_16x16x32_bf16 v[116:119], a[152:155], a[196:199], v[116:119]
v_accvgpr_write_b32 a67, 0
v_mfma_f32_16x16x32_bf16 v[176:179], a[152:155], a[200:203], v[176:179]
v_accvgpr_write_b32 a68, 0
v_mfma_f32_16x16x32_bf16 v[180:183], a[152:155], a[204:207], v[180:183]
v_accvgpr_write_b32 a69, 0
v_mfma_f32_16x16x32_bf16 v[240:243], a[152:155], a[208:211], v[240:243]
buffer_load_dwordx4 v42, s[8:11], s36 offen offset:2048  lds
v_mfma_f32_16x16x32_bf16 v[244:247], a[152:155], a[212:215], v[244:247]
v_accvgpr_write_b32 a70, 0
v_mfma_f32_16x16x32_bf16 v[120:123], a[156:159], a[192:195], v[120:123]
v_accvgpr_write_b32 a71, 0
v_mfma_f32_16x16x32_bf16 v[124:127], a[156:159], a[196:199], v[124:127]
v_accvgpr_write_b32 a72, 0
v_mfma_f32_16x16x32_bf16 v[184:187], a[156:159], a[200:203], v[184:187]
buffer_load_dwordx4 v43, s[8:11], s36 offen offset:3072  lds
v_mfma_f32_16x16x32_bf16 v[188:191], a[156:159], a[204:207], v[188:191]
v_accvgpr_write_b32 a73, 0
v_mfma_f32_16x16x32_bf16 v[248:251], a[156:159], a[208:211], v[248:251]
v_accvgpr_write_b32 a74, 0
v_mfma_f32_16x16x32_bf16 v[252:255], a[156:159], a[212:215], v[252:255]
v_accvgpr_write_b32 a75, 0
s_waitcnt vmcnt(16) lgkmcnt(0)
s_barrier
v_mfma_f32_16x16x32_bf16 v[64:67], a[160:163], a[216:219], v[64:67]
ds_read_b64_tr_b16 a[128:129], v16 offset:0
v_accvgpr_write_b32 a76, 0
v_mfma_f32_16x16x32_bf16 v[68:71], a[160:163], a[220:223], v[68:71]
ds_read_b64_tr_b16 a[130:131], v16 offset:1024
s_lshl_b32 s42, s43, 7
s_add_u32 s42, s42, s33
v_mfma_f32_16x16x32_bf16 v[128:131], a[160:163], a[224:227], v[128:131]
s_add_u32 s43, s43, 1
s_cmp_eq_u32 s43, 9
v_mfma_f32_16x16x32_bf16 v[132:135], a[160:163], a[228:231], v[132:135]
ds_read_b128 a[192:195], v24 offset:0
s_cselect_b32 s43, 0, s43
s_add_u32 m0, s39, 12288
v_mfma_f32_16x16x32_bf16 v[192:195], a[160:163], a[232:235], v[192:195]
ds_read_b128 a[196:199], v24 offset:2048
buffer_load_dwordx4 v44, s[4:7], s42 offen offset:0  lds
v_mfma_f32_16x16x32_bf16 v[196:199], a[160:163], a[236:239], v[196:199]
buffer_load_dwordx4 v45, s[4:7], s42 offen offset:1024  lds
v_mfma_f32_16x16x32_bf16 v[72:75], a[164:167], a[216:219], v[72:75]
ds_read_b128 a[200:203], v24 offset:4096
v_accvgpr_write_b32 a77, 0
v_mfma_f32_16x16x32_bf16 v[76:79], a[164:167], a[220:223], v[76:79]
v_accvgpr_write_b32 a78, 0
v_mfma_f32_16x16x32_bf16 v[136:139], a[164:167], a[224:227], v[136:139]
ds_read_b128 a[204:207], v24 offset:6144
v_mfma_f32_16x16x32_bf16 v[140:143], a[164:167], a[228:231], v[140:143]
ds_read_b128 a[208:211], v24 offset:8192
buffer_load_dwordx4 v46, s[4:7], s42 offen offset:2048  lds
v_mfma_f32_16x16x32_bf16 v[200:203], a[164:167], a[232:235], v[200:203]
v_accvgpr_write_b32 a79, 0
v_mfma_f32_16x16x32_bf16 v[204:207], a[164:167], a[236:239], v[204:207]
ds_read_b128 a[212:215], v24 offset:10240
v_mfma_f32_16x16x32_bf16 v[80:83], a[168:171], a[216:219], v[80:83]
s_add_u32 m0, s38, 24576
s_xor_b32 s36, s41, 262144
v_mfma_f32_16x16x32_bf16 v[84:87], a[168:171], a[220:223], v[84:87]
ds_read_b64_tr_b16 a[132:133], v17 offset:0
buffer_load_dwordx4 v40, s[8:11], s36 offen offset:0  lds
v_mfma_f32_16x16x32_bf16 v[144:147], a[168:171], a[224:227], v[144:147]
ds_read_b64_tr_b16 a[134:135], v17 offset:1024
v_mfma_f32_16x16x32_bf16 v[148:151], a[168:171], a[228:231], v[148:151]
v_accvgpr_write_b32 a80, 0
v_mfma_f32_16x16x32_bf16 v[208:211], a[168:171], a[232:235], v[208:211]
ds_read_b64_tr_b16 a[136:137], v18 offset:0
v_mfma_f32_16x16x32_bf16 v[212:215], a[168:171], a[236:239], v[212:215]
v_accvgpr_write_b32 a81, 0
v_mfma_f32_16x16x32_bf16 v[88:91], a[172:175], a[216:219], v[88:91]
ds_read_b64_tr_b16 a[138:139], v18 offset:1024
buffer_load_dwordx4 v41, s[8:11], s36 offen offset:1024  lds
v_mfma_f32_16x16x32_bf16 v[92:95], a[172:175], a[220:223], v[92:95]
ds_read_b64_tr_b16 a[140:141], v19 offset:0
v_mfma_f32_16x16x32_bf16 v[152:155], a[172:175], a[224:227], v[152:155]
v_accvgpr_write_b32 a82, 0
v_mfma_f32_16x16x32_bf16 v[156:159], a[172:175], a[228:231], v[156:159]
ds_read_b64_tr_b16 a[142:143], v19 offset:1024
v_accvgpr_write_b32 a83, 0
v_mfma_f32_16x16x32_bf16 v[216:219], a[172:175], a[232:235], v[216:219]
ds_read_b64_tr_b16 a[144:145], v20 offset:0
buffer_load_dwordx4 v42, s[8:11], s36 offen offset:2048  lds
v_mfma_f32_16x16x32_bf16 v[220:223], a[172:175], a[236:239], v[220:223]
v_accvgpr_write_b32 a84, 0
v_mfma_f32_16x16x32_bf16 v[96:99], a[176:179], a[216:219], v[96:99]
ds_read_b64_tr_b16 a[146:147], v20 offset:1024
v_accvgpr_write_b32 a85, 0
v_mfma_f32_16x16x32_bf16 v[100:103], a[176:179], a[220:223], v[100:103]
v_accvgpr_write_b32 a86, 0
v_mfma_f32_16x16x32_bf16 v[160:163], a[176:179], a[224:227], v[160:163]
ds_read_b64_tr_b16 a[148:149], v21 offset:0
buffer_load_dwordx4 v43, s[8:11], s36 offen offset:3072  lds
v_mfma_f32_16x16x32_bf16 v[164:167], a[176:179], a[228:231], v[164:167]
ds_read_b64_tr_b16 a[150:151], v21 offset:1024
v_accvgpr_write_b32 a87, 0
v_mfma_f32_16x16x32_bf16 v[224:227], a[176:179], a[232:235], v[224:227]
v_accvgpr_write_b32 a88, 0
v_mfma_f32_16x16x32_bf16 v[228:231], a[176:179], a[236:239], v[228:231]
ds_read_b64_tr_b16 a[152:153], v22 offset:0
s_add_u32 m0, s38, 28672
s_xor_b32 s36, s41, 393216
v_mfma_f32_16x16x32_bf16 v[104:107], a[180:183], a[216:219], v[104:107]
buffer_load_dwordx4 v40, s[8:11], s36 offen offset:0  lds
v_accvgpr_write_b32 a89, 0
v_mfma_f32_16x16x32_bf16 v[108:111], a[180:183], a[220:223], v[108:111]
ds_read_b64_tr_b16 a[154:155], v22 offset:1024
v_mfma_f32_16x16x32_bf16 v[168:171], a[180:183], a[224:227], v[168:171]
ds_read_b64_tr_b16 a[156:157], v23 offset:0
v_mfma_f32_16x16x32_bf16 v[172:175], a[180:183], a[228:231], v[172:175]
v_accvgpr_write_b32 a90, 0
v_mfma_f32_16x16x32_bf16 v[232:235], a[180:183], a[232:235], v[232:235]
ds_read_b64_tr_b16 a[158:159], v23 offset:1024
v_mfma_f32_16x16x32_bf16 v[236:239], a[180:183], a[236:239], v[236:239]
buffer_load_dwordx4 v41, s[8:11], s36 offen offset:1024  lds
v_mfma_f32_16x16x32_bf16 v[112:115], a[184:187], a[216:219], v[112:115]
v_accvgpr_write_b32 a91, 0
v_mfma_f32_16x16x32_bf16 v[116:119], a[184:187], a[220:223], v[116:119]
v_accvgpr_write_b32 a92, 0
v_mfma_f32_16x16x32_bf16 v[176:179], a[184:187], a[224:227], v[176:179]
v_accvgpr_write_b32 a93, 0
v_mfma_f32_16x16x32_bf16 v[180:183], a[184:187], a[228:231], v[180:183]
buffer_load_dwordx4 v42, s[8:11], s36 offen offset:2048  lds
v_accvgpr_write_b32 a94, 0
v_mfma_f32_16x16x32_bf16 v[240:243], a[184:187], a[232:235], v[240:243]
v_accvgpr_write_b32 a95, 0
v_mfma_f32_16x16x32_bf16 v[244:247], a[184:187], a[236:239], v[244:247]
v_accvgpr_write_b32 a96, 0
v_mfma_f32_16x16x32_bf16 v[120:123], a[188:191], a[216:219], v[120:123]
v_accvgpr_write_b32 a97, 0
v_mfma_f32_16x16x32_bf16 v[124:127], a[188:191], a[220:223], v[124:127]
buffer_load_dwordx4 v43, s[8:11], s36 offen offset:3072  lds
v_mfma_f32_16x16x32_bf16 v[184:187], a[188:191], a[224:227], v[184:187]
v_accvgpr_write_b32 a98, 0
v_mfma_f32_16x16x32_bf16 v[188:191], a[188:191], a[228:231], v[188:191]
v_accvgpr_write_b32 a99, 0
v_mfma_f32_16x16x32_bf16 v[248:251], a[188:191], a[232:235], v[248:251]
v_accvgpr_write_b32 a100, 0
v_mfma_f32_16x16x32_bf16 v[252:255], a[188:191], a[236:239], v[252:255]
v_accvgpr_write_b32 a101, 0
s_waitcnt vmcnt(19) lgkmcnt(0)
v_mfma_f32_16x16x32_bf16 v[64:67], a[128:131], a[192:195], v[64:67]
ds_read_b64_tr_b16 a[160:161], v16 offset:8192
v_accvgpr_write_b32 a102, 0
v_mfma_f32_16x16x32_bf16 v[68:71], a[128:131], a[196:199], v[68:71]
ds_read_b64_tr_b16 a[162:163], v16 offset:9216
s_lshl_b32 s41, s29, 19
v_mfma_f32_16x16x32_bf16 v[128:131], a[128:131], a[200:203], v[128:131]
s_add_u32 s41, s41, s32
s_add_u32 s29, s29, 1
v_mfma_f32_16x16x32_bf16 v[132:135], a[128:131], a[204:207], v[132:135]
ds_read_b128 a[216:219], v25 offset:0
s_cmp_eq_u32 s29, 9
s_cselect_b32 s29, 0, s29
v_mfma_f32_16x16x32_bf16 v[192:195], a[128:131], a[208:211], v[192:195]
ds_read_b128 a[220:223], v25 offset:2048
s_add_u32 m0, s38, 0
s_xor_b32 s36, s41, 0
v_mfma_f32_16x16x32_bf16 v[196:199], a[128:131], a[212:215], v[196:199]
buffer_load_dwordx4 v40, s[8:11], s36 offen offset:0  lds
v_mfma_f32_16x16x32_bf16 v[72:75], a[132:135], a[192:195], v[72:75]
ds_read_b128 a[224:227], v25 offset:4096
buffer_load_dwordx4 v41, s[8:11], s36 offen offset:1024  lds
v_mfma_f32_16x16x32_bf16 v[76:79], a[132:135], a[196:199], v[76:79]
v_accvgpr_write_b32 a103, 0
v_mfma_f32_16x16x32_bf16 v[136:139], a[132:135], a[200:203], v[136:139]
ds_read_b128 a[228:231], v25 offset:6144
v_mfma_f32_16x16x32_bf16 v[140:143], a[132:135], a[204:207], v[140:143]
ds_read_b128 a[232:235], v25 offset:8192
v_accvgpr_write_b32 a104, 0
v_mfma_f32_16x16x32_bf16 v[200:203], a[132:135], a[208:211], v[200:203]
v_accvgpr_write_b32 a105, 0
v_mfma_f32_16x16x32_bf16 v[204:207], a[132:135], a[212:215], v[204:207]
ds_read_b128 a[236:239], v25 offset:10240
v_mfma_f32_16x16x32_bf16 v[80:83], a[136:139], a[192:195], v[80:83]
buffer_load_dwordx4 v42, s[8:11], s36 offen offset:2048  lds
v_accvgpr_write_b32 a106, 0
v_mfma_f32_16x16x32_bf16 v[84:87], a[136:139], a[196:199], v[84:87]
ds_read_b64_tr_b16 a[164:165], v17 offset:8192
v_mfma_f32_16x16x32_bf16 v[144:147], a[136:139], a[200:203], v[144:147]
ds_read_b64_tr_b16 a[166:167], v17 offset:9216
v_mfma_f32_16x16x32_bf16 v[148:151], a[136:139], a[204:207], v[148:151]
v_accvgpr_write_b32 a107, 0
v_mfma_f32_16x16x32_bf16 v[208:211], a[136:139], a[208:211], v[208:211]
ds_read_b64_tr_b16 a[168:169], v18 offset:8192
v_mfma_f32_16x16x32_bf16 v[212:215], a[136:139], a[212:215], v[212:215]
v_accvgpr_write_b32 a108, 0
v_mfma_f32_16x16x32_bf16 v[88:91], a[140:143], a[192:195], v[88:91]
ds_read_b64_tr_b16 a[170:171], v18 offset:9216
buffer_load_dwordx4 v43, s[8:11], s36 offen offset:3072  lds
v_mfma_f32_16x16x32_bf16 v[92:95], a[140:143], a[196:199], v[92:95]
ds_read_b64_tr_b16 a[172:173], v19 offset:8192
v_mfma_f32_16x16x32_bf16 v[152:155], a[140:143], a[200:203], v[152:155]
v_accvgpr_write_b32 a109, 0
v_mfma_f32_16x16x32_bf16 v[156:159], a[140:143], a[204:207], v[156:159]
ds_read_b64_tr_b16 a[174:175], v19 offset:9216
v_accvgpr_write_b32 a110, 0
v_mfma_f32_16x16x32_bf16 v[216:219], a[140:143], a[208:211], v[216:219]
ds_read_b64_tr_b16 a[176:177], v20 offset:8192
v_mfma_f32_16x16x32_bf16 v[220:223], a[140:143], a[212:215], v[220:223]
s_add_u32 m0, s38, 4096
s_xor_b32 s36, s41, 131072
v_mfma_f32_16x16x32_bf16 v[96:99], a[144:147], a[192:195], v[96:99]
ds_read_b64_tr_b16 a[178:179], v20 offset:9216
buffer_load_dwordx4 v40, s[8:11], s36 offen offset:0  lds
v_mfma_f32_16x16x32_bf16 v[100:103], a[144:147], a[196:199], v[100:103]
v_accvgpr_write_b32 a111, 0
v_mfma_f32_16x16x32_bf16 v[160:163], a[144:147], a[200:203], v[160:163]
ds_read_b64_tr_b16 a[180:181], v21 offset:8192
v_mfma_f32_16x16x32_bf16 v[164:167], a[144:147], a[204:207], v[164:167]
ds_read_b64_tr_b16 a[182:183], v21 offset:9216
v_accvgpr_write_b32 a112, 0
v_mfma_f32_16x16x32_bf16 v[224:227], a[144:147], a[208:211], v[224:227]
v_accvgpr_write_b32 a113, 0
v_mfma_f32_16x16x32_bf16 v[228:231], a[144:147], a[212:215], v[228:231]
ds_read_b64_tr_b16 a[184:185], v22 offset:8192
v_mfma_f32_16x16x32_bf16 v[104:107], a[148:151], a[192:195], v[104:107]
buffer_load_dwordx4 v41, s[8:11], s36 offen offset:1024  lds
v_accvgpr_write_b32 a114, 0
v_mfma_f32_16x16x32_bf16 v[108:111], a[148:151], a[196:199], v[108:111]
ds_read_b64_tr_b16 a[186:187], v22 offset:9216
v_mfma_f32_16x16x32_bf16 v[168:171], a[148:151], a[200:203], v[168:171]
ds_read_b64_tr_b16 a[188:189], v23 offset:8192
v_mfma_f32_16x16x32_bf16 v[172:175], a[148:151], a[204:207], v[172:175]
v_accvgpr_write_b32 a115, 0
v_mfma_f32_16x16x32_bf16 v[232:235], a[148:151], a[208:211], v[232:235]
ds_read_b64_tr_b16 a[190:191], v23 offset:9216
v_mfma_f32_16x16x32_bf16 v[236:239], a[148:151], a[212:215], v[236:239]
v_accvgpr_write_b32 a116, 0
v_mfma_f32_16x16x32_bf16 v[112:115], a[152:155], a[192:195], v[112:115]
buffer_load_dwordx4 v42, s[8:11], s36 offen offset:2048  lds
v_accvgpr_write_b32 a117, 0
v_mfma_f32_16x16x32_bf16 v[116:119], a[152:155], a[196:199], v[116:119]
v_accvgpr_write_b32 a118, 0
v_mfma_f32_16x16x32_bf16 v[176:179], a[152:155], a[200:203], v[176:179]
v_accvgpr_write_b32 a119, 0
v_mfma_f32_16x16x32_bf16 v[180:183], a[152:155], a[204:207], v[180:183]
v_accvgpr_write_b32 a120, 0
v_mfma_f32_16x16x32_bf16 v[240:243], a[152:155], a[208:211], v[240:243]
v_accvgpr_write_b32 a121, 0
v_mfma_f32_16x16x32_bf16 v[244:247], a[152:155], a[212:215], v[244:247]
v_accvgpr_write_b32 a122, 0
v_mfma_f32_16x16x32_bf16 v[120:123], a[156:159], a[192:195], v[120:123]
buffer_load_dwordx4 v43, s[8:11], s36 offen offset:3072  lds
v_accvgpr_write_b32 a123, 0
v_mfma_f32_16x16x32_bf16 v[124:127], a[156:159], a[196:199], v[124:127]
v_accvgpr_write_b32 a124, 0
v_mfma_f32_16x16x32_bf16 v[184:187], a[156:159], a[200:203], v[184:187]
v_accvgpr_write_b32 a125, 0
v_mfma_f32_16x16x32_bf16 v[188:191], a[156:159], a[204:207], v[188:191]
v_accvgpr_write_b32 a126, 0
v_mfma_f32_16x16x32_bf16 v[248:251], a[156:159], a[208:211], v[248:251]
v_accvgpr_write_b32 a127, 0
v_mfma_f32_16x16x32_bf16 v[252:255], a[156:159], a[212:215], v[252:255]
s_waitcnt vmcnt(16) lgkmcnt(0)
s_barrier
v_mfma_f32_16x16x32_bf16 v[64:67], a[160:163], a[216:219], v[64:67]
ds_read_b64_tr_b16 a[128:129], v16 offset:16384
v_mfma_f32_16x16x32_bf16 v[68:71], a[160:163], a[220:223], v[68:71]
ds_read_b64_tr_b16 a[130:131], v16 offset:17408
s_lshl_b32 s42, s43, 7
s_add_u32 s42, s42, s33
v_mfma_f32_16x16x32_bf16 v[128:131], a[160:163], a[224:227], v[128:131]
s_add_u32 s43, s43, 1
s_cmp_eq_u32 s43, 9
v_mfma_f32_16x16x32_bf16 v[132:135], a[160:163], a[228:231], v[132:135]
ds_read_b128 a[192:195], v24 offset:12288
s_cselect_b32 s43, 0, s43
s_add_u32 m0, s39, 0
v_mfma_f32_16x16x32_bf16 v[192:195], a[160:163], a[232:235], v[192:195]
ds_read_b128 a[196:199], v24 offset:14336
buffer_load_dwordx4 v44, s[4:7], s42 offen offset:0  lds
v_mfma_f32_16x16x32_bf16 v[196:199], a[160:163], a[236:239], v[196:199]
buffer_load_dwordx4 v45, s[4:7], s42 offen offset:1024  lds
v_mfma_f32_16x16x32_bf16 v[72:75], a[164:167], a[216:219], v[72:75]
ds_read_b128 a[200:203], v24 offset:16384
v_mfma_f32_16x16x32_bf16 v[76:79], a[164:167], a[220:223], v[76:79]
v_mfma_f32_16x16x32_bf16 v[136:139], a[164:167], a[224:227], v[136:139]
ds_read_b128 a[204:207], v24 offset:18432
v_mfma_f32_16x16x32_bf16 v[140:143], a[164:167], a[228:231], v[140:143]
ds_read_b128 a[208:211], v24 offset:20480
buffer_load_dwordx4 v46, s[4:7], s42 offen offset:2048  lds
v_mfma_f32_16x16x32_bf16 v[200:203], a[164:167], a[232:235], v[200:203]
v_mfma_f32_16x16x32_bf16 v[204:207], a[164:167], a[236:239], v[204:207]
ds_read_b128 a[212:215], v24 offset:22528
v_mfma_f32_16x16x32_bf16 v[80:83], a[168:171], a[216:219], v[80:83]
s_add_u32 m0, s38, 8192
s_xor_b32 s36, s41, 262144
v_mfma_f32_16x16x32_bf16 v[84:87], a[168:171], a[220:223], v[84:87]
ds_read_b64_tr_b16 a[132:133], v17 offset:16384
buffer_load_dwordx4 v40, s[8:11], s36 offen offset:0  lds
v_mfma_f32_16x16x32_bf16 v[144:147], a[168:171], a[224:227], v[144:147]
ds_read_b64_tr_b16 a[134:135], v17 offset:17408
v_mfma_f32_16x16x32_bf16 v[148:151], a[168:171], a[228:231], v[148:151]
v_mfma_f32_16x16x32_bf16 v[208:211], a[168:171], a[232:235], v[208:211]
ds_read_b64_tr_b16 a[136:137], v18 offset:16384
v_mfma_f32_16x16x32_bf16 v[212:215], a[168:171], a[236:239], v[212:215]
v_mfma_f32_16x16x32_bf16 v[88:91], a[172:175], a[216:219], v[88:91]
ds_read_b64_tr_b16 a[138:139], v18 offset:17408
buffer_load_dwordx4 v41, s[8:11], s36 offen offset:1024  lds
v_mfma_f32_16x16x32_bf16 v[92:95], a[172:175], a[220:223], v[92:95]
ds_read_b64_tr_b16 a[140:141], v19 offset:16384
v_mfma_f32_16x16x32_bf16 v[152:155], a[172:175], a[224:227], v[152:155]
v_mfma_f32_16x16x32_bf16 v[156:159], a[172:175], a[228:231], v[156:159]
ds_read_b64_tr_b16 a[142:143], v19 offset:17408
v_mfma_f32_16x16x32_bf16 v[216:219], a[172:175], a[232:235], v[216:219]
ds_read_b64_tr_b16 a[144:145], v20 offset:16384
buffer_load_dwordx4 v42, s[8:11], s36 offen offset:2048  lds
v_mfma_f32_16x16x32_bf16 v[220:223], a[172:175], a[236:239], v[220:223]
v_mfma_f32_16x16x32_bf16 v[96:99], a[176:179], a[216:219], v[96:99]
ds_read_b64_tr_b16 a[146:147], v20 offset:17408
v_mfma_f32_16x16x32_bf16 v[100:103], a[176:179], a[220:223], v[100:103]
v_mfma_f32_16x16x32_bf16 v[160:163], a[176:179], a[224:227], v[160:163]
ds_read_b64_tr_b16 a[148:149], v21 offset:16384
buffer_load_dwordx4 v43, s[8:11], s36 offen offset:3072  lds
v_mfma_f32_16x16x32_bf16 v[164:167], a[176:179], a[228:231], v[164:167]
ds_read_b64_tr_b16 a[150:151], v21 offset:17408
v_mfma_f32_16x16x32_bf16 v[224:227], a[176:179], a[232:235], v[224:227]
v_mfma_f32_16x16x32_bf16 v[228:231], a[176:179], a[236:239], v[228:231]
ds_read_b64_tr_b16 a[152:153], v22 offset:16384
s_add_u32 m0, s38, 12288
s_xor_b32 s36, s41, 393216
v_mfma_f32_16x16x32_bf16 v[104:107], a[180:183], a[216:219], v[104:107]
buffer_load_dwordx4 v40, s[8:11], s36 offen offset:0  lds
v_mfma_f32_16x16x32_bf16 v[108:111], a[180:183], a[220:223], v[108:111]
ds_read_b64_tr_b16 a[154:155], v22 offset:17408
v_mfma_f32_16x16x32_bf16 v[168:171], a[180:183], a[224:227], v[168:171]
ds_read_b64_tr_b16 a[156:157], v23 offset:16384
v_mfma_f32_16x16x32_bf16 v[172:175], a[180:183], a[228:231], v[172:175]
v_mfma_f32_16x16x32_bf16 v[232:235], a[180:183], a[232:235], v[232:235]
ds_read_b64_tr_b16 a[158:159], v23 offset:17408
v_mfma_f32_16x16x32_bf16 v[236:239], a[180:183], a[236:239], v[236:239]
buffer_load_dwordx4 v41, s[8:11], s36 offen offset:1024  lds
v_mfma_f32_16x16x32_bf16 v[112:115], a[184:187], a[216:219], v[112:115]
v_mfma_f32_16x16x32_bf16 v[116:119], a[184:187], a[220:223], v[116:119]
v_mfma_f32_16x16x32_bf16 v[176:179], a[184:187], a[224:227], v[176:179]
v_mfma_f32_16x16x32_bf16 v[180:183], a[184:187], a[228:231], v[180:183]
buffer_load_dwordx4 v42, s[8:11], s36 offen offset:2048  lds
v_mfma_f32_16x16x32_bf16 v[240:243], a[184:187], a[232:235], v[240:243]
v_mfma_f32_16x16x32_bf16 v[244:247], a[184:187], a[236:239], v[244:247]
v_mfma_f32_16x16x32_bf16 v[120:123], a[188:191], a[216:219], v[120:123]
v_mfma_f32_16x16x32_bf16 v[124:127], a[188:191], a[220:223], v[124:127]
buffer_load_dwordx4 v43, s[8:11], s36 offen offset:3072  lds
v_mfma_f32_16x16x32_bf16 v[184:187], a[188:191], a[224:227], v[184:187]
v_mfma_f32_16x16x32_bf16 v[188:191], a[188:191], a[228:231], v[188:191]
v_mfma_f32_16x16x32_bf16 v[248:251], a[188:191], a[232:235], v[248:251]
v_mfma_f32_16x16x32_bf16 v[252:255], a[188:191], a[236:239], v[252:255]
s_waitcnt vmcnt(19) lgkmcnt(0)
v_mfma_f32_16x16x32_bf16 v[64:67], a[128:131], a[192:195], v[64:67]
ds_read_b64_tr_b16 a[160:161], v16 offset:24576
v_mfma_f32_16x16x32_bf16 v[68:71], a[128:131], a[196:199], v[68:71]
ds_read_b64_tr_b16 a[162:163], v16 offset:25600
s_lshl_b32 s41, s29, 19
v_mfma_f32_16x16x32_bf16 v[128:131], a[128:131], a[200:203], v[128:131]
s_add_u32 s41, s41, s32
s_add_u32 s29, s29, 1
v_mfma_f32_16x16x32_bf16 v[132:135], a[128:131], a[204:207], v[132:135]
ds_read_b128 a[216:219], v25 offset:12288
s_cmp_eq_u32 s29, 9
s_cselect_b32 s29, 0, s29
v_mfma_f32_16x16x32_bf16 v[192:195], a[128:131], a[208:211], v[192:195]
ds_read_b128 a[220:223], v25 offset:14336
s_add_u32 m0, s38, 16384
s_xor_b32 s36, s41, 0
v_mfma_f32_16x16x32_bf16 v[196:199], a[128:131], a[212:215], v[196:199]
buffer_load_dwordx4 v40, s[8:11], s36 offen offset:0  lds
v_mfma_f32_16x16x32_bf16 v[72:75], a[132:135], a[192:195], v[72:75]
ds_read_b128 a[224:227], v25 offset:16384
buffer_load_dwordx4 v41, s[8:11], s36 offen offset:1024  lds
v_mfma_f32_16x16x32_bf16 v[76:79], a[132:135], a[196:199], v[76:79]
v_mfma_f32_16x16x32_bf16 v[136:139], a[132:135], a[200:203], v[136:139]
ds_read_b128 a[228:231], v25 offset:18432
v_mfma_f32_16x16x32_bf16 v[140:143], a[132:135], a[204:207], v[140:143]
ds_read_b128 a[232:235], v25 offset:20480
v_mfma_f32_16x16x32_bf16 v[200:203], a[132:135], a[208:211], v[200:203]
v_mfma_f32_16x16x32_bf16 v[204:207], a[132:135], a[212:215], v[204:207]
ds_read_b128 a[236:239], v25 offset:22528
v_mfma_f32_16x16x32_bf16 v[80:83], a[136:139], a[192:195], v[80:83]
buffer_load_dwordx4 v42, s[8:11], s36 offen offset:2048  lds
v_mfma_f32_16x16x32_bf16 v[84:87], a[136:139], a[196:199], v[84:87]
ds_read_b64_tr_b16 a[164:165], v17 offset:24576
v_mfma_f32_16x16x32_bf16 v[144:147], a[136:139], a[200:203], v[144:147]
ds_read_b64_tr_b16 a[166:167], v17 offset:25600
v_mfma_f32_16x16x32_bf16 v[148:151], a[136:139], a[204:207], v[148:151]
v_mfma_f32_16x16x32_bf16 v[208:211], a[136:139], a[208:211], v[208:211]
ds_read_b64_tr_b16 a[168:169], v18 offset:24576
v_mfma_f32_16x16x32_bf16 v[212:215], a[136:139], a[212:215], v[212:215]
v_mfma_f32_16x16x32_bf16 v[88:91], a[140:143], a[192:195], v[88:91]
ds_read_b64_tr_b16 a[170:171], v18 offset:25600
buffer_load_dwordx4 v43, s[8:11], s36 offen offset:3072  lds
v_mfma_f32_16x16x32_bf16 v[92:95], a[140:143], a[196:199], v[92:95]
ds_read_b64_tr_b16 a[172:173], v19 offset:24576
v_mfma_f32_16x16x32_bf16 v[152:155], a[140:143], a[200:203], v[152:155]
v_mfma_f32_16x16x32_bf16 v[156:159], a[140:143], a[204:207], v[156:159]
ds_read_b64_tr_b16 a[174:175], v19 offset:25600
v_mfma_f32_16x16x32_bf16 v[216:219], a[140:143], a[208:211], v[216:219]
ds_read_b64_tr_b16 a[176:177], v20 offset:24576
v_mfma_f32_16x16x32_bf16 v[220:223], a[140:143], a[212:215], v[220:223]
s_add_u32 m0, s38, 20480
s_xor_b32 s36, s41, 131072
v_mfma_f32_16x16x32_bf16 v[96:99], a[144:147], a[192:195], v[96:99]
ds_read_b64_tr_b16 a[178:179], v20 offset:25600
buffer_load_dwordx4 v40, s[8:11], s36 offen offset:0  lds
v_mfma_f32_16x16x32_bf16 v[100:103], a[144:147], a[196:199], v[100:103]
v_mfma_f32_16x16x32_bf16 v[160:163], a[144:147], a[200:203], v[160:163]
ds_read_b64_tr_b16 a[180:181], v21 offset:24576
v_mfma_f32_16x16x32_bf16 v[164:167], a[144:147], a[204:207], v[164:167]
ds_read_b64_tr_b16 a[182:183], v21 offset:25600
v_mfma_f32_16x16x32_bf16 v[224:227], a[144:147], a[208:211], v[224:227]
v_mfma_f32_16x16x32_bf16 v[228:231], a[144:147], a[212:215], v[228:231]
ds_read_b64_tr_b16 a[184:185], v22 offset:24576
v_mfma_f32_16x16x32_bf16 v[104:107], a[148:151], a[192:195], v[104:107]
buffer_load_dwordx4 v41, s[8:11], s36 offen offset:1024  lds
v_mfma_f32_16x16x32_bf16 v[108:111], a[148:151], a[196:199], v[108:111]
ds_read_b64_tr_b16 a[186:187], v22 offset:25600
v_mfma_f32_16x16x32_bf16 v[168:171], a[148:151], a[200:203], v[168:171]
ds_read_b64_tr_b16 a[188:189], v23 offset:24576
v_mfma_f32_16x16x32_bf16 v[172:175], a[148:151], a[204:207], v[172:175]
v_mfma_f32_16x16x32_bf16 v[232:235], a[148:151], a[208:211], v[232:235]
ds_read_b64_tr_b16 a[190:191], v23 offset:25600
v_mfma_f32_16x16x32_bf16 v[236:239], a[148:151], a[212:215], v[236:239]
v_mfma_f32_16x16x32_bf16 v[112:115], a[152:155], a[192:195], v[112:115]
buffer_load_dwordx4 v42, s[8:11], s36 offen offset:2048  lds
v_mfma_f32_16x16x32_bf16 v[116:119], a[152:155], a[196:199], v[116:119]
v_mfma_f32_16x16x32_bf16 v[176:179], a[152:155], a[200:203], v[176:179]
v_mfma_f32_16x16x32_bf16 v[180:183], a[152:155], a[204:207], v[180:183]
v_mfma_f32_16x16x32_bf16 v[240:243], a[152:155], a[208:211], v[240:243]
v_mfma_f32_16x16x32_bf16 v[244:247], a[152:155], a[212:215], v[244:247]
v_mfma_f32_16x16x32_bf16 v[120:123], a[156:159], a[192:195], v[120:123]
buffer_load_dwordx4 v43, s[8:11], s36 offen offset:3072  lds
v_mfma_f32_16x16x32_bf16 v[124:127], a[156:159], a[196:199], v[124:127]
v_mfma_f32_16x16x32_bf16 v[184:187], a[156:159], a[200:203], v[184:187]
v_mfma_f32_16x16x32_bf16 v[188:191], a[156:159], a[204:207], v[188:191]
v_mfma_f32_16x16x32_bf16 v[248:251], a[156:159], a[208:211], v[248:251]
v_mfma_f32_16x16x32_bf16 v[252:255], a[156:159], a[212:215], v[252:255]
s_waitcnt vmcnt(16) lgkmcnt(0)
s_barrier
v_mfma_f32_16x16x32_bf16 v[64:67], a[160:163], a[216:219], v[64:67]
ds_read_b64_tr_b16 a[128:129], v16 offset:0
v_mfma_f32_16x16x32_bf16 v[68:71], a[160:163], a[220:223], v[68:71]
ds_read_b64_tr_b16 a[130:131], v16 offset:1024
s_lshl_b32 s42, s43, 7
s_add_u32 s42, s42, s33
v_mfma_f32_16x16x32_bf16 v[128:131], a[160:163], a[224:227], v[128:131]
s_add_u32 s43, s43, 1
s_cmp_eq_u32 s43, 9
v_mfma_f32_16x16x32_bf16 v[132:135], a[160:163], a[228:231], v[132:135]
ds_read_b128 a[192:195], v24 offset:0
s_cselect_b32 s43, 0, s43
s_add_u32 m0, s39, 12288
v_mfma_f32_16x16x32_bf16 v[192:195], a[160:163], a[232:235], v[192:195]
ds_read_b128 a[196:199], v24 offset:2048
buffer_load_dwordx4 v44, s[4:7], s42 offen offset:0  lds
v_mfma_f32_16x16x32_bf16 v[196:199], a[160:163], a[236:239], v[196:199]
buffer_load_dwordx4 v45, s[4:7], s42 offen offset:1024  lds
v_mfma_f32_16x16x32_bf16 v[72:75], a[164:167], a[216:219], v[72:75]
ds_read_b128 a[200:203], v24 offset:4096
v_mfma_f32_16x16x32_bf16 v[76:79], a[164:167], a[220:223], v[76:79]
v_mfma_f32_16x16x32_bf16 v[136:139], a[164:167], a[224:227], v[136:139]
ds_read_b128 a[204:207], v24 offset:6144
v_mfma_f32_16x16x32_bf16 v[140:143], a[164:167], a[228:231], v[140:143]
ds_read_b128 a[208:211], v24 offset:8192
buffer_load_dwordx4 v46, s[4:7], s42 offen offset:2048  lds
v_mfma_f32_16x16x32_bf16 v[200:203], a[164:167], a[232:235], v[200:203]
v_mfma_f32_16x16x32_bf16 v[204:207], a[164:167], a[236:239], v[204:207]
ds_read_b128 a[212:215], v24 offset:10240
v_mfma_f32_16x16x32_bf16 v[80:83], a[168:171], a[216:219], v[80:83]
s_add_u32 m0, s38, 24576
s_xor_b32 s36, s41, 262144
v_mfma_f32_16x16x32_bf16 v[84:87], a[168:171], a[220:223], v[84:87]
ds_read_b64_tr_b16 a[132:133], v17 offset:0
buffer_load_dwordx4 v40, s[8:11], s36 offen offset:0  lds
v_mfma_f32_16x16x32_bf16 v[144:147], a[168:171], a[224:227], v[144:147]
ds_read_b64_tr_b16 a[134:135], v17 offset:1024
v_mfma_f32_16x16x32_bf16 v[148:151], a[168:171], a[228:231], v[148:151]
v_mfma_f32_16x16x32_bf16 v[208:211], a[168:171], a[232:235], v[208:211]
ds_read_b64_tr_b16 a[136:137], v18 offset:0
v_mfma_f32_16x16x32_bf16 v[212:215], a[168:171], a[236:239], v[212:215]
v_mfma_f32_16x16x32_bf16 v[88:91], a[172:175], a[216:219], v[88:91]
ds_read_b64_tr_b16 a[138:139], v18 offset:1024
buffer_load_dwordx4 v41, s[8:11], s36 offen offset:1024  lds
v_mfma_f32_16x16x32_bf16 v[92:95], a[172:175], a[220:223], v[92:95]
ds_read_b64_tr_b16 a[140:141], v19 offset:0
v_mfma_f32_16x16x32_bf16 v[152:155], a[172:175], a[224:227], v[152:155]
v_mfma_f32_16x16x32_bf16 v[156:159], a[172:175], a[228:231], v[156:159]
ds_read_b64_tr_b16 a[142:143], v19 offset:1024
v_mfma_f32_16x16x32_bf16 v[216:219], a[172:175], a[232:235], v[216:219]
ds_read_b64_tr_b16 a[144:145], v20 offset:0
buffer_load_dwordx4 v42, s[8:11], s36 offen offset:2048  lds
v_mfma_f32_16x16x32_bf16 v[220:223], a[172:175], a[236:239], v[220:223]
v_mfma_f32_16x16x32_bf16 v[96:99], a[176:179], a[216:219], v[96:99]
ds_read_b64_tr_b16 a[146:147], v20 offset:1024
v_mfma_f32_16x16x32_bf16 v[100:103], a[176:179], a[220:223], v[100:103]
v_mfma_f32_16x16x32_bf16 v[160:163], a[176:179], a[224:227], v[160:163]
ds_read_b64_tr_b16 a[148:149], v21 offset:0
buffer_load_dwordx4 v43, s[8:11], s36 offen offset:3072  lds
v_mfma_f32_16x16x32_bf16 v[164:167], a[176:179], a[228:231], v[164:167]
ds_read_b64_tr_b16 a[150:151], v21 offset:1024
v_mfma_f32_16x16x32_bf16 v[224:227], a[176:179], a[232:235], v[224:227]
v_mfma_f32_16x16x32_bf16 v[228:231], a[176:179], a[236:239], v[228:231]
ds_read_b64_tr_b16 a[152:153], v22 offset:0
s_add_u32 m0, s38, 28672
s_xor_b32 s36, s41, 393216
v_mfma_f32_16x16x32_bf16 v[104:107], a[180:183], a[216:219], v[104:107]
buffer_load_dwordx4 v40, s[8:11], s36 offen offset:0  lds
v_mfma_f32_16x16x32_bf16 v[108:111], a[180:183], a[220:223], v[108:111]
ds_read_b64_tr_b16 a[154:155], v22 offset:1024
v_mfma_f32_16x16x32_bf16 v[168:171], a[180:183], a[224:227], v[168:171]
ds_read_b64_tr_b16 a[156:157], v23 offset:0
v_mfma_f32_16x16x32_bf16 v[172:175], a[180:183], a[228:231], v[172:175]
v_mfma_f32_16x16x32_bf16 v[232:235], a[180:183], a[232:235], v[232:235]
ds_read_b64_tr_b16 a[158:159], v23 offset:1024
v_mfma_f32_16x16x32_bf16 v[236:239], a[180:183], a[236:239], v[236:239]
buffer_load_dwordx4 v41, s[8:11], s36 offen offset:1024  lds
v_mfma_f32_16x16x32_bf16 v[112:115], a[184:187], a[216:219], v[112:115]
v_mfma_f32_16x16x32_bf16 v[116:119], a[184:187], a[220:223], v[116:119]
v_mfma_f32_16x16x32_bf16 v[176:179], a[184:187], a[224:227], v[176:179]
v_mfma_f32_16x16x32_bf16 v[180:183], a[184:187], a[228:231], v[180:183]
buffer_load_dwordx4 v42, s[8:11], s36 offen offset:2048  lds
v_mfma_f32_16x16x32_bf16 v[240:243], a[184:187], a[232:235], v[240:243]
v_mfma_f32_16x16x32_bf16 v[244:247], a[184:187], a[236:239], v[244:247]
v_mfma_f32_16x16x32_bf16 v[120:123], a[188:191], a[216:219], v[120:123]
v_mfma_f32_16x16x32_bf16 v[124:127], a[188:191], a[220:223], v[124:127]
buffer_load_dwordx4 v43, s[8:11], s36 offen offset:3072  lds
v_mfma_f32_16x16x32_bf16 v[184:187], a[188:191], a[224:227], v[184:187]
v_mfma_f32_16x16x32_bf16 v[188:191], a[188:191], a[228:231], v[188:191]
v_mfma_f32_16x16x32_bf16 v[248:251], a[188:191], a[232:235], v[248:251]
v_mfma_f32_16x16x32_bf16 v[252:255], a[188:191], a[236:239], v[252:255]
s_waitcnt vmcnt(19) lgkmcnt(0)
v_mfma_f32_16x16x32_bf16 v[64:67], a[128:131], a[192:195], v[64:67]
ds_read_b64_tr_b16 a[160:161], v16 offset:8192
v_mfma_f32_16x16x32_bf16 v[68:71], a[128:131], a[196:199], v[68:71]
ds_read_b64_tr_b16 a[162:163], v16 offset:9216
s_lshl_b32 s41, s29, 19
v_mfma_f32_16x16x32_bf16 v[128:131], a[128:131], a[200:203], v[128:131]
s_add_u32 s41, s41, s32
s_add_u32 s29, s29, 1
v_mfma_f32_16x16x32_bf16 v[132:135], a[128:131], a[204:207], v[132:135]
ds_read_b128 a[216:219], v25 offset:0
s_cmp_eq_u32 s29, 9
s_cselect_b32 s29, 0, s29
v_mfma_f32_16x16x32_bf16 v[192:195], a[128:131], a[208:211], v[192:195]
ds_read_b128 a[220:223], v25 offset:2048
s_add_u32 m0, s38, 0
s_xor_b32 s36, s41, 0
v_mfma_f32_16x16x32_bf16 v[196:199], a[128:131], a[212:215], v[196:199]
buffer_load_dwordx4 v40, s[8:11], s36 offen offset:0  lds
v_mfma_f32_16x16x32_bf16 v[72:75], a[132:135], a[192:195], v[72:75]
ds_read_b128 a[224:227], v25 offset:4096
buffer_load_dwordx4 v41, s[8:11], s36 offen offset:1024  lds
v_mfma_f32_16x16x32_bf16 v[76:79], a[132:135], a[196:199], v[76:79]
v_mfma_f32_16x16x32_bf16 v[136:139], a[132:135], a[200:203], v[136:139]
ds_read_b128 a[228:231], v25 offset:6144
v_mfma_f32_16x16x32_bf16 v[140:143], a[132:135], a[204:207], v[140:143]
ds_read_b128 a[232:235], v25 offset:8192
v_mfma_f32_16x16x32_bf16 v[200:203], a[132:135], a[208:211], v[200:203]
v_mfma_f32_16x16x32_bf16 v[204:207], a[132:135], a[212:215], v[204:207]
ds_read_b128 a[236:239], v25 offset:10240
v_mfma_f32_16x16x32_bf16 v[80:83], a[136:139], a[192:195], v[80:83]
buffer_load_dwordx4 v42, s[8:11], s36 offen offset:2048  lds
v_mfma_f32_16x16x32_bf16 v[84:87], a[136:139], a[196:199], v[84:87]
ds_read_b64_tr_b16 a[164:165], v17 offset:8192
v_mfma_f32_16x16x32_bf16 v[144:147], a[136:139], a[200:203], v[144:147]
ds_read_b64_tr_b16 a[166:167], v17 offset:9216
v_mfma_f32_16x16x32_bf16 v[148:151], a[136:139], a[204:207], v[148:151]
v_mfma_f32_16x16x32_bf16 v[208:211], a[136:139], a[208:211], v[208:211]
ds_read_b64_tr_b16 a[168:169], v18 offset:8192
v_mfma_f32_16x16x32_bf16 v[212:215], a[136:139], a[212:215], v[212:215]
v_mfma_f32_16x16x32_bf16 v[88:91], a[140:143], a[192:195], v[88:91]
ds_read_b64_tr_b16 a[170:171], v18 offset:9216
buffer_load_dwordx4 v43, s[8:11], s36 offen offset:3072  lds
v_mfma_f32_16x16x32_bf16 v[92:95], a[140:143], a[196:199], v[92:95]
ds_read_b64_tr_b16 a[172:173], v19 offset:8192
v_mfma_f32_16x16x32_bf16 v[152:155], a[140:143], a[200:203], v[152:155]
v_mfma_f32_16x16x32_bf16 v[156:159], a[140:143], a[204:207], v[156:159]
ds_read_b64_tr_b16 a[174:175], v19 offset:9216
v_mfma_f32_16x16x32_bf16 v[216:219], a[140:143], a[208:211], v[216:219]
ds_read_b64_tr_b16 a[176:177], v20 offset:8192
v_mfma_f32_16x16x32_bf16 v[220:223], a[140:143], a[212:215], v[220:223]
s_add_u32 m0, s38, 4096
s_xor_b32 s36, s41, 131072
v_mfma_f32_16x16x32_bf16 v[96:99], a[144:147], a[192:195], v[96:99]
ds_read_b64_tr_b16 a[178:179], v20 offset:9216
buffer_load_dwordx4 v40, s[8:11], s36 offen offset:0  lds
v_mfma_f32_16x16x32_bf16 v[100:103], a[144:147], a[196:199], v[100:103]
v_mfma_f32_16x16x32_bf16 v[160:163], a[144:147], a[200:203], v[160:163]
ds_read_b64_tr_b16 a[180:181], v21 offset:8192
v_mfma_f32_16x16x32_bf16 v[164:167], a[144:147], a[204:207], v[164:167]
ds_read_b64_tr_b16 a[182:183], v21 offset:9216
v_mfma_f32_16x16x32_bf16 v[224:227], a[144:147], a[208:211], v[224:227]
v_mfma_f32_16x16x32_bf16 v[228:231], a[144:147], a[212:215], v[228:231]
ds_read_b64_tr_b16 a[184:185], v22 offset:8192
v_mfma_f32_16x16x32_bf16 v[104:107], a[148:151], a[192:195], v[104:107]
buffer_load_dwordx4 v41, s[8:11], s36 offen offset:1024  lds
v_mfma_f32_16x16x32_bf16 v[108:111], a[148:151], a[196:199], v[108:111]
ds_read_b64_tr_b16 a[186:187], v22 offset:9216
v_mfma_f32_16x16x32_bf16 v[168:171], a[148:151], a[200:203], v[168:171]
ds_read_b64_tr_b16 a[188:189], v23 offset:8192
v_mfma_f32_16x16x32_bf16 v[172:175], a[148:151], a[204:207], v[172:175]
v_mfma_f32_16x16x32_bf16 v[232:235], a[148:151], a[208:211], v[232:235]
ds_read_b64_tr_b16 a[190:191], v23 offset:9216
v_mfma_f32_16x16x32_bf16 v[236:239], a[148:151], a[212:215], v[236:239]
v_mfma_f32_16x16x32_bf16 v[112:115], a[152:155], a[192:195], v[112:115]
buffer_load_dwordx4 v42, s[8:11], s36 offen offset:2048  lds
v_mfma_f32_16x16x32_bf16 v[116:119], a[152:155], a[196:199], v[116:119]
v_mfma_f32_16x16x32_bf16 v[176:179], a[152:155], a[200:203], v[176:179]
v_mfma_f32_16x16x32_bf16 v[180:183], a[152:155], a[204:207], v[180:183]
v_mfma_f32_16x16x32_bf16 v[240:243], a[152:155], a[208:211], v[240:243]
v_mfma_f32_16x16x32_bf16 v[244:247], a[152:155], a[212:215], v[244:247]
v_mfma_f32_16x16x32_bf16 v[120:123], a[156:159], a[192:195], v[120:123]
buffer_load_dwordx4 v43, s[8:11], s36 offen offset:3072  lds
v_mfma_f32_16x16x32_bf16 v[124:127], a[156:159], a[196:199], v[124:127]
v_mfma_f32_16x16x32_bf16 v[184:187], a[156:159], a[200:203], v[184:187]
v_mfma_f32_16x16x32_bf16 v[188:191], a[156:159], a[204:207], v[188:191]
v_mfma_f32_16x16x32_bf16 v[248:251], a[156:159], a[208:211], v[248:251]
v_mfma_f32_16x16x32_bf16 v[252:255], a[156:159], a[212:215], v[252:255]
s_waitcnt vmcnt(16) lgkmcnt(0)
s_barrier
v_mfma_f32_16x16x32_bf16 v[64:67], a[160:163], a[216:219], v[64:67]
ds_read_b64_tr_b16 a[128:129], v16 offset:16384
v_mfma_f32_16x16x32_bf16 v[68:71], a[160:163], a[220:223], v[68:71]
ds_read_b64_tr_b16 a[130:131], v16 offset:17408
s_lshl_b32 s42, s43, 7
s_add_u32 s42, s42, s33
v_mfma_f32_16x16x32_bf16 v[128:131], a[160:163], a[224:227], v[128:131]
s_add_u32 s43, s43, 1
s_cmp_eq_u32 s43, 9
v_mfma_f32_16x16x32_bf16 v[132:135], a[160:163], a[228:231], v[132:135]
ds_read_b128 a[192:195], v24 offset:12288
s_cselect_b32 s43, 0, s43
s_add_u32 m0, s39, 0
v_mfma_f32_16x16x32_bf16 v[192:195], a[160:163], a[232:235], v[192:195]
ds_read_b128 a[196:199], v24 offset:14336
buffer_load_dwordx4 v44, s[4:7], s42 offen offset:0  lds
v_mfma_f32_16x16x32_bf16 v[196:199], a[160:163], a[236:239], v[196:199]
buffer_load_dwordx4 v45, s[4:7], s42 offen offset:1024  lds
v_mfma_f32_16x16x32_bf16 v[72:75], a[164:167], a[216:219], v[72:75]
ds_read_b128 a[200:203], v24 offset:16384
v_mfma_f32_16x16x32_bf16 v[76:79], a[164:167], a[220:223], v[76:79]
v_mfma_f32_16x16x32_bf16 v[136:139], a[164:167], a[224:227], v[136:139]
ds_read_b128 a[204:207], v24 offset:18432
v_mfma_f32_16x16x32_bf16 v[140:143], a[164:167], a[228:231], v[140:143]
ds_read_b128 a[208:211], v24 offset:20480
buffer_load_dwordx4 v46, s[4:7], s42 offen offset:2048  lds
v_mfma_f32_16x16x32_bf16 v[200:203], a[164:167], a[232:235], v[200:203]
v_mfma_f32_16x16x32_bf16 v[204:207], a[164:167], a[236:239], v[204:207]
ds_read_b128 a[212:215], v24 offset:22528
v_mfma_f32_16x16x32_bf16 v[80:83], a[168:171], a[216:219], v[80:83]
s_add_u32 m0, s38, 8192
s_xor_b32 s36, s41, 262144
v_mfma_f32_16x16x32_bf16 v[84:87], a[168:171], a[220:223], v[84:87]
ds_read_b64_tr_b16 a[132:133], v17 offset:16384
buffer_load_dwordx4 v40, s[8:11], s36 offen offset:0  lds
v_mfma_f32_16x16x32_bf16 v[144:147], a[168:171], a[224:227], v[144:147]
ds_read_b64_tr_b16 a[134:135], v17 offset:17408
v_mfma_f32_16x16x32_bf16 v[148:151], a[168:171], a[228:231], v[148:151]
v_mfma_f32_16x16x32_bf16 v[208:211], a[168:171], a[232:235], v[208:211]
ds_read_b64_tr_b16 a[136:137], v18 offset:16384
v_mfma_f32_16x16x32_bf16 v[212:215], a[168:171], a[236:239], v[212:215]
v_mfma_f32_16x16x32_bf16 v[88:91], a[172:175], a[216:219], v[88:91]
ds_read_b64_tr_b16 a[138:139], v18 offset:17408
buffer_load_dwordx4 v41, s[8:11], s36 offen offset:1024  lds
v_mfma_f32_16x16x32_bf16 v[92:95], a[172:175], a[220:223], v[92:95]
ds_read_b64_tr_b16 a[140:141], v19 offset:16384
v_mfma_f32_16x16x32_bf16 v[152:155], a[172:175], a[224:227], v[152:155]
v_mfma_f32_16x16x32_bf16 v[156:159], a[172:175], a[228:231], v[156:159]
ds_read_b64_tr_b16 a[142:143], v19 offset:17408
v_mfma_f32_16x16x32_bf16 v[216:219], a[172:175], a[232:235], v[216:219]
ds_read_b64_tr_b16 a[144:145], v20 offset:16384
buffer_load_dwordx4 v42, s[8:11], s36 offen offset:2048  lds
v_mfma_f32_16x16x32_bf16 v[220:223], a[172:175], a[236:239], v[220:223]
v_mfma_f32_16x16x32_bf16 v[96:99], a[176:179], a[216:219], v[96:99]
ds_read_b64_tr_b16 a[146:147], v20 offset:17408
v_mfma_f32_16x16x32_bf16 v[100:103], a[176:179], a[220:223], v[100:103]
v_mfma_f32_16x16x32_bf16 v[160:163], a[176:179], a[224:227], v[160:163]
ds_read_b64_tr_b16 a[148:149], v21 offset:16384
buffer_load_dwordx4 v43, s[8:11], s36 offen offset:3072  lds
v_mfma_f32_16x16x32_bf16 v[164:167], a[176:179], a[228:231], v[164:167]
ds_read_b64_tr_b16 a[150:151], v21 offset:17408
v_mfma_f32_16x16x32_bf16 v[224:227], a[176:179], a[232:235], v[224:227]
v_mfma_f32_16x16x32_bf16 v[228:231], a[176:179], a[236:239], v[228:231]
ds_read_b64_tr_b16 a[152:153], v22 offset:16384
s_add_u32 m0, s38, 12288
s_xor_b32 s36, s41, 393216
v_mfma_f32_16x16x32_bf16 v[104:107], a[180:183], a[216:219], v[104:107]
buffer_load_dwordx4 v40, s[8:11], s36 offen offset:0  lds
v_mfma_f32_16x16x32_bf16 v[108:111], a[180:183], a[220:223], v[108:111]
ds_read_b64_tr_b16 a[154:155], v22 offset:17408
v_mfma_f32_16x16x32_bf16 v[168:171], a[180:183], a[224:227], v[168:171]
ds_read_b64_tr_b16 a[156:157], v23 offset:16384
v_mfma_f32_16x16x32_bf16 v[172:175], a[180:183], a[228:231], v[172:175]
v_mfma_f32_16x16x32_bf16 v[232:235], a[180:183], a[232:235], v[232:235]
ds_read_b64_tr_b16 a[158:159], v23 offset:17408
v_mfma_f32_16x16x32_bf16 v[236:239], a[180:183], a[236:239], v[236:239]
buffer_load_dwordx4 v41, s[8:11], s36 offen offset:1024  lds
v_mfma_f32_16x16x32_bf16 v[112:115], a[184:187], a[216:219], v[112:115]
v_mfma_f32_16x16x32_bf16 v[116:119], a[184:187], a[220:223], v[116:119]
v_mfma_f32_16x16x32_bf16 v[176:179], a[184:187], a[224:227], v[176:179]
v_mfma_f32_16x16x32_bf16 v[180:183], a[184:187], a[228:231], v[180:183]
buffer_load_dwordx4 v42, s[8:11], s36 offen offset:2048  lds
v_mfma_f32_16x16x32_bf16 v[240:243], a[184:187], a[232:235], v[240:243]
v_mfma_f32_16x16x32_bf16 v[244:247], a[184:187], a[236:239], v[244:247]
v_mfma_f32_16x16x32_bf16 v[120:123], a[188:191], a[216:219], v[120:123]
v_mfma_f32_16x16x32_bf16 v[124:127], a[188:191], a[220:223], v[124:127]
buffer_load_dwordx4 v43, s[8:11], s36 offen offset:3072  lds
v_mfma_f32_16x16x32_bf16 v[184:187], a[188:191], a[224:227], v[184:187]
v_mfma_f32_16x16x32_bf16 v[188:191], a[188:191], a[228:231], v[188:191]
v_mfma_f32_16x16x32_bf16 v[248:251], a[188:191], a[232:235], v[248:251]
v_mfma_f32_16x16x32_bf16 v[252:255], a[188:191], a[236:239], v[252:255]
s_waitcnt vmcnt(19) lgkmcnt(0)
v_mfma_f32_16x16x32_bf16 v[64:67], a[128:131], a[192:195], v[64:67]
ds_read_b64_tr_b16 a[160:161], v16 offset:24576
v_mfma_f32_16x16x32_bf16 v[68:71], a[128:131], a[196:199], v[68:71]
ds_read_b64_tr_b16 a[162:163], v16 offset:25600
s_add_u32 m0, s38, 16896
v_mfma_f32_16x16x32_bf16 v[128:131], a[128:131], a[200:203], v[128:131]
buffer_load_dwordx4 v8, s[12:15], s44 offen offset:0 nt lds
v_mfma_f32_16x16x32_bf16 v[132:135], a[128:131], a[204:207], v[132:135]
ds_read_b128 a[216:219], v25 offset:12288
v_mfma_f32_16x16x32_bf16 v[192:195], a[128:131], a[208:211], v[192:195]
ds_read_b128 a[220:223], v25 offset:14336
v_mfma_f32_16x16x32_bf16 v[196:199], a[128:131], a[212:215], v[196:199]
v_mfma_f32_16x16x32_bf16 v[72:75], a[132:135], a[192:195], v[72:75]
ds_read_b128 a[224:227], v25 offset:16384
s_add_u32 m0, s38, 16960
v_mfma_f32_16x16x32_bf16 v[76:79], a[132:135], a[196:199], v[76:79]
buffer_load_dwordx4 v8, s[12:15], s44 offen offset:1024 nt lds
v_mfma_f32_16x16x32_bf16 v[136:139], a[132:135], a[200:203], v[136:139]
ds_read_b128 a[228:231], v25 offset:18432
v_mfma_f32_16x16x32_bf16 v[140:143], a[132:135], a[204:207], v[140:143]
ds_read_b128 a[232:235], v25 offset:20480
v_mfma_f32_16x16x32_bf16 v[200:203], a[132:135], a[208:211], v[200:203]
v_mfma_f32_16x16x32_bf16 v[204:207], a[132:135], a[212:215], v[204:207]
ds_read_b128 a[236:239], v25 offset:22528
v_mfma_f32_16x16x32_bf16 v[80:83], a[136:139], a[192:195], v[80:83]
v_mfma_f32_16x16x32_bf16 v[84:87], a[136:139], a[196:199], v[84:87]
ds_read_b64_tr_b16 a[164:165], v17 offset:24576
s_add_u32 m0, s38, 17024
v_mfma_f32_16x16x32_bf16 v[144:147], a[136:139], a[200:203], v[144:147]
ds_read_b64_tr_b16 a[166:167], v17 offset:25600
buffer_load_dwordx4 v8, s[12:15], s44 offen offset:2048 nt lds
v_mfma_f32_16x16x32_bf16 v[148:151], a[136:139], a[204:207], v[148:151]
v_mfma_f32_16x16x32_bf16 v[208:211], a[136:139], a[208:211], v[208:211]
ds_read_b64_tr_b16 a[168:169], v18 offset:24576
v_mfma_f32_16x16x32_bf16 v[212:215], a[136:139], a[212:215], v[212:215]
v_mfma_f32_16x16x32_bf16 v[88:91], a[140:143], a[192:195], v[88:91]
ds_read_b64_tr_b16 a[170:171], v18 offset:25600
v_mfma_f32_16x16x32_bf16 v[92:95], a[140:143], a[196:199], v[92:95]
ds_read_b64_tr_b16 a[172:173], v19 offset:24576
v_mfma_f32_16x16x32_bf16 v[152:155], a[140:143], a[200:203], v[152:155]
s_add_u32 m0, s38, 17088
v_mfma_f32_16x16x32_bf16 v[156:159], a[140:143], a[204:207], v[156:159]
ds_read_b64_tr_b16 a[174:175], v19 offset:25600
buffer_load_dwordx4 v8, s[12:15], s44 offen offset:3072 nt lds
v_mfma_f32_16x16x32_bf16 v[216:219], a[140:143], a[208:211], v[216:219]
ds_read_b64_tr_b16 a[176:177], v20 offset:24576
v_mfma_f32_16x16x32_bf16 v[220:223], a[140:143], a[212:215], v[220:223]
v_mfma_f32_16x16x32_bf16 v[96:99], a[144:147], a[192:195], v[96:99]
ds_read_b64_tr_b16 a[178:179], v20 offset:25600
v_mfma_f32_16x16x32_bf16 v[100:103], a[144:147], a[196:199], v[100:103]
v_mfma_f32_16x16x32_bf16 v[160:163], a[144:147], a[200:203], v[160:163]
ds_read_b64_tr_b16 a[180:181], v21 offset:24576
s_add_u32 m0, s38, 21248
v_mfma_f32_16x16x32_bf16 v[164:167], a[144:147], a[204:207], v[164:167]
ds_read_b64_tr_b16 a[182:183], v21 offset:25600
buffer_load_dwordx4 v8, s[12:15], s45 offen offset:0 nt lds
v_mfma_f32_16x16x32_bf16 v[224:227], a[144:147], a[208:211], v[224:227]
v_mfma_f32_16x16x32_bf16 v[228:231], a[144:147], a[212:215], v[228:231]
ds_read_b64_tr_b16 a[184:185], v22 offset:24576
v_mfma_f32_16x16x32_bf16 v[104:107], a[148:151], a[192:195], v[104:107]
v_mfma_f32_16x16x32_bf16 v[108:111], a[148:151], a[196:199], v[108:111]
ds_read_b64_tr_b16 a[186:187], v22 offset:25600
v_mfma_f32_16x16x32_bf16 v[168:171], a[148:151], a[200:203], v[168:171]
ds_read_b64_tr_b16 a[188:189], v23 offset:24576
v_mfma_f32_16x16x32_bf16 v[172:175], a[148:151], a[204:207], v[172:175]
s_add_u32 m0, s38, 21312
v_mfma_f32_16x16x32_bf16 v[232:235], a[148:151], a[208:211], v[232:235]
ds_read_b64_tr_b16 a[190:191], v23 offset:25600
buffer_load_dwordx4 v8, s[12:15], s45 offen offset:1024 nt lds
v_mfma_f32_16x16x32_bf16 v[236:239], a[148:151], a[212:215], v[236:239]
v_mfma_f32_16x16x32_bf16 v[112:115], a[152:155], a[192:195], v[112:115]
v_mfma_f32_16x16x32_bf16 v[116:119], a[152:155], a[196:199], v[116:119]
v_mfma_f32_16x16x32_bf16 v[176:179], a[152:155], a[200:203], v[176:179]
v_mfma_f32_16x16x32_bf16 v[180:183], a[152:155], a[204:207], v[180:183]
v_mfma_f32_16x16x32_bf16 v[240:243], a[152:155], a[208:211], v[240:243]
s_add_u32 m0, s38, 21376
v_mfma_f32_16x16x32_bf16 v[244:247], a[152:155], a[212:215], v[244:247]
buffer_load_dwordx4 v8, s[12:15], s45 offen offset:2048 nt lds
v_mfma_f32_16x16x32_bf16 v[120:123], a[156:159], a[192:195], v[120:123]
v_mfma_f32_16x16x32_bf16 v[124:127], a[156:159], a[196:199], v[124:127]
v_mfma_f32_16x16x32_bf16 v[184:187], a[156:159], a[200:203], v[184:187]
v_mfma_f32_16x16x32_bf16 v[188:191], a[156:159], a[204:207], v[188:191]
v_mfma_f32_16x16x32_bf16 v[248:251], a[156:159], a[208:211], v[248:251]
v_mfma_f32_16x16x32_bf16 v[252:255], a[156:159], a[212:215], v[252:255]
s_waitcnt vmcnt(15) lgkmcnt(0)
s_barrier
v_mfma_f32_16x16x32_bf16 v[64:67], a[160:163], a[216:219], v[64:67]
ds_read_b64_tr_b16 a[128:129], v16 offset:0
v_mfma_f32_16x16x32_bf16 v[68:71], a[160:163], a[220:223], v[68:71]
ds_read_b64_tr_b16 a[130:131], v16 offset:1024
s_add_u32 m0, s38, 21440
v_mfma_f32_16x16x32_bf16 v[128:131], a[160:163], a[224:227], v[128:131]
buffer_load_dwordx4 v8, s[12:15], s45 offen offset:3072 nt lds
v_mfma_f32_16x16x32_bf16 v[132:135], a[160:163], a[228:231], v[132:135]
ds_read_b128 a[192:195], v24 offset:0
v_mfma_f32_16x16x32_bf16 v[192:195], a[160:163], a[232:235], v[192:195]
ds_read_b128 a[196:199], v24 offset:2048
v_mfma_f32_16x16x32_bf16 v[196:199], a[160:163], a[236:239], v[196:199]
s_add_u32 m0, s38, 25600
v_mfma_f32_16x16x32_bf16 v[72:75], a[164:167], a[216:219], v[72:75]
ds_read_b128 a[200:203], v24 offset:4096
buffer_load_dwordx4 v9, s[16:19], s44 offen offset:0 nt lds
v_mfma_f32_16x16x32_bf16 v[76:79], a[164:167], a[220:223], v[76:79]
v_mfma_f32_16x16x32_bf16 v[136:139], a[164:167], a[224:227], v[136:139]
ds_read_b128 a[204:207], v24 offset:6144
v_mfma_f32_16x16x32_bf16 v[140:143], a[164:167], a[228:231], v[140:143]
ds_read_b128 a[208:211], v24 offset:8192
v_mfma_f32_16x16x32_bf16 v[200:203], a[164:167], a[232:235], v[200:203]
s_add_u32 m0, s38, 25600
v_mfma_f32_16x16x32_bf16 v[204:207], a[164:167], a[236:239], v[204:207]
ds_read_b128 a[212:215], v24 offset:10240
buffer_load_dwordx4 v9, s[16:19], s44 offen offset:1024 nt lds
v_mfma_f32_16x16x32_bf16 v[80:83], a[168:171], a[216:219], v[80:83]
v_mfma_f32_16x16x32_bf16 v[84:87], a[168:171], a[220:223], v[84:87]
ds_read_b64_tr_b16 a[132:133], v17 offset:0
v_mfma_f32_16x16x32_bf16 v[144:147], a[168:171], a[224:227], v[144:147]
ds_read_b64_tr_b16 a[134:135], v17 offset:1024
v_mfma_f32_16x16x32_bf16 v[148:151], a[168:171], a[228:231], v[148:151]
s_add_u32 m0, s38, 25600
v_mfma_f32_16x16x32_bf16 v[208:211], a[168:171], a[232:235], v[208:211]
ds_read_b64_tr_b16 a[136:137], v18 offset:0
buffer_load_dwordx4 v9, s[16:19], s44 offen offset:2048 nt lds
v_mfma_f32_16x16x32_bf16 v[212:215], a[168:171], a[236:239], v[212:215]
v_mfma_f32_16x16x32_bf16 v[88:91], a[172:175], a[216:219], v[88:91]
ds_read_b64_tr_b16 a[138:139], v18 offset:1024
v_mfma_f32_16x16x32_bf16 v[92:95], a[172:175], a[220:223], v[92:95]
ds_read_b64_tr_b16 a[140:141], v19 offset:0
v_mfma_f32_16x16x32_bf16 v[152:155], a[172:175], a[224:227], v[152:155]
s_add_u32 m0, s38, 25600
v_mfma_f32_16x16x32_bf16 v[156:159], a[172:175], a[228:231], v[156:159]
ds_read_b64_tr_b16 a[142:143], v19 offset:1024
buffer_load_dwordx4 v9, s[16:19], s44 offen offset:3072 nt lds
v_mfma_f32_16x16x32_bf16 v[216:219], a[172:175], a[232:235], v[216:219]
ds_read_b64_tr_b16 a[144:145], v20 offset:0
v_mfma_f32_16x16x32_bf16 v[220:223], a[172:175], a[236:239], v[220:223]
v_mfma_f32_16x16x32_bf16 v[96:99], a[176:179], a[216:219], v[96:99]
ds_read_b64_tr_b16 a[146:147], v20 offset:1024
v_mfma_f32_16x16x32_bf16 v[100:103], a[176:179], a[220:223], v[100:103]
v_mfma_f32_16x16x32_bf16 v[160:163], a[176:179], a[224:227], v[160:163]
ds_read_b64_tr_b16 a[148:149], v21 offset:0
s_add_u32 m0, s38, 29696
v_mfma_f32_16x16x32_bf16 v[164:167], a[176:179], a[228:231], v[164:167]
ds_read_b64_tr_b16 a[150:151], v21 offset:1024
buffer_load_dwordx4 v9, s[16:19], s45 offen offset:0 nt lds
v_mfma_f32_16x16x32_bf16 v[224:227], a[176:179], a[232:235], v[224:227]
v_mfma_f32_16x16x32_bf16 v[228:231], a[176:179], a[236:239], v[228:231]
ds_read_b64_tr_b16 a[152:153], v22 offset:0
v_mfma_f32_16x16x32_bf16 v[104:107], a[180:183], a[216:219], v[104:107]
v_mfma_f32_16x16x32_bf16 v[108:111], a[180:183], a[220:223], v[108:111]
ds_read_b64_tr_b16 a[154:155], v22 offset:1024
s_add_u32 m0, s38, 29696
v_mfma_f32_16x16x32_bf16 v[168:171], a[180:183], a[224:227], v[168:171]
ds_read_b64_tr_b16 a[156:157], v23 offset:0
buffer_load_dwordx4 v9, s[16:19], s45 offen offset:1024 nt lds
v_mfma_f32_16x16x32_bf16 v[172:175], a[180:183], a[228:231], v[172:175]
v_mfma_f32_16x16x32_bf16 v[232:235], a[180:183], a[232:235], v[232:235]
ds_read_b64_tr_b16 a[158:159], v23 offset:1024
v_mfma_f32_16x16x32_bf16 v[236:239], a[180:183], a[236:239], v[236:239]
v_mfma_f32_16x16x32_bf16 v[112:115], a[184:187], a[216:219], v[112:115]
s_add_u32 m0, s38, 29696
v_mfma_f32_16x16x32_bf16 v[116:119], a[184:187], a[220:223], v[116:119]
buffer_load_dwordx4 v9, s[16:19], s45 offen offset:2048 nt lds
v_mfma_f32_16x16x32_bf16 v[176:179], a[184:187], a[224:227], v[176:179]
v_mfma_f32_16x16x32_bf16 v[180:183], a[184:187], a[228:231], v[180:183]
v_mfma_f32_16x16x32_bf16 v[240:243], a[184:187], a[232:235], v[240:243]
v_mfma_f32_16x16x32_bf16 v[244:247], a[184:187], a[236:239], v[244:247]
s_add_u32 m0, s38, 29696
v_mfma_f32_16x16x32_bf16 v[120:123], a[188:191], a[216:219], v[120:123]
buffer_load_dwordx4 v9, s[16:19], s45 offen offset:3072 nt lds
v_mfma_f32_16x16x32_bf16 v[124:127], a[188:191], a[220:223], v[124:127]
v_mfma_f32_16x16x32_bf16 v[184:187], a[188:191], a[224:227], v[184:187]
v_mfma_f32_16x16x32_bf16 v[188:191], a[188:191], a[228:231], v[188:191]
v_mfma_f32_16x16x32_bf16 v[248:251], a[188:191], a[232:235], v[248:251]
v_mfma_f32_16x16x32_bf16 v[252:255], a[188:191], a[236:239], v[252:255]
s_add_u32 s44, s44, 8192
s_and_b32 s44, s44, 0x3ffff
s_add_u32 s45, s44, 4096
s_and_b32 s45, s45, 0x3ffff
s_mov_b32 s14, s40
s_mov_b32 s18, s40
s_waitcnt vmcnt(16) lgkmcnt(0)
v_mfma_f32_16x16x32_bf16 v[64:67], a[128:131], a[192:195], v[64:67]
ds_read_b64_tr_b16 a[160:161], v16 offset:8192
v_mfma_f32_16x16x32_bf16 v[68:71], a[128:131], a[196:199], v[68:71]
ds_read_b64_tr_b16 a[162:163], v16 offset:9216
s_add_u32 m0, s38, 0
v_mfma_f32_16x16x32_bf16 v[128:131], a[128:131], a[200:203], v[128:131]
buffer_load_dwordx4 v8, s[12:15], s44 offen offset:0 nt lds
v_mfma_f32_16x16x32_bf16 v[132:135], a[128:131], a[204:207], v[132:135]
ds_read_b128 a[216:219], v25 offset:0
v_mfma_f32_16x16x32_bf16 v[192:195], a[128:131], a[208:211], v[192:195]
ds_read_b128 a[220:223], v25 offset:2048
v_mfma_f32_16x16x32_bf16 v[196:199], a[128:131], a[212:215], v[196:199]
v_mfma_f32_16x16x32_bf16 v[72:75], a[132:135], a[192:195], v[72:75]
ds_read_b128 a[224:227], v25 offset:4096
s_add_u32 m0, s38, 64
v_mfma_f32_16x16x32_bf16 v[76:79], a[132:135], a[196:199], v[76:79]
buffer_load_dwordx4 v8, s[12:15], s44 offen offset:1024 nt lds
v_mfma_f32_16x16x32_bf16 v[136:139], a[132:135], a[200:203], v[136:139]
ds_read_b128 a[228:231], v25 offset:6144
v_mfma_f32_16x16x32_bf16 v[140:143], a[132:135], a[204:207], v[140:143]
ds_read_b128 a[232:235], v25 offset:8192
v_mfma_f32_16x16x32_bf16 v[200:203], a[132:135], a[208:211], v[200:203]
v_mfma_f32_16x16x32_bf16 v[204:207], a[132:135], a[212:215], v[204:207]
ds_read_b128 a[236:239], v25 offset:10240
v_mfma_f32_16x16x32_bf16 v[80:83], a[136:139], a[192:195], v[80:83]
v_mfma_f32_16x16x32_bf16 v[84:87], a[136:139], a[196:199], v[84:87]
ds_read_b64_tr_b16 a[164:165], v17 offset:8192
s_add_u32 m0, s38, 128
v_mfma_f32_16x16x32_bf16 v[144:147], a[136:139], a[200:203], v[144:147]
ds_read_b64_tr_b16 a[166:167], v17 offset:9216
buffer_load_dwordx4 v8, s[12:15], s44 offen offset:2048 nt lds
v_mfma_f32_16x16x32_bf16 v[148:151], a[136:139], a[204:207], v[148:151]
v_mfma_f32_16x16x32_bf16 v[208:211], a[136:139], a[208:211], v[208:211]
ds_read_b64_tr_b16 a[168:169], v18 offset:8192
v_mfma_f32_16x16x32_bf16 v[212:215], a[136:139], a[212:215], v[212:215]
v_mfma_f32_16x16x32_bf16 v[88:91], a[140:143], a[192:195], v[88:91]
ds_read_b64_tr_b16 a[170:171], v18 offset:9216
v_mfma_f32_16x16x32_bf16 v[92:95], a[140:143], a[196:199], v[92:95]
ds_read_b64_tr_b16 a[172:173], v19 offset:8192
v_mfma_f32_16x16x32_bf16 v[152:155], a[140:143], a[200:203], v[152:155]
s_add_u32 m0, s38, 192
v_mfma_f32_16x16x32_bf16 v[156:159], a[140:143], a[204:207], v[156:159]
ds_read_b64_tr_b16 a[174:175], v19 offset:9216
buffer_load_dwordx4 v8, s[12:15], s44 offen offset:3072 nt lds
v_mfma_f32_16x16x32_bf16 v[216:219], a[140:143], a[208:211], v[216:219]
ds_read_b64_tr_b16 a[176:177], v20 offset:8192
v_mfma_f32_16x16x32_bf16 v[220:223], a[140:143], a[212:215], v[220:223]
v_mfma_f32_16x16x32_bf16 v[96:99], a[144:147], a[192:195], v[96:99]
ds_read_b64_tr_b16 a[178:179], v20 offset:9216
v_mfma_f32_16x16x32_bf16 v[100:103], a[144:147], a[196:199], v[100:103]
v_mfma_f32_16x16x32_bf16 v[160:163], a[144:147], a[200:203], v[160:163]
ds_read_b64_tr_b16 a[180:181], v21 offset:8192
s_add_u32 m0, s38, 4352
v_mfma_f32_16x16x32_bf16 v[164:167], a[144:147], a[204:207], v[164:167]
ds_read_b64_tr_b16 a[182:183], v21 offset:9216
buffer_load_dwordx4 v8, s[12:15], s45 offen offset:0 nt lds
v_mfma_f32_16x16x32_bf16 v[224:227], a[144:147], a[208:211], v[224:227]
v_mfma_f32_16x16x32_bf16 v[228:231], a[144:147], a[212:215], v[228:231]
ds_read_b64_tr_b16 a[184:185], v22 offset:8192
v_mfma_f32_16x16x32_bf16 v[104:107], a[148:151], a[192:195], v[104:107]
v_mfma_f32_16x16x32_bf16 v[108:111], a[148:151], a[196:199], v[108:111]
ds_read_b64_tr_b16 a[186:187], v22 offset:9216
v_mfma_f32_16x16x32_bf16 v[168:171], a[148:151], a[200:203], v[168:171]
ds_read_b64_tr_b16 a[188:189], v23 offset:8192
v_mfma_f32_16x16x32_bf16 v[172:175], a[148:151], a[204:207], v[172:175]
s_add_u32 m0, s38, 4416
v_mfma_f32_16x16x32_bf16 v[232:235], a[148:151], a[208:211], v[232:235]
ds_read_b64_tr_b16 a[190:191], v23 offset:9216
buffer_load_dwordx4 v8, s[12:15], s45 offen offset:1024 nt lds
v_mfma_f32_16x16x32_bf16 v[236:239], a[148:151], a[212:215], v[236:239]
v_mfma_f32_16x16x32_bf16 v[112:115], a[152:155], a[192:195], v[112:115]
v_mfma_f32_16x16x32_bf16 v[116:119], a[152:155], a[196:199], v[116:119]
v_mfma_f32_16x16x32_bf16 v[176:179], a[152:155], a[200:203], v[176:179]
v_mfma_f32_16x16x32_bf16 v[180:183], a[152:155], a[204:207], v[180:183]
v_mfma_f32_16x16x32_bf16 v[240:243], a[152:155], a[208:211], v[240:243]
s_add_u32 m0, s38, 4480
v_mfma_f32_16x16x32_bf16 v[244:247], a[152:155], a[212:215], v[244:247]
buffer_load_dwordx4 v8, s[12:15], s45 offen offset:2048 nt lds
v_mfma_f32_16x16x32_bf16 v[120:123], a[156:159], a[192:195], v[120:123]
v_mfma_f32_16x16x32_bf16 v[124:127], a[156:159], a[196:199], v[124:127]
v_mfma_f32_16x16x32_bf16 v[184:187], a[156:159], a[200:203], v[184:187]
v_mfma_f32_16x16x32_bf16 v[188:191], a[156:159], a[204:207], v[188:191]
v_mfma_f32_16x16x32_bf16 v[248:251], a[156:159], a[208:211], v[248:251]
v_mfma_f32_16x16x32_bf16 v[252:255], a[156:159], a[212:215], v[252:255]
s_waitcnt lgkmcnt(0)
v_mfma_f32_16x16x32_bf16 v[64:67], a[160:163], a[216:219], v[64:67]
v_accvgpr_write_b32 a128, 0
v_mfma_f32_16x16x32_bf16 v[68:71], a[160:163], a[220:223], v[68:71]
s_add_u32 m0, s38, 4544
v_accvgpr_write_b32 a129, 0
v_mfma_f32_16x16x32_bf16 v[128:131], a[160:163], a[224:227], v[128:131]
buffer_load_dwordx4 v8, s[12:15], s45 offen offset:3072 nt lds
v_accvgpr_write_b32 a130, 0
v_mfma_f32_16x16x32_bf16 v[132:135], a[160:163], a[228:231], v[132:135]
v_accvgpr_write_b32 a131, 0
v_mfma_f32_16x16x32_bf16 v[192:195], a[160:163], a[232:235], v[192:195]
v_accvgpr_write_b32 a132, 0
v_mfma_f32_16x16x32_bf16 v[196:199], a[160:163], a[236:239], v[196:199]
s_add_u32 m0, s38, 8704
v_accvgpr_write_b32 a133, 0
v_mfma_f32_16x16x32_bf16 v[72:75], a[164:167], a[216:219], v[72:75]
buffer_load_dwordx4 v9, s[16:19], s44 offen offset:0 nt lds
v_accvgpr_write_b32 a134, 0
v_mfma_f32_16x16x32_bf16 v[76:79], a[164:167], a[220:223], v[76:79]
v_accvgpr_write_b32 a135, 0
v_mfma_f32_16x16x32_bf16 v[136:139], a[164:167], a[224:227], v[136:139]
v_accvgpr_write_b32 a136, 0
v_mfma_f32_16x16x32_bf16 v[140:143], a[164:167], a[228:231], v[140:143]
v_accvgpr_write_b32 a137, 0
v_mfma_f32_16x16x32_bf16 v[200:203], a[164:167], a[232:235], v[200:203]
s_add_u32 m0, s38, 8704
v_accvgpr_write_b32 a138, 0
v_mfma_f32_16x16x32_bf16 v[204:207], a[164:167], a[236:239], v[204:207]
buffer_load_dwordx4 v9, s[16:19], s44 offen offset:1024 nt lds
v_accvgpr_write_b32 a139, 0
v_mfma_f32_16x16x32_bf16 v[80:83], a[168:171], a[216:219], v[80:83]
v_accvgpr_write_b32 a140, 0
v_mfma_f32_16x16x32_bf16 v[84:87], a[168:171], a[220:223], v[84:87]
v_accvgpr_write_b32 a141, 0
v_mfma_f32_16x16x32_bf16 v[144:147], a[168:171], a[224:227], v[144:147]
v_accvgpr_write_b32 a142, 0
v_mfma_f32_16x16x32_bf16 v[148:151], a[168:171], a[228:231], v[148:151]
s_add_u32 m0, s38, 8704
v_accvgpr_write_b32 a143, 0
v_mfma_f32_16x16x32_bf16 v[208:211], a[168:171], a[232:235], v[208:211]
buffer_load_dwordx4 v9, s[16:19], s44 offen offset:2048 nt lds
v_accvgpr_write_b32 a144, 0
v_mfma_f32_16x16x32_bf16 v[212:215], a[168:171], a[236:239], v[212:215]
v_accvgpr_write_b32 a145, 0
v_mfma_f32_16x16x32_bf16 v[88:91], a[172:175], a[216:219], v[88:91]
v_accvgpr_write_b32 a146, 0
v_mfma_f32_16x16x32_bf16 v[92:95], a[172:175], a[220:223], v[92:95]
v_accvgpr_write_b32 a147, 0
v_mfma_f32_16x16x32_bf16 v[152:155], a[172:175], a[224:227], v[152:155]
s_add_u32 m0, s38, 8704
v_accvgpr_write_b32 a148, 0
v_mfma_f32_16x16x32_bf16 v[156:159], a[172:175], a[228:231], v[156:159]
buffer_load_dwordx4 v9, s[16:19], s44 offen offset:3072 nt lds
v_accvgpr_write_b32 a149, 0
v_mfma_f32_16x16x32_bf16 v[216:219], a[172:175], a[232:235], v[216:219]
v_accvgpr_write_b32 a150, 0
v_mfma_f32_16x16x32_bf16 v[220:223], a[172:175], a[236:239], v[220:223]
v_accvgpr_write_b32 a151, 0
v_mfma_f32_16x16x32_bf16 v[96:99], a[176:179], a[216:219], v[96:99]
v_accvgpr_write_b32 a152, 0
v_mfma_f32_16x16x32_bf16 v[100:103], a[176:179], a[220:223], v[100:103]
v_accvgpr_write_b32 a153, 0
v_mfma_f32_16x16x32_bf16 v[160:163], a[176:179], a[224:227], v[160:163]
s_add_u32 m0, s38, 12800
v_accvgpr_write_b32 a154, 0
v_mfma_f32_16x16x32_bf16 v[164:167], a[176:179], a[228:231], v[164:167]
buffer_load_dwordx4 v9, s[16:19], s45 offen offset:0 nt lds
v_accvgpr_write_b32 a155, 0
v_mfma_f32_16x16x32_bf16 v[224:227], a[176:179], a[232:235], v[224:227]
v_accvgpr_write_b32 a156, 0
v_mfma_f32_16x16x32_bf16 v[228:231], a[176:179], a[236:239], v[228:231]
v_accvgpr_write_b32 a157, 0
v_mfma_f32_16x16x32_bf16 v[104:107], a[180:183], a[216:219], v[104:107]
v_accvgpr_write_b32 a158, 0
v_mfma_f32_16x16x32_bf16 v[108:111], a[180:183], a[220:223], v[108:111]
s_add_u32 m0, s38, 12800
v_accvgpr_write_b32 a159, 0
v_mfma_f32_16x16x32_bf16 v[168:171], a[180:183], a[224:227], v[168:171]
buffer_load_dwordx4 v9, s[16:19], s45 offen offset:1024 nt lds
v_mfma_f32_16x16x32_bf16 v[172:175], a[180:183], a[228:231], v[172:175]
v_mfma_f32_16x16x32_bf16 v[232:235], a[180:183], a[232:235], v[232:235]
v_mfma_f32_16x16x32_bf16 v[236:239], a[180:183], a[236:239], v[236:239]
v_mfma_f32_16x16x32_bf16 v[112:115], a[184:187], a[216:219], v[112:115]
s_add_u32 m0, s38, 12800
v_mfma_f32_16x16x32_bf16 v[116:119], a[184:187], a[220:223], v[116:119]
buffer_load_dwordx4 v9, s[16:19], s45 offen offset:2048 nt lds
v_mfma_f32_16x16x32_bf16 v[176:179], a[184:187], a[224:227], v[176:179]
v_mfma_f32_16x16x32_bf16 v[180:183], a[184:187], a[228:231], v[180:183]
v_mfma_f32_16x16x32_bf16 v[240:243], a[184:187], a[232:235], v[240:243]
v_mfma_f32_16x16x32_bf16 v[244:247], a[184:187], a[236:239], v[244:247]
s_add_u32 m0, s38, 12800
v_mfma_f32_16x16x32_bf16 v[120:123], a[188:191], a[216:219], v[120:123]
buffer_load_dwordx4 v9, s[16:19], s45 offen offset:3072 nt lds
v_mfma_f32_16x16x32_bf16 v[124:127], a[188:191], a[220:223], v[124:127]
v_mfma_f32_16x16x32_bf16 v[184:187], a[188:191], a[224:227], v[184:187]
v_mfma_f32_16x16x32_bf16 v[188:191], a[188:191], a[228:231], v[188:191]
v_mfma_f32_16x16x32_bf16 v[248:251], a[188:191], a[232:235], v[248:251]
v_mfma_f32_16x16x32_bf16 v[252:255], a[188:191], a[236:239], v[252:255]
s_add_u32 s44, s44, 8192
s_and_b32 s44, s44, 0x3ffff
s_add_u32 s45, s44, 4096
s_and_b32 s45, s45, 0x3ffff
s_mov_b32 s14, 262144
s_mov_b32 s18, 262144
s_cmp_eq_u32 s24, 0
s_cselect_b32 s4, s72, s82
s_cselect_b32 s5, s73, s83
s_mov_b32 s6, 4718592
s_mov_b32 s7, 0x20000
s_nop 7
v_pk_mul_f32 v[254:255], v[254:255], s[84:85]
v_pk_mul_f32 v[252:253], v[252:253], s[84:85]
v_cvt_pk_bf16_f32 v255, v254, v255
v_pk_mul_f32 v[250:251], v[250:251], s[84:85]
v_cvt_pk_bf16_f32 v254, v252, v253
v_pk_mul_f32 v[248:249], v[248:249], s[84:85]
v_cvt_pk_bf16_f32 v253, v250, v251
v_pk_mul_f32 v[246:247], v[246:247], s[84:85]
v_cvt_pk_bf16_f32 v252, v248, v249
v_pk_mul_f32 v[244:245], v[244:245], s[84:85]
v_cvt_pk_bf16_f32 v251, v246, v247
v_pk_mul_f32 v[242:243], v[242:243], s[84:85]
v_cvt_pk_bf16_f32 v250, v244, v245
v_pk_mul_f32 v[240:241], v[240:241], s[84:85]
v_cvt_pk_bf16_f32 v249, v242, v243
v_pk_mul_f32 v[238:239], v[238:239], s[84:85]
v_cvt_pk_bf16_f32 v248, v240, v241
v_pk_mul_f32 v[236:237], v[236:237], s[84:85]
v_cvt_pk_bf16_f32 v247, v238, v239
v_pk_mul_f32 v[234:235], v[234:235], s[84:85]
v_cvt_pk_bf16_f32 v246, v236, v237
v_pk_mul_f32 v[232:233], v[232:233], s[84:85]
v_cvt_pk_bf16_f32 v245, v234, v235
v_pk_mul_f32 v[230:231], v[230:231], s[84:85]
v_cvt_pk_bf16_f32 v244, v232, v233
v_pk_mul_f32 v[228:229], v[228:229], s[84:85]
v_cvt_pk_bf16_f32 v243, v230, v231
v_pk_mul_f32 v[226:227], v[226:227], s[84:85]
v_cvt_pk_bf16_f32 v242, v228, v229
v_pk_mul_f32 v[224:225], v[224:225], s[84:85]
v_cvt_pk_bf16_f32 v241, v226, v227
v_pk_mul_f32 v[222:223], v[222:223], s[84:85]
v_cvt_pk_bf16_f32 v240, v224, v225
v_pk_mul_f32 v[220:221], v[220:221], s[84:85]
v_cvt_pk_bf16_f32 v239, v222, v223
v_pk_mul_f32 v[218:219], v[218:219], s[84:85]
v_cvt_pk_bf16_f32 v238, v220, v221
v_pk_mul_f32 v[216:217], v[216:217], s[84:85]
v_cvt_pk_bf16_f32 v237, v218, v219
v_pk_mul_f32 v[214:215], v[214:215], s[84:85]
v_cvt_pk_bf16_f32 v236, v216, v217
v_pk_mul_f32 v[212:213], v[212:213], s[84:85]
v_cvt_pk_bf16_f32 v235, v214, v215
v_pk_mul_f32 v[210:211], v[210:211], s[84:85]
v_cvt_pk_bf16_f32 v234, v212, v213
v_pk_mul_f32 v[208:209], v[208:209], s[84:85]
v_cvt_pk_bf16_f32 v233, v210, v211
v_pk_mul_f32 v[206:207], v[206:207], s[84:85]
v_cvt_pk_bf16_f32 v232, v208, v209
v_pk_mul_f32 v[204:205], v[204:205], s[84:85]
v_cvt_pk_bf16_f32 v231, v206, v207
v_pk_mul_f32 v[202:203], v[202:203], s[84:85]
v_cvt_pk_bf16_f32 v230, v204, v205
v_pk_mul_f32 v[200:201], v[200:201], s[84:85]
v_cvt_pk_bf16_f32 v229, v202, v203
v_pk_mul_f32 v[198:199], v[198:199], s[84:85]
v_cvt_pk_bf16_f32 v228, v200, v201
v_pk_mul_f32 v[196:197], v[196:197], s[84:85]
v_cvt_pk_bf16_f32 v227, v198, v199
v_pk_mul_f32 v[194:195], v[194:195], s[84:85]
v_cvt_pk_bf16_f32 v226, v196, v197
v_pk_mul_f32 v[192:193], v[192:193], s[84:85]
v_cvt_pk_bf16_f32 v225, v194, v195
v_pk_mul_f32 v[190:191], v[190:191], s[84:85]
v_cvt_pk_bf16_f32 v224, v192, v193
v_pk_mul_f32 v[188:189], v[188:189], s[84:85]
v_cvt_pk_bf16_f32 v223, v190, v191
v_pk_mul_f32 v[186:187], v[186:187], s[84:85]
v_cvt_pk_bf16_f32 v222, v188, v189
v_pk_mul_f32 v[184:185], v[184:185], s[84:85]
v_cvt_pk_bf16_f32 v221, v186, v187
v_pk_mul_f32 v[182:183], v[182:183], s[84:85]
v_cvt_pk_bf16_f32 v220, v184, v185
v_pk_mul_f32 v[180:181], v[180:181], s[84:85]
v_cvt_pk_bf16_f32 v219, v182, v183
v_pk_mul_f32 v[178:179], v[178:179], s[84:85]
v_cvt_pk_bf16_f32 v218, v180, v181
v_pk_mul_f32 v[176:177], v[176:177], s[84:85]
v_cvt_pk_bf16_f32 v217, v178, v179
v_pk_mul_f32 v[174:175], v[174:175], s[84:85]
v_cvt_pk_bf16_f32 v216, v176, v177
v_pk_mul_f32 v[172:173], v[172:173], s[84:85]
v_cvt_pk_bf16_f32 v215, v174, v175
v_pk_mul_f32 v[170:171], v[170:171], s[84:85]
v_cvt_pk_bf16_f32 v214, v172, v173
v_pk_mul_f32 v[168:169], v[168:169], s[84:85]
v_cvt_pk_bf16_f32 v213, v170, v171
v_pk_mul_f32 v[166:167], v[166:167], s[84:85]
v_cvt_pk_bf16_f32 v212, v168, v169
v_pk_mul_f32 v[164:165], v[164:165], s[84:85]
v_cvt_pk_bf16_f32 v211, v166, v167
v_pk_mul_f32 v[162:163], v[162:163], s[84:85]
v_cvt_pk_bf16_f32 v210, v164, v165
v_pk_mul_f32 v[160:161], v[160:161], s[84:85]
v_cvt_pk_bf16_f32 v209, v162, v163
v_pk_mul_f32 v[158:159], v[158:159], s[84:85]
v_cvt_pk_bf16_f32 v208, v160, v161
v_pk_mul_f32 v[156:157], v[156:157], s[84:85]
v_cvt_pk_bf16_f32 v207, v158, v159
v_pk_mul_f32 v[154:155], v[154:155], s[84:85]
v_cvt_pk_bf16_f32 v206, v156, v157
v_pk_mul_f32 v[152:153], v[152:153], s[84:85]
v_cvt_pk_bf16_f32 v205, v154, v155
v_pk_mul_f32 v[150:151], v[150:151], s[84:85]
v_cvt_pk_bf16_f32 v204, v152, v153
v_pk_mul_f32 v[148:149], v[148:149], s[84:85]
v_cvt_pk_bf16_f32 v203, v150, v151
v_pk_mul_f32 v[146:147], v[146:147], s[84:85]
v_cvt_pk_bf16_f32 v202, v148, v149
v_pk_mul_f32 v[144:145], v[144:145], s[84:85]
v_cvt_pk_bf16_f32 v201, v146, v147
v_pk_mul_f32 v[142:143], v[142:143], s[84:85]
v_cvt_pk_bf16_f32 v200, v144, v145
v_pk_mul_f32 v[140:141], v[140:141], s[84:85]
v_cvt_pk_bf16_f32 v199, v142, v143
v_pk_mul_f32 v[138:139], v[138:139], s[84:85]
v_cvt_pk_bf16_f32 v198, v140, v141
v_pk_mul_f32 v[136:137], v[136:137], s[84:85]
v_cvt_pk_bf16_f32 v197, v138, v139
v_pk_mul_f32 v[134:135], v[134:135], s[84:85]
v_cvt_pk_bf16_f32 v196, v136, v137
v_pk_mul_f32 v[132:133], v[132:133], s[84:85]
v_cvt_pk_bf16_f32 v195, v134, v135
v_pk_mul_f32 v[130:131], v[130:131], s[84:85]
v_cvt_pk_bf16_f32 v194, v132, v133
v_pk_mul_f32 v[128:129], v[128:129], s[84:85]
v_cvt_pk_bf16_f32 v193, v130, v131
v_pk_mul_f32 v[126:127], v[126:127], s[84:85]
v_cvt_pk_bf16_f32 v192, v128, v129
v_pk_mul_f32 v[124:125], v[124:125], s[84:85]
v_cvt_pk_bf16_f32 v191, v126, v127
v_pk_mul_f32 v[122:123], v[122:123], s[84:85]
v_cvt_pk_bf16_f32 v190, v124, v125
v_pk_mul_f32 v[120:121], v[120:121], s[84:85]
v_cvt_pk_bf16_f32 v189, v122, v123
v_pk_mul_f32 v[118:119], v[118:119], s[84:85]
v_cvt_pk_bf16_f32 v188, v120, v121
v_pk_mul_f32 v[116:117], v[116:117], s[84:85]
v_cvt_pk_bf16_f32 v187, v118, v119
v_pk_mul_f32 v[114:115], v[114:115], s[84:85]
v_cvt_pk_bf16_f32 v186, v116, v117
v_pk_mul_f32 v[112:113], v[112:113], s[84:85]
v_cvt_pk_bf16_f32 v185, v114, v115
v_pk_mul_f32 v[110:111], v[110:111], s[84:85]
v_cvt_pk_bf16_f32 v184, v112, v113
v_pk_mul_f32 v[108:109], v[108:109], s[84:85]
v_cvt_pk_bf16_f32 v183, v110, v111
v_pk_mul_f32 v[106:107], v[106:107], s[84:85]
v_cvt_pk_bf16_f32 v182, v108, v109
v_pk_mul_f32 v[104:105], v[104:105], s[84:85]
v_cvt_pk_bf16_f32 v181, v106, v107
v_pk_mul_f32 v[102:103], v[102:103], s[84:85]
v_cvt_pk_bf16_f32 v180, v104, v105
v_pk_mul_f32 v[100:101], v[100:101], s[84:85]
v_cvt_pk_bf16_f32 v179, v102, v103
v_pk_mul_f32 v[98:99], v[98:99], s[84:85]
v_cvt_pk_bf16_f32 v178, v100, v101
v_pk_mul_f32 v[96:97], v[96:97], s[84:85]
v_cvt_pk_bf16_f32 v177, v98, v99
v_pk_mul_f32 v[94:95], v[94:95], s[84:85]
v_cvt_pk_bf16_f32 v176, v96, v97
v_pk_mul_f32 v[92:93], v[92:93], s[84:85]
v_cvt_pk_bf16_f32 v175, v94, v95
v_pk_mul_f32 v[90:91], v[90:91], s[84:85]
v_cvt_pk_bf16_f32 v174, v92, v93
v_pk_mul_f32 v[88:89], v[88:89], s[84:85]
v_cvt_pk_bf16_f32 v173, v90, v91
v_pk_mul_f32 v[86:87], v[86:87], s[84:85]
v_cvt_pk_bf16_f32 v172, v88, v89
v_pk_mul_f32 v[84:85], v[84:85], s[84:85]
v_cvt_pk_bf16_f32 v171, v86, v87
v_pk_mul_f32 v[82:83], v[82:83], s[84:85]
v_cvt_pk_bf16_f32 v170, v84, v85
v_pk_mul_f32 v[80:81], v[80:81], s[84:85]
v_cvt_pk_bf16_f32 v169, v82, v83
s_waitcnt vmcnt(24)
s_barrier
ds_read_b128 a[192:195], v10 offset:16896
ds_read_b128 a[196:199], v11 offset:16896
ds_read_b128 a[200:203], v10 offset:16960
ds_read_b128 a[204:207], v11 offset:16960
ds_read_b128 a[208:211], v10 offset:17024
ds_read_b128 a[212:215], v11 offset:17024
ds_read_b128 a[216:219], v10 offset:17088
ds_read_b128 a[220:223], v11 offset:17088
v_pk_mul_f32 v[78:79], v[78:79], s[84:85]
v_cvt_pk_bf16_f32 v168, v80, v81
v_pk_mul_f32 v[76:77], v[76:77], s[84:85]
v_cvt_pk_bf16_f32 v167, v78, v79
v_pk_mul_f32 v[74:75], v[74:75], s[84:85]
v_cvt_pk_bf16_f32 v166, v76, v77
v_pk_mul_f32 v[72:73], v[72:73], s[84:85]
v_cvt_pk_bf16_f32 v165, v74, v75
v_pk_mul_f32 v[70:71], v[70:71], s[84:85]
v_cvt_pk_bf16_f32 v164, v72, v73
v_pk_mul_f32 v[68:69], v[68:69], s[84:85]
v_cvt_pk_bf16_f32 v163, v70, v71
v_pk_mul_f32 v[66:67], v[66:67], s[84:85]
v_cvt_pk_bf16_f32 v162, v68, v69
v_pk_mul_f32 v[64:65], v[64:65], s[84:85]
v_cvt_pk_bf16_f32 v161, v66, v67
v_cvt_pk_bf16_f32 v160, v64, v65
v_permlane16_swap_b32 v252, v254
v_permlane16_swap_b32 v253, v255
v_permlane16_swap_b32 v248, v250
v_permlane16_swap_b32 v249, v251
v_permlane16_swap_b32 v244, v246
v_permlane16_swap_b32 v245, v247
v_permlane16_swap_b32 v240, v242
v_permlane16_swap_b32 v241, v243
v_permlane16_swap_b32 v236, v238
v_permlane16_swap_b32 v237, v239
v_permlane16_swap_b32 v232, v234
v_permlane16_swap_b32 v233, v235
v_permlane16_swap_b32 v228, v230
v_permlane16_swap_b32 v229, v231
v_permlane16_swap_b32 v224, v226
v_permlane16_swap_b32 v225, v227
v_permlane16_swap_b32 v220, v222
v_permlane16_swap_b32 v221, v223
v_permlane16_swap_b32 v216, v218
v_permlane16_swap_b32 v217, v219
v_permlane16_swap_b32 v212, v214
v_permlane16_swap_b32 v213, v215
v_permlane16_swap_b32 v208, v210
v_permlane16_swap_b32 v209, v211
v_permlane16_swap_b32 v204, v206
v_permlane16_swap_b32 v205, v207
v_permlane16_swap_b32 v200, v202
v_permlane16_swap_b32 v201, v203
v_permlane16_swap_b32 v196, v198
v_permlane16_swap_b32 v197, v199
v_permlane16_swap_b32 v192, v194
v_permlane16_swap_b32 v193, v195
v_permlane16_swap_b32 v188, v190
v_permlane16_swap_b32 v189, v191
v_permlane16_swap_b32 v184, v186
v_permlane16_swap_b32 v185, v187
v_permlane16_swap_b32 v180, v182
v_permlane16_swap_b32 v181, v183
v_permlane16_swap_b32 v176, v178
v_permlane16_swap_b32 v177, v179
v_permlane16_swap_b32 v172, v174
v_permlane16_swap_b32 v173, v175
v_permlane16_swap_b32 v168, v170
v_permlane16_swap_b32 v169, v171
v_permlane16_swap_b32 v164, v166
v_permlane16_swap_b32 v165, v167
v_permlane16_swap_b32 v160, v162
v_permlane16_swap_b32 v161, v163
L_qdone:
s_nop 0
s_waitcnt lgkmcnt(0)
v_mfma_f32_32x32x16_bf16 v[16:31], a[192:195], v[160:163], 0
v_accvgpr_write_b32 a224, 0
v_accvgpr_write_b32 a225, 0
v_accvgpr_write_b32 a226, 0
v_accvgpr_write_b32 a227, 0
v_accvgpr_write_b32 a228, 0
v_accvgpr_write_b32 a229, 0
v_accvgpr_write_b32 a230, 0
v_accvgpr_write_b32 a231, 0
v_mfma_f32_32x32x16_bf16 v[16:31], a[196:199], v[164:167], v[16:31]
v_accvgpr_write_b32 a232, 0
v_accvgpr_write_b32 a233, 0
v_accvgpr_write_b32 a234, 0
v_accvgpr_write_b32 a235, 0
v_accvgpr_write_b32 a236, 0
v_accvgpr_write_b32 a237, 0
v_accvgpr_write_b32 a238, 0
v_mfma_f32_32x32x16_bf16 v[16:31], a[200:203], v[168:171], v[16:31]
v_accvgpr_write_b32 a239, 0
v_accvgpr_write_b32 a240, 0
v_accvgpr_write_b32 a241, 0
v_accvgpr_write_b32 a242, 0
v_accvgpr_write_b32 a243, 0
v_accvgpr_write_b32 a244, 0
v_accvgpr_write_b32 a245, 0
v_accvgpr_write_b32 a246, 0
v_mfma_f32_32x32x16_bf16 v[16:31], a[204:207], v[172:175], v[16:31]
v_accvgpr_write_b32 a247, 0
v_accvgpr_write_b32 a248, 0
v_accvgpr_write_b32 a249, 0
v_accvgpr_write_b32 a250, 0
v_accvgpr_write_b32 a251, 0
v_accvgpr_write_b32 a252, 0
v_accvgpr_write_b32 a253, 0
v_mfma_f32_32x32x16_bf16 v[16:31], a[208:211], v[176:179], v[16:31]
v_accvgpr_write_b32 a254, 0
v_accvgpr_write_b32 a255, 0
v_mov_b32 v128, 0
v_mov_b32 v129, 0
v_mov_b32 v130, 0
v_mov_b32 v131, 0
v_mov_b32 v132, 0
v_mov_b32 v133, 0
v_mfma_f32_32x32x16_bf16 v[16:31], a[212:215], v[180:183], v[16:31]
v_mov_b32 v134, 0
v_mov_b32 v135, 0
v_mov_b32 v144, 0
v_mov_b32 v145, 0
v_mov_b32 v146, 0
v_accvgpr_write_b32 a160, 0
v_accvgpr_write_b32 a161, 0
v_mfma_f32_32x32x16_bf16 v[16:31], a[216:219], v[184:187], v[16:31]
v_accvgpr_write_b32 a162, 0
v_accvgpr_write_b32 a163, 0
v_accvgpr_write_b32 a164, 0
v_accvgpr_write_b32 a165, 0
v_accvgpr_write_b32 a166, 0
v_accvgpr_write_b32 a167, 0
v_accvgpr_write_b32 a168, 0
v_accvgpr_write_b32 a169, 0
v_mfma_f32_32x32x16_bf16 v[16:31], a[220:223], v[188:191], v[16:31]
v_accvgpr_write_b32 a170, 0
v_accvgpr_write_b32 a171, 0
v_accvgpr_write_b32 a172, 0
v_accvgpr_write_b32 a173, 0
v_accvgpr_write_b32 a174, 0
v_accvgpr_write_b32 a175, 0
v_accvgpr_write_b32 a176, 0
v_mfma_f32_32x32x16_bf16 v[32:47], a[192:195], v[192:195], 0
v_accvgpr_write_b32 a177, 0
v_accvgpr_write_b32 a178, 0
v_accvgpr_write_b32 a179, 0
v_accvgpr_write_b32 a180, 0
v_accvgpr_write_b32 a181, 0
v_accvgpr_write_b32 a182, 0
v_accvgpr_write_b32 a183, 0
v_accvgpr_write_b32 a184, 0
v_mfma_f32_32x32x16_bf16 v[32:47], a[196:199], v[196:199], v[32:47]
v_accvgpr_write_b32 a185, 0
v_accvgpr_write_b32 a186, 0
v_accvgpr_write_b32 a187, 0
v_accvgpr_write_b32 a188, 0
v_accvgpr_write_b32 a189, 0
v_accvgpr_write_b32 a190, 0
v_accvgpr_write_b32 a191, 0
s_nop 1
v_mfma_f32_32x32x16_bf16 v[32:47], a[200:203], v[200:203], v[32:47]
v_max3_f32 v148, v16, v17, v18
v_max3_f32 v148, v148, v19, v20
v_max3_f32 v148, v148, v21, v22
v_max3_f32 v148, v148, v23, v24
v_max3_f32 v148, v148, v25, v26
v_max3_f32 v148, v148, v27, v28
v_mfma_f32_32x32x16_bf16 v[32:47], a[204:207], v[204:207], v[32:47]
v_max3_f32 v148, v148, v29, v30
v_max_f32 v148, v148, v31
v_mov_b32 v149, v148
s_nop 1
v_permlane32_swap_b32 v148, v149
s_nop 1
v_mfma_f32_32x32x16_bf16 v[32:47], a[208:211], v[208:211], v[32:47]
v_max_f32 v148, v148, v149
v_sub_f32 v64, 0, v148
v_sub_f32 v65, 0, v148
v_sub_f32 v66, 0, v148
v_sub_f32 v67, 0, v148
v_mfma_f32_32x32x16_bf16 v[32:47], a[212:215], v[212:215], v[32:47]
v_sub_f32 v68, 0, v148
v_sub_f32 v69, 0, v148
v_sub_f32 v70, 0, v148
v_sub_f32 v71, 0, v148
v_sub_f32 v72, 0, v148
v_sub_f32 v73, 0, v148
v_mfma_f32_32x32x16_bf16 v[32:47], a[216:219], v[216:219], v[32:47]
v_sub_f32 v74, 0, v148
v_sub_f32 v75, 0, v148
v_sub_f32 v76, 0, v148
v_sub_f32 v77, 0, v148
v_sub_f32 v78, 0, v148
v_sub_f32 v79, 0, v148
v_mfma_f32_32x32x16_bf16 v[32:47], a[220:223], v[220:223], v[32:47]
v_sub_f32 v16, v16, v148
v_sub_f32 v17, v17, v148
v_sub_f32 v18, v18, v148
v_sub_f32 v19, v19, v148
v_sub_f32 v20, v20, v148
v_mfma_f32_32x32x16_bf16 v[48:63], a[192:195], v[224:227], 0
v_sub_f32 v21, v21, v148
v_sub_f32 v22, v22, v148
v_sub_f32 v23, v23, v148
v_sub_f32 v24, v24, v148
v_sub_f32 v25, v25, v148
v_sub_f32 v26, v26, v148
v_mfma_f32_32x32x16_bf16 v[48:63], a[196:199], v[228:231], v[48:63]
v_sub_f32 v27, v27, v148
v_sub_f32 v28, v28, v148
v_sub_f32 v29, v29, v148
v_sub_f32 v30, v30, v148
v_sub_f32 v31, v31, v148
v_mfma_f32_32x32x16_bf16 v[48:63], a[200:203], v[232:235], v[48:63]
v_mfma_f32_32x32x16_bf16 v[48:63], a[204:207], v[236:239], v[48:63]
v_max3_f32 v148, v32, v33, v34
v_max3_f32 v148, v148, v35, v36
v_max3_f32 v148, v148, v37, v38
v_max3_f32 v148, v148, v39, v40
v_max3_f32 v148, v148, v41, v42
v_max3_f32 v148, v148, v43, v44
v_mfma_f32_32x32x16_bf16 v[48:63], a[208:211], v[240:243], v[48:63]
v_max3_f32 v148, v148, v45, v46
v_max_f32 v148, v148, v47
v_mov_b32 v149, v148
s_nop 1
v_permlane32_swap_b32 v148, v149
s_nop 1
v_mfma_f32_32x32x16_bf16 v[48:63], a[212:215], v[244:247], v[48:63]
v_max_f32 v148, v148, v149
v_sub_f32 v80, 0, v148
v_sub_f32 v81, 0, v148
v_sub_f32 v82, 0, v148
v_sub_f32 v83, 0, v148
v_sub_f32 v84, 0, v148
v_mfma_f32_32x32x16_bf16 v[48:63], a[216:219], v[248:251], v[48:63]
v_sub_f32 v85, 0, v148
v_sub_f32 v86, 0, v148
v_sub_f32 v87, 0, v148
v_sub_f32 v88, 0, v148
v_sub_f32 v89, 0, v148
v_sub_f32 v90, 0, v148
v_mfma_f32_32x32x16_bf16 v[48:63], a[220:223], v[252:255], v[48:63]
v_sub_f32 v91, 0, v148
v_sub_f32 v92, 0, v148
v_sub_f32 v93, 0, v148
v_sub_f32 v94, 0, v148
v_sub_f32 v95, 0, v148
s_nop 7
v_max3_f32 v148, v48, v49, v50
v_max3_f32 v148, v148, v51, v52
v_max3_f32 v148, v148, v53, v54
v_max3_f32 v148, v148, v55, v56
v_max3_f32 v148, v148, v57, v58
v_max3_f32 v148, v148, v59, v60
v_max3_f32 v148, v148, v61, v62
v_max_f32 v148, v148, v63
v_mov_b32 v149, v148
s_nop 1
v_permlane32_swap_b32 v148, v149
s_nop 1
v_max_f32 v148, v148, v149
v_sub_f32 v96, 0, v148
v_sub_f32 v97, 0, v148
v_sub_f32 v98, 0, v148
v_sub_f32 v99, 0, v148
v_sub_f32 v100, 0, v148
v_sub_f32 v101, 0, v148
v_sub_f32 v102, 0, v148
v_sub_f32 v103, 0, v148
v_sub_f32 v104, 0, v148
v_sub_f32 v105, 0, v148
v_sub_f32 v106, 0, v148
v_sub_f32 v107, 0, v148
v_sub_f32 v108, 0, v148
v_sub_f32 v109, 0, v148
v_sub_f32 v110, 0, v148
v_sub_f32 v111, 0, v148
s_mov_b32 s40, 0
s_mul_i32 s32, s25, 589824
s_lshl_b32 s34, s3, 8
s_add_u32 s32, s32, s34
s_mul_i32 s41, s3, 147456
s_add_u32 s41, s41, s32
s_mul_i32 s33, s28, 147456
s_add_u32 s33, s33, 1024
s_and_b32 s34, s27, 1
s_lshl_b32 s34, s34, 7
s_sub_u32 s33, s33, s34
s_cmp_lg_u32 s24, 0
s_cbranch_scc1 L_enterB
s_and_b32 s34, s3, 1
s_mul_i32 s26, s34, 4352
s_add_u32 s26, s26, s50
s_lshl_b32 s43, s34, 12
s_add_u32 s47, s43, s50
s_add_u32 s45, s44, s43
s_and_b32 s45, s45, 0x3ffff
.p2align 6
L_mainA:
s_waitcnt vmcnt(8)
s_barrier
v_mfma_f32_32x32x16_bf16 a[128:143], a[224:227], v[128:131], a[128:143]
ds_read_b64_tr_b16 a[224:225], v12 offset:16896
ds_read_b64_tr_b16 a[226:227], v12 offset:18944
v_mfma_f32_32x32x16_bf16 a[144:159], a[232:235], v[128:131], a[144:159]
ds_read_b64_tr_b16 a[232:233], v13 offset:16896
ds_read_b64_tr_b16 a[234:235], v13 offset:18944
s_waitcnt vmcnt(3)
s_add_u32 m0, s26, 16896
s_nop 0
buffer_load_dwordx4 v8, s[12:15], s45 offen offset:0 nt lds
v_mfma_f32_32x32x16_bf16 a[160:175], a[240:243], v[128:131], a[160:175]
ds_read_b64_tr_b16 a[240:241], v14 offset:16896
v_exp_f32 v136, v16
v_exp_f32 v137, v17
v_exp_f32 v138, v18
v_mfma_f32_32x32x16_bf16 a[176:191], a[248:251], v[128:131], a[176:191]
ds_read_b64_tr_b16 a[242:243], v14 offset:18944
v_add_f32 v147, v136, v137
v_cvt_pk_bf16_f32 v112, v136, v137
v_exp_f32 v139, v19
v_mfma_f32_32x32x16_bf16 a[128:143], a[228:231], v[132:135], a[128:143]
ds_read_b64_tr_b16 a[248:249], v15 offset:16896
v_add_f32 v147, v147, v138
v_exp_f32 v140, v20
v_mfma_f32_32x32x16_bf16 a[144:159], a[236:239], v[132:135], a[144:159]
ds_read_b64_tr_b16 a[250:251], v15 offset:18944
v_add_f32 v147, v147, v139
v_cvt_pk_bf16_f32 v113, v138, v139
v_exp_f32 v141, v21
v_mfma_f32_32x32x16_bf16 a[160:175], a[244:247], v[132:135], a[160:175]
ds_read_b64_tr_b16 a[228:229], v12 offset:20992
v_add_f32 v147, v147, v140
v_exp_f32 v142, v22
v_add_f32 v147, v147, v141
v_cvt_pk_bf16_f32 v114, v140, v141
v_mfma_f32_32x32x16_bf16 a[176:191], a[252:255], v[132:135], a[176:191]
ds_read_b64_tr_b16 a[230:231], v12 offset:23040
s_waitcnt vmcnt(3)
s_add_u32 m0, s26, 16960
s_nop 0
buffer_load_dwordx4 v8, s[12:15], s45 offen offset:1024 nt lds
v_exp_f32 v143, v23
v_add_f32 v147, v147, v142
v_exp_f32 v136, v24
v_mfma_f32_32x32x16_bf16 v[32:47], a[192:195], v[192:195], v[80:95]
ds_read_b64_tr_b16 a[236:237], v13 offset:20992
v_add_f32 v147, v147, v143
v_cvt_pk_bf16_f32 v115, v142, v143
v_exp_f32 v137, v25
v_mfma_f32_32x32x16_bf16 v[32:47], a[196:199], v[196:199], v[32:47]
ds_read_b64_tr_b16 a[238:239], v13 offset:23040
v_add_f32 v147, v147, v136
v_exp_f32 v138, v26
v_mfma_f32_32x32x16_bf16 v[32:47], a[200:203], v[200:203], v[32:47]
ds_read_b64_tr_b16 a[244:245], v14 offset:20992
v_add_f32 v147, v147, v137
v_cvt_pk_bf16_f32 v116, v136, v137
v_exp_f32 v139, v27
v_add_f32 v147, v147, v138
v_mfma_f32_32x32x16_bf16 v[32:47], a[204:207], v[204:207], v[32:47]
ds_read_b64_tr_b16 a[246:247], v14 offset:23040
v_exp_f32 v140, v28
v_add_f32 v147, v147, v139
v_cvt_pk_bf16_f32 v117, v138, v139
v_mfma_f32_32x32x16_bf16 v[32:47], a[208:211], v[208:211], v[32:47]
ds_read_b64_tr_b16 a[252:253], v15 offset:20992
v_exp_f32 v141, v29
v_add_f32 v147, v147, v140
v_exp_f32 v142, v30
v_mfma_f32_32x32x16_bf16 v[32:47], a[212:215], v[212:215], v[32:47]
ds_read_b64_tr_b16 a[254:255], v15 offset:23040
s_waitcnt vmcnt(3)
s_add_u32 m0, s26, 17024
s_nop 0
buffer_load_dwordx4 v8, s[12:15], s45 offen offset:2048 nt lds
v_add_f32 v147, v147, v141
v_cvt_pk_bf16_f32 v118, v140, v141
v_exp_f32 v143, v31
v_mfma_f32_32x32x16_bf16 v[32:47], a[216:219], v[216:219], v[32:47]
v_add_f32 v147, v147, v142
v_add_f32 v147, v147, v143
v_cvt_pk_bf16_f32 v119, v142, v143
v_mfma_f32_32x32x16_bf16 v[32:47], a[220:223], v[220:223], v[32:47]
v_cmp_nge_f32 vcc, s46, v147
s_cbranch_vccnz L_tramp_As0a
L_back_As0a:
v_add_f32 v144, v144, v147
s_waitcnt lgkmcnt(4)
v_mfma_f32_32x32x16_bf16 a[0:15], a[224:227], v[112:115], a[0:15]
v_mfma_f32_32x32x16_bf16 a[16:31], a[232:235], v[112:115], a[16:31]
s_nop 4
v_mfma_f32_32x32x16_bf16 a[32:47], a[240:243], v[112:115], a[32:47]
v_exp_f32 v136, v32
v_exp_f32 v137, v33
v_exp_f32 v138, v34
v_mfma_f32_32x32x16_bf16 a[48:63], a[248:251], v[112:115], a[48:63]
s_waitcnt vmcnt(3)
s_add_u32 m0, s26, 17088
s_nop 0
buffer_load_dwordx4 v8, s[12:15], s45 offen offset:3072 nt lds
v_add_f32 v147, v136, v137
v_cvt_pk_bf16_f32 v120, v136, v137
v_exp_f32 v139, v35
v_mfma_f32_32x32x16_bf16 a[0:15], a[228:231], v[116:119], a[0:15]
v_add_f32 v147, v147, v138
v_exp_f32 v140, v36
v_mfma_f32_32x32x16_bf16 a[16:31], a[236:239], v[116:119], a[16:31]
v_add_f32 v147, v147, v139
v_cvt_pk_bf16_f32 v121, v138, v139
v_exp_f32 v141, v37
s_waitcnt lgkmcnt(0)
v_mfma_f32_32x32x16_bf16 a[32:47], a[244:247], v[116:119], a[32:47]
v_add_f32 v147, v147, v140
v_exp_f32 v142, v38
v_add_f32 v147, v147, v141
v_cvt_pk_bf16_f32 v122, v140, v141
v_mfma_f32_32x32x16_bf16 a[48:63], a[252:255], v[116:119], a[48:63]
v_exp_f32 v143, v39
v_add_f32 v147, v147, v142
v_exp_f32 v136, v40
v_mfma_f32_32x32x16_bf16 v[48:63], a[192:195], v[224:227], v[96:111]
v_add_f32 v147, v147, v143
v_cvt_pk_bf16_f32 v123, v142, v143
v_exp_f32 v137, v41
v_mfma_f32_32x32x16_bf16 v[48:63], a[196:199], v[228:231], v[48:63]
v_add_f32 v147, v147, v136
v_exp_f32 v138, v42
v_mfma_f32_32x32x16_bf16 v[48:63], a[200:203], v[232:235], v[48:63]
v_add_f32 v147, v147, v137
v_cvt_pk_bf16_f32 v124, v136, v137
v_exp_f32 v139, v43
v_add_f32 v147, v147, v138
v_mfma_f32_32x32x16_bf16 v[48:63], a[204:207], v[236:239], v[48:63]
v_exp_f32 v140, v44
v_add_f32 v147, v147, v139
v_cvt_pk_bf16_f32 v125, v138, v139
v_mfma_f32_32x32x16_bf16 v[48:63], a[208:211], v[240:243], v[48:63]
v_exp_f32 v141, v45
v_add_f32 v147, v147, v140
v_exp_f32 v142, v46
v_mfma_f32_32x32x16_bf16 v[48:63], a[212:215], v[244:247], v[48:63]
v_add_f32 v147, v147, v141
v_cvt_pk_bf16_f32 v126, v140, v141
v_exp_f32 v143, v47
v_mfma_f32_32x32x16_bf16 v[48:63], a[216:219], v[248:251], v[48:63]
v_add_f32 v147, v147, v142
v_add_f32 v147, v147, v143
v_cvt_pk_bf16_f32 v127, v142, v143
v_mfma_f32_32x32x16_bf16 v[48:63], a[220:223], v[252:255], v[48:63]
v_cmp_nge_f32 vcc, s46, v147
s_cbranch_vccnz L_tramp_As0b
L_back_As0b:
v_add_f32 v145, v145, v147
s_waitcnt vmcnt(8)
s_barrier
v_mfma_f32_32x32x16_bf16 a[64:79], a[224:227], v[120:123], a[64:79]
ds_read_b128 a[192:195], v10 offset:34816
ds_read_b128 a[196:199], v11 offset:34816
ds_read_b128 a[200:203], v10 offset:34880
ds_read_b128 a[204:207], v11 offset:34880
v_mfma_f32_32x32x16_bf16 a[80:95], a[232:235], v[120:123], a[80:95]
ds_read_b128 a[208:211], v10 offset:34944
ds_read_b128 a[212:215], v11 offset:34944
ds_read_b128 a[216:219], v10 offset:35008
ds_read_b128 a[220:223], v11 offset:35008
v_mfma_f32_32x32x16_bf16 a[96:111], a[240:243], v[120:123], a[96:111]
s_waitcnt vmcnt(5)
s_add_u32 m0, s47, 25600
s_nop 0
buffer_load_dwordx4 v9, s[16:19], s45 offen offset:0 nt lds
v_exp_f32 v136, v48
v_exp_f32 v137, v49
v_exp_f32 v138, v50
v_mfma_f32_32x32x16_bf16 a[112:127], a[248:251], v[120:123], a[112:127]
v_add_f32 v147, v136, v137
v_cvt_pk_bf16_f32 v128, v136, v137
v_exp_f32 v139, v51
v_mfma_f32_32x32x16_bf16 a[64:79], a[228:231], v[124:127], a[64:79]
v_add_f32 v147, v147, v138
v_exp_f32 v140, v52
v_mfma_f32_32x32x16_bf16 a[80:95], a[236:239], v[124:127], a[80:95]
v_add_f32 v147, v147, v139
v_cvt_pk_bf16_f32 v129, v138, v139
v_exp_f32 v141, v53
v_mfma_f32_32x32x16_bf16 a[96:111], a[244:247], v[124:127], a[96:111]
s_waitcnt vmcnt(5)
buffer_load_dwordx4 v9, s[16:19], s45 offen offset:1024 nt lds
v_add_f32 v147, v147, v140
v_exp_f32 v142, v54
v_add_f32 v147, v147, v141
v_cvt_pk_bf16_f32 v130, v140, v141
v_mfma_f32_32x32x16_bf16 a[112:127], a[252:255], v[124:127], a[112:127]
v_exp_f32 v143, v55
v_add_f32 v147, v147, v142
v_exp_f32 v136, v56
s_waitcnt lgkmcnt(0)
v_mfma_f32_32x32x16_bf16 v[16:31], a[192:195], v[160:163], v[64:79]
v_add_f32 v147, v147, v143
v_cvt_pk_bf16_f32 v131, v142, v143
v_exp_f32 v137, v57
v_mfma_f32_32x32x16_bf16 v[16:31], a[196:199], v[164:167], v[16:31]
v_add_f32 v147, v147, v136
v_exp_f32 v138, v58
v_mfma_f32_32x32x16_bf16 v[16:31], a[200:203], v[168:171], v[16:31]
s_waitcnt vmcnt(5)
buffer_load_dwordx4 v9, s[16:19], s45 offen offset:2048 nt lds
v_add_f32 v147, v147, v137
v_cvt_pk_bf16_f32 v132, v136, v137
v_exp_f32 v139, v59
v_add_f32 v147, v147, v138
v_mfma_f32_32x32x16_bf16 v[16:31], a[204:207], v[172:175], v[16:31]
v_exp_f32 v140, v60
v_add_f32 v147, v147, v139
v_cvt_pk_bf16_f32 v133, v138, v139
v_mfma_f32_32x32x16_bf16 v[16:31], a[208:211], v[176:179], v[16:31]
v_exp_f32 v141, v61
v_add_f32 v147, v147, v140
v_exp_f32 v142, v62
v_mfma_f32_32x32x16_bf16 v[16:31], a[212:215], v[180:183], v[16:31]
v_add_f32 v147, v147, v141
v_cvt_pk_bf16_f32 v134, v140, v141
v_exp_f32 v143, v63
v_mfma_f32_32x32x16_bf16 v[16:31], a[216:219], v[184:187], v[16:31]
s_waitcnt vmcnt(5)
buffer_load_dwordx4 v9, s[16:19], s45 offen offset:3072 nt lds
v_add_f32 v147, v147, v142
v_add_f32 v147, v147, v143
v_cvt_pk_bf16_f32 v135, v142, v143
v_mfma_f32_32x32x16_bf16 v[16:31], a[220:223], v[188:191], v[16:31]
s_add_u32 s44, s44, 8192
s_and_b32 s44, s44, 0x3ffff
s_add_u32 s45, s44, s43
s_and_b32 s45, s45, 0x3ffff
v_cmp_nge_f32 vcc, s46, v147
s_cbranch_vccnz L_tramp_As0c
L_back_As0c:
v_add_f32 v146, v146, v147
s_waitcnt vmcnt(8)
s_barrier
v_mfma_f32_32x32x16_bf16 a[128:143], a[224:227], v[128:131], a[128:143]
ds_read_b64_tr_b16 a[224:225], v12 offset:34816
ds_read_b64_tr_b16 a[226:227], v12 offset:36864
v_mfma_f32_32x32x16_bf16 a[144:159], a[232:235], v[128:131], a[144:159]
ds_read_b64_tr_b16 a[232:233], v13 offset:34816
ds_read_b64_tr_b16 a[234:235], v13 offset:36864
s_waitcnt vmcnt(3)
s_add_u32 m0, s26, 34816
s_nop 0
buffer_load_dwordx4 v8, s[12:15], s45 offen offset:0 nt lds
v_mfma_f32_32x32x16_bf16 a[160:175], a[240:243], v[128:131], a[160:175]
ds_read_b64_tr_b16 a[240:241], v14 offset:34816
v_exp_f32 v136, v16
v_exp_f32 v137, v17
v_exp_f32 v138, v18
v_mfma_f32_32x32x16_bf16 a[176:191], a[248:251], v[128:131], a[176:191]
ds_read_b64_tr_b16 a[242:243], v14 offset:36864
v_add_f32 v147, v136, v137
v_cvt_pk_bf16_f32 v112, v136, v137
v_exp_f32 v139, v19
v_mfma_f32_32x32x16_bf16 a[128:143], a[228:231], v[132:135], a[128:143]
ds_read_b64_tr_b16 a[248:249], v15 offset:34816
v_add_f32 v147, v147, v138
v_exp_f32 v140, v20
v_mfma_f32_32x32x16_bf16 a[144:159], a[236:239], v[132:135], a[144:159]
ds_read_b64_tr_b16 a[250:251], v15 offset:36864
v_add_f32 v147, v147, v139
v_cvt_pk_bf16_f32 v113, v138, v139
v_exp_f32 v141, v21
v_mfma_f32_32x32x16_bf16 a[160:175], a[244:247], v[132:135], a[160:175]
ds_read_b64_tr_b16 a[228:229], v12 offset:38912
v_add_f32 v147, v147, v140
v_exp_f32 v142, v22
v_add_f32 v147, v147, v141
v_cvt_pk_bf16_f32 v114, v140, v141
v_mfma_f32_32x32x16_bf16 a[176:191], a[252:255], v[132:135], a[176:191]
ds_read_b64_tr_b16 a[230:231], v12 offset:40960
s_waitcnt vmcnt(3)
s_add_u32 m0, s26, 34880
s_nop 0
buffer_load_dwordx4 v8, s[12:15], s45 offen offset:1024 nt lds
v_exp_f32 v143, v23
v_add_f32 v147, v147, v142
v_exp_f32 v136, v24
v_mfma_f32_32x32x16_bf16 v[32:47], a[192:195], v[192:195], v[80:95]
ds_read_b64_tr_b16 a[236:237], v13 offset:38912
v_add_f32 v147, v147, v143
v_cvt_pk_bf16_f32 v115, v142, v143
v_exp_f32 v137, v25
v_mfma_f32_32x32x16_bf16 v[32:47], a[196:199], v[196:199], v[32:47]
ds_read_b64_tr_b16 a[238:239], v13 offset:40960
v_add_f32 v147, v147, v136
v_exp_f32 v138, v26
v_mfma_f32_32x32x16_bf16 v[32:47], a[200:203], v[200:203], v[32:47]
ds_read_b64_tr_b16 a[244:245], v14 offset:38912
v_add_f32 v147, v147, v137
v_cvt_pk_bf16_f32 v116, v136, v137
v_exp_f32 v139, v27
v_add_f32 v147, v147, v138
v_mfma_f32_32x32x16_bf16 v[32:47], a[204:207], v[204:207], v[32:47]
ds_read_b64_tr_b16 a[246:247], v14 offset:40960
v_exp_f32 v140, v28
v_add_f32 v147, v147, v139
v_cvt_pk_bf16_f32 v117, v138, v139
v_mfma_f32_32x32x16_bf16 v[32:47], a[208:211], v[208:211], v[32:47]
ds_read_b64_tr_b16 a[252:253], v15 offset:38912
v_exp_f32 v141, v29
v_add_f32 v147, v147, v140
v_exp_f32 v142, v30
v_mfma_f32_32x32x16_bf16 v[32:47], a[212:215], v[212:215], v[32:47]
ds_read_b64_tr_b16 a[254:255], v15 offset:40960
s_waitcnt vmcnt(3)
s_add_u32 m0, s26, 34944
s_nop 0
buffer_load_dwordx4 v8, s[12:15], s45 offen offset:2048 nt lds
v_add_f32 v147, v147, v141
v_cvt_pk_bf16_f32 v118, v140, v141
v_exp_f32 v143, v31
v_mfma_f32_32x32x16_bf16 v[32:47], a[216:219], v[216:219], v[32:47]
v_add_f32 v147, v147, v142
v_add_f32 v147, v147, v143
v_cvt_pk_bf16_f32 v119, v142, v143
v_mfma_f32_32x32x16_bf16 v[32:47], a[220:223], v[220:223], v[32:47]
v_cmp_nge_f32 vcc, s46, v147
s_cbranch_vccnz L_tramp_As1a
L_back_As1a:
v_add_f32 v144, v144, v147
s_waitcnt lgkmcnt(4)
v_mfma_f32_32x32x16_bf16 a[0:15], a[224:227], v[112:115], a[0:15]
v_mfma_f32_32x32x16_bf16 a[16:31], a[232:235], v[112:115], a[16:31]
s_nop 4
v_mfma_f32_32x32x16_bf16 a[32:47], a[240:243], v[112:115], a[32:47]
v_exp_f32 v136, v32
v_exp_f32 v137, v33
v_exp_f32 v138, v34
v_mfma_f32_32x32x16_bf16 a[48:63], a[248:251], v[112:115], a[48:63]
s_waitcnt vmcnt(3)
s_add_u32 m0, s26, 35008
s_nop 0
buffer_load_dwordx4 v8, s[12:15], s45 offen offset:3072 nt lds
v_add_f32 v147, v136, v137
v_cvt_pk_bf16_f32 v120, v136, v137
v_exp_f32 v139, v35
v_mfma_f32_32x32x16_bf16 a[0:15], a[228:231], v[116:119], a[0:15]
v_add_f32 v147, v147, v138
v_exp_f32 v140, v36
v_mfma_f32_32x32x16_bf16 a[16:31], a[236:239], v[116:119], a[16:31]
v_add_f32 v147, v147, v139
v_cvt_pk_bf16_f32 v121, v138, v139
v_exp_f32 v141, v37
s_waitcnt lgkmcnt(0)
v_mfma_f32_32x32x16_bf16 a[32:47], a[244:247], v[116:119], a[32:47]
v_add_f32 v147, v147, v140
v_exp_f32 v142, v38
v_add_f32 v147, v147, v141
v_cvt_pk_bf16_f32 v122, v140, v141
v_mfma_f32_32x32x16_bf16 a[48:63], a[252:255], v[116:119], a[48:63]
v_exp_f32 v143, v39
v_add_f32 v147, v147, v142
v_exp_f32 v136, v40
v_mfma_f32_32x32x16_bf16 v[48:63], a[192:195], v[224:227], v[96:111]
v_add_f32 v147, v147, v143
v_cvt_pk_bf16_f32 v123, v142, v143
v_exp_f32 v137, v41
v_mfma_f32_32x32x16_bf16 v[48:63], a[196:199], v[228:231], v[48:63]
v_add_f32 v147, v147, v136
v_exp_f32 v138, v42
v_mfma_f32_32x32x16_bf16 v[48:63], a[200:203], v[232:235], v[48:63]
v_add_f32 v147, v147, v137
v_cvt_pk_bf16_f32 v124, v136, v137
v_exp_f32 v139, v43
v_add_f32 v147, v147, v138
v_mfma_f32_32x32x16_bf16 v[48:63], a[204:207], v[236:239], v[48:63]
v_exp_f32 v140, v44
v_add_f32 v147, v147, v139
v_cvt_pk_bf16_f32 v125, v138, v139
v_mfma_f32_32x32x16_bf16 v[48:63], a[208:211], v[240:243], v[48:63]
v_exp_f32 v141, v45
v_add_f32 v147, v147, v140
v_exp_f32 v142, v46
v_mfma_f32_32x32x16_bf16 v[48:63], a[212:215], v[244:247], v[48:63]
v_add_f32 v147, v147, v141
v_cvt_pk_bf16_f32 v126, v140, v141
v_exp_f32 v143, v47
v_mfma_f32_32x32x16_bf16 v[48:63], a[216:219], v[248:251], v[48:63]
v_add_f32 v147, v147, v142
v_add_f32 v147, v147, v143
v_cvt_pk_bf16_f32 v127, v142, v143
v_mfma_f32_32x32x16_bf16 v[48:63], a[220:223], v[252:255], v[48:63]
v_cmp_nge_f32 vcc, s46, v147
s_cbranch_vccnz L_tramp_As1b
L_back_As1b:
v_add_f32 v145, v145, v147
s_waitcnt vmcnt(8)
s_barrier
v_mfma_f32_32x32x16_bf16 a[64:79], a[224:227], v[120:123], a[64:79]
ds_read_b128 a[192:195], v10 offset:16896
ds_read_b128 a[196:199], v11 offset:16896
ds_read_b128 a[200:203], v10 offset:16960
ds_read_b128 a[204:207], v11 offset:16960
v_mfma_f32_32x32x16_bf16 a[80:95], a[232:235], v[120:123], a[80:95]
ds_read_b128 a[208:211], v10 offset:17024
ds_read_b128 a[212:215], v11 offset:17024
ds_read_b128 a[216:219], v10 offset:17088
ds_read_b128 a[220:223], v11 offset:17088
v_mfma_f32_32x32x16_bf16 a[96:111], a[240:243], v[120:123], a[96:111]
s_waitcnt vmcnt(5)
s_add_u32 m0, s47, 43520
s_nop 0
buffer_load_dwordx4 v9, s[16:19], s45 offen offset:0 nt lds
v_exp_f32 v136, v48
v_exp_f32 v137, v49
v_exp_f32 v138, v50
v_mfma_f32_32x32x16_bf16 a[112:127], a[248:251], v[120:123], a[112:127]
v_add_f32 v147, v136, v137
v_cvt_pk_bf16_f32 v128, v136, v137
v_exp_f32 v139, v51
v_mfma_f32_32x32x16_bf16 a[64:79], a[228:231], v[124:127], a[64:79]
v_add_f32 v147, v147, v138
v_exp_f32 v140, v52
v_mfma_f32_32x32x16_bf16 a[80:95], a[236:239], v[124:127], a[80:95]
v_add_f32 v147, v147, v139
v_cvt_pk_bf16_f32 v129, v138, v139
v_exp_f32 v141, v53
v_mfma_f32_32x32x16_bf16 a[96:111], a[244:247], v[124:127], a[96:111]
s_waitcnt vmcnt(5)
buffer_load_dwordx4 v9, s[16:19], s45 offen offset:1024 nt lds
v_add_f32 v147, v147, v140
v_exp_f32 v142, v54
v_add_f32 v147, v147, v141
v_cvt_pk_bf16_f32 v130, v140, v141
v_mfma_f32_32x32x16_bf16 a[112:127], a[252:255], v[124:127], a[112:127]
v_exp_f32 v143, v55
v_add_f32 v147, v147, v142
v_exp_f32 v136, v56
s_waitcnt lgkmcnt(0)
v_mfma_f32_32x32x16_bf16 v[16:31], a[192:195], v[160:163], v[64:79]
v_add_f32 v147, v147, v143
v_cvt_pk_bf16_f32 v131, v142, v143
v_exp_f32 v137, v57
v_mfma_f32_32x32x16_bf16 v[16:31], a[196:199], v[164:167], v[16:31]
v_add_f32 v147, v147, v136
v_exp_f32 v138, v58
v_mfma_f32_32x32x16_bf16 v[16:31], a[200:203], v[168:171], v[16:31]
s_waitcnt vmcnt(5)
buffer_load_dwordx4 v9, s[16:19], s45 offen offset:2048 nt lds
v_add_f32 v147, v147, v137
v_cvt_pk_bf16_f32 v132, v136, v137
v_exp_f32 v139, v59
v_add_f32 v147, v147, v138
v_mfma_f32_32x32x16_bf16 v[16:31], a[204:207], v[172:175], v[16:31]
v_exp_f32 v140, v60
v_add_f32 v147, v147, v139
v_cvt_pk_bf16_f32 v133, v138, v139
v_mfma_f32_32x32x16_bf16 v[16:31], a[208:211], v[176:179], v[16:31]
v_exp_f32 v141, v61
v_add_f32 v147, v147, v140
v_exp_f32 v142, v62
v_mfma_f32_32x32x16_bf16 v[16:31], a[212:215], v[180:183], v[16:31]
v_add_f32 v147, v147, v141
v_cvt_pk_bf16_f32 v134, v140, v141
v_exp_f32 v143, v63
v_mfma_f32_32x32x16_bf16 v[16:31], a[216:219], v[184:187], v[16:31]
s_waitcnt vmcnt(5)
buffer_load_dwordx4 v9, s[16:19], s45 offen offset:3072 nt lds
v_add_f32 v147, v147, v142
v_add_f32 v147, v147, v143
v_cvt_pk_bf16_f32 v135, v142, v143
v_mfma_f32_32x32x16_bf16 v[16:31], a[220:223], v[188:191], v[16:31]
s_add_u32 s44, s44, 8192
s_and_b32 s44, s44, 0x3ffff
s_add_u32 s45, s44, s43
s_and_b32 s45, s45, 0x3ffff
v_cmp_nge_f32 vcc, s46, v147
s_cbranch_vccnz L_tramp_As1c
L_back_As1c:
v_add_f32 v146, v146, v147
s_add_u32 s40, s40, 1
s_cmp_lt_u32 s40, 15
s_cbranch_scc1 L_mainA
s_waitcnt vmcnt(8)
s_barrier
v_mfma_f32_32x32x16_bf16 a[128:143], a[224:227], v[128:131], a[128:143]
ds_read_b64_tr_b16 a[224:225], v12 offset:16896
ds_read_b64_tr_b16 a[226:227], v12 offset:18944
v_mfma_f32_32x32x16_bf16 a[144:159], a[232:235], v[128:131], a[144:159]
ds_read_b64_tr_b16 a[232:233], v13 offset:16896
ds_read_b64_tr_b16 a[234:235], v13 offset:18944
v_mfma_f32_32x32x16_bf16 a[160:175], a[240:243], v[128:131], a[160:175]
ds_read_b64_tr_b16 a[240:241], v14 offset:16896
v_exp_f32 v136, v16
v_exp_f32 v137, v17
v_exp_f32 v138, v18
v_mfma_f32_32x32x16_bf16 a[176:191], a[248:251], v[128:131], a[176:191]
ds_read_b64_tr_b16 a[242:243], v14 offset:18944
s_lshr_b32 s29, s27, 1
s_mul_i32 s29, s29, 3
s_lshr_b32 s29, s29, 1
s_lshl_b32 s42, s3, 2
s_add_u32 s42, s42, 4
v_add_f32 v147, v136, v137
v_cvt_pk_bf16_f32 v112, v136, v137
v_exp_f32 v139, v19
v_mfma_f32_32x32x16_bf16 a[128:143], a[228:231], v[132:135], a[128:143]
ds_read_b64_tr_b16 a[248:249], v15 offset:16896
s_add_u32 s35, s29, s42
s_and_b32 s35, s35, 15
s_add_u32 s29, s29, 1
s_cmp_eq_u32 s29, 12
s_cselect_b32 s29, 0, s29
v_add_f32 v147, v147, v138
v_exp_f32 v140, v20
v_mfma_f32_32x32x16_bf16 a[144:159], a[236:239], v[132:135], a[144:159]
ds_read_b64_tr_b16 a[250:251], v15 offset:18944
s_mul_i32 s64, s35, 36864
s_add_u32 s64, s64, s32
s_lshr_b32 s34, s35, 2
s_and_b32 s35, s35, 3
s_mul_i32 s76, s34, 34816
v_add_f32 v147, v147, v139
v_cvt_pk_bf16_f32 v113, v138, v139
v_exp_f32 v141, v21
v_mfma_f32_32x32x16_bf16 a[160:175], a[244:247], v[132:135], a[160:175]
ds_read_b64_tr_b16 a[228:229], v12 offset:20992
s_mul_i32 s37, s35, 6144
s_add_u32 s76, s76, s37
s_mul_i32 s34, s34, 6144
s_add_u32 s34, s34, 139264
s_cmp_eq_u32 s35, 3
s_cselect_b32 s76, s34, s76
v_add_f32 v147, v147, v140
v_exp_f32 v142, v22
v_add_f32 v147, v147, v141
v_cvt_pk_bf16_f32 v114, v140, v141
v_mfma_f32_32x32x16_bf16 a[176:191], a[252:255], v[132:135], a[176:191]
ds_read_b64_tr_b16 a[230:231], v12 offset:23040
s_add_u32 s35, s29, s42
s_and_b32 s35, s35, 15
s_add_u32 s29, s29, 1
s_cmp_eq_u32 s29, 12
s_cselect_b32 s29, 0, s29
v_exp_f32 v143, v23
v_add_f32 v147, v147, v142
v_exp_f32 v136, v24
v_mfma_f32_32x32x16_bf16 v[32:47], a[192:195], v[192:195], v[80:95]
ds_read_b64_tr_b16 a[236:237], v13 offset:20992
s_mul_i32 s65, s35, 36864
s_add_u32 s65, s65, s32
s_lshr_b32 s34, s35, 2
s_and_b32 s35, s35, 3
s_mul_i32 s77, s34, 34816
v_add_f32 v147, v147, v143
v_cvt_pk_bf16_f32 v115, v142, v143
v_exp_f32 v137, v25
v_mfma_f32_32x32x16_bf16 v[32:47], a[196:199], v[196:199], v[32:47]
ds_read_b64_tr_b16 a[238:239], v13 offset:23040
s_mul_i32 s37, s35, 6144
s_add_u32 s77, s77, s37
s_mul_i32 s34, s34, 6144
s_add_u32 s34, s34, 139264
s_cmp_eq_u32 s35, 3
s_cselect_b32 s77, s34, s77
v_add_f32 v147, v147, v136
v_exp_f32 v138, v26
v_mfma_f32_32x32x16_bf16 v[32:47], a[200:203], v[200:203], v[32:47]
ds_read_b64_tr_b16 a[244:245], v14 offset:20992
s_add_u32 s35, s29, s42
s_and_b32 s35, s35, 15
s_add_u32 s29, s29, 1
s_cmp_eq_u32 s29, 12
s_cselect_b32 s29, 0, s29
v_add_f32 v147, v147, v137
v_cvt_pk_bf16_f32 v116, v136, v137
v_exp_f32 v139, v27
v_add_f32 v147, v147, v138
v_mfma_f32_32x32x16_bf16 v[32:47], a[204:207], v[204:207], v[32:47]
ds_read_b64_tr_b16 a[246:247], v14 offset:23040
s_mul_i32 s66, s35, 36864
s_add_u32 s66, s66, s32
s_lshr_b32 s34, s35, 2
s_and_b32 s35, s35, 3
s_mul_i32 s78, s34, 34816
v_exp_f32 v140, v28
v_add_f32 v147, v147, v139
v_cvt_pk_bf16_f32 v117, v138, v139
v_mfma_f32_32x32x16_bf16 v[32:47], a[208:211], v[208:211], v[32:47]
ds_read_b64_tr_b16 a[252:253], v15 offset:20992
s_mul_i32 s37, s35, 6144
s_add_u32 s78, s78, s37
s_mul_i32 s34, s34, 6144
s_add_u32 s34, s34, 139264
s_cmp_eq_u32 s35, 3
s_cselect_b32 s78, s34, s78
v_exp_f32 v141, v29
v_add_f32 v147, v147, v140
v_exp_f32 v142, v30
v_mfma_f32_32x32x16_bf16 v[32:47], a[212:215], v[212:215], v[32:47]
ds_read_b64_tr_b16 a[254:255], v15 offset:23040
s_add_u32 s35, s29, s42
s_and_b32 s35, s35, 15
s_add_u32 s29, s29, 1
s_cmp_eq_u32 s29, 12
s_cselect_b32 s29, 0, s29
v_add_f32 v147, v147, v141
v_cvt_pk_bf16_f32 v118, v140, v141
v_exp_f32 v143, v31
v_mfma_f32_32x32x16_bf16 v[32:47], a[216:219], v[216:219], v[32:47]
s_mul_i32 s67, s35, 36864
s_add_u32 s67, s67, s32
s_lshr_b32 s34, s35, 2
s_and_b32 s35, s35, 3
s_mul_i32 s79, s34, 34816
v_add_f32 v147, v147, v142
v_add_f32 v147, v147, v143
v_cvt_pk_bf16_f32 v119, v142, v143
v_mfma_f32_32x32x16_bf16 v[32:47], a[220:223], v[220:223], v[32:47]
s_mul_i32 s37, s35, 6144
s_add_u32 s79, s79, s37
s_mul_i32 s34, s34, 6144
s_add_u32 s34, s34, 139264
s_cmp_eq_u32 s35, 3
s_cselect_b32 s79, s34, s79
v_cmp_nge_f32 vcc, s46, v147
s_cbranch_vccnz L_tramp_Ap0a
L_back_Ap0a:
v_add_f32 v144, v144, v147
s_waitcnt lgkmcnt(4)
v_mfma_f32_32x32x16_bf16 a[0:15], a[224:227], v[112:115], a[0:15]
s_add_u32 s35, s29, s42
s_and_b32 s35, s35, 15
s_add_u32 s29, s29, 1
s_cmp_eq_u32 s29, 12
s_cselect_b32 s29, 0, s29
v_mfma_f32_32x32x16_bf16 a[16:31], a[232:235], v[112:115], a[16:31]
s_mul_i32 s68, s35, 36864
s_add_u32 s68, s68, s32
s_lshr_b32 s34, s35, 2
s_and_b32 s35, s35, 3
s_mul_i32 s80, s34, 34816
v_mfma_f32_32x32x16_bf16 a[32:47], a[240:243], v[112:115], a[32:47]
s_mul_i32 s37, s35, 6144
s_add_u32 s80, s80, s37
s_mul_i32 s34, s34, 6144
s_add_u32 s34, s34, 139264
s_cmp_eq_u32 s35, 3
s_cselect_b32 s80, s34, s80
v_exp_f32 v136, v32
v_exp_f32 v137, v33
v_exp_f32 v138, v34
v_mfma_f32_32x32x16_bf16 a[48:63], a[248:251], v[112:115], a[48:63]
s_add_u32 s35, s29, s42
s_and_b32 s35, s35, 15
s_add_u32 s29, s29, 1
s_cmp_eq_u32 s29, 12
s_cselect_b32 s29, 0, s29
v_add_f32 v147, v136, v137
v_cvt_pk_bf16_f32 v120, v136, v137
v_exp_f32 v139, v35
v_mfma_f32_32x32x16_bf16 a[0:15], a[228:231], v[116:119], a[0:15]
s_mul_i32 s69, s35, 36864
s_add_u32 s69, s69, s32
s_lshr_b32 s34, s35, 2
s_and_b32 s35, s35, 3
s_mul_i32 s81, s34, 34816
v_add_f32 v147, v147, v138
v_exp_f32 v140, v36
v_mfma_f32_32x32x16_bf16 a[16:31], a[236:239], v[116:119], a[16:31]
s_mul_i32 s37, s35, 6144
s_add_u32 s81, s81, s37
s_mul_i32 s34, s34, 6144
s_add_u32 s34, s34, 139264
s_cmp_eq_u32 s35, 3
s_cselect_b32 s81, s34, s81
v_add_f32 v147, v147, v139
v_cvt_pk_bf16_f32 v121, v138, v139
v_exp_f32 v141, v37
s_waitcnt lgkmcnt(0)
v_mfma_f32_32x32x16_bf16 a[32:47], a[244:247], v[116:119], a[32:47]
s_add_u32 s35, s29, s42
s_and_b32 s35, s35, 15
s_add_u32 s29, s29, 1
s_cmp_eq_u32 s29, 12
s_cselect_b32 s29, 0, s29
v_add_f32 v147, v147, v140
v_exp_f32 v142, v38
v_add_f32 v147, v147, v141
v_cvt_pk_bf16_f32 v122, v140, v141
v_mfma_f32_32x32x16_bf16 a[48:63], a[252:255], v[116:119], a[48:63]
s_mul_i32 s70, s35, 36864
s_add_u32 s70, s70, s32
s_lshr_b32 s34, s35, 2
s_and_b32 s35, s35, 3
s_mul_i32 s82, s34, 34816
v_exp_f32 v143, v39
v_add_f32 v147, v147, v142
v_exp_f32 v136, v40
v_mfma_f32_32x32x16_bf16 v[48:63], a[192:195], v[224:227], v[96:111]
s_mul_i32 s37, s35, 6144
s_add_u32 s82, s82, s37
s_mul_i32 s34, s34, 6144
s_add_u32 s34, s34, 139264
s_cmp_eq_u32 s35, 3
s_cselect_b32 s82, s34, s82
v_add_f32 v147, v147, v143
v_cvt_pk_bf16_f32 v123, v142, v143
v_exp_f32 v137, v41
v_mfma_f32_32x32x16_bf16 v[48:63], a[196:199], v[228:231], v[48:63]
s_add_u32 s35, s29, s42
s_and_b32 s35, s35, 15
s_add_u32 s29, s29, 1
s_cmp_eq_u32 s29, 12
s_cselect_b32 s29, 0, s29
v_add_f32 v147, v147, v136
v_exp_f32 v138, v42
v_mfma_f32_32x32x16_bf16 v[48:63], a[200:203], v[232:235], v[48:63]
s_mul_i32 s71, s35, 36864
s_add_u32 s71, s71, s32
s_lshr_b32 s34, s35, 2
s_and_b32 s35, s35, 3
s_mul_i32 s83, s34, 34816
v_add_f32 v147, v147, v137
v_cvt_pk_bf16_f32 v124, v136, v137
v_exp_f32 v139, v43
v_add_f32 v147, v147, v138
v_mfma_f32_32x32x16_bf16 v[48:63], a[204:207], v[236:239], v[48:63]
s_mul_i32 s37, s35, 6144
s_add_u32 s83, s83, s37
s_mul_i32 s34, s34, 6144
s_add_u32 s34, s34, 139264
s_cmp_eq_u32 s35, 3
s_cselect_b32 s83, s34, s83
v_exp_f32 v140, v44
v_add_f32 v147, v147, v139
v_cvt_pk_bf16_f32 v125, v138, v139
v_mfma_f32_32x32x16_bf16 v[48:63], a[208:211], v[240:243], v[48:63]
s_add_u32 s35, s29, s42
s_and_b32 s35, s35, 15
s_add_u32 s29, s29, 1
s_cmp_eq_u32 s29, 12
s_cselect_b32 s29, 0, s29
v_exp_f32 v141, v45
v_add_f32 v147, v147, v140
v_exp_f32 v142, v46
v_mfma_f32_32x32x16_bf16 v[48:63], a[212:215], v[244:247], v[48:63]
s_mul_i32 s72, s35, 36864
s_add_u32 s72, s72, s32
s_lshr_b32 s34, s35, 2
s_and_b32 s35, s35, 3
s_mul_i32 s8, s34, 34816
v_add_f32 v147, v147, v141
v_cvt_pk_bf16_f32 v126, v140, v141
v_exp_f32 v143, v47
v_mfma_f32_32x32x16_bf16 v[48:63], a[216:219], v[248:251], v[48:63]
s_mul_i32 s37, s35, 6144
s_add_u32 s8, s8, s37
s_mul_i32 s34, s34, 6144
s_add_u32 s34, s34, 139264
s_cmp_eq_u32 s35, 3
s_cselect_b32 s8, s34, s8
v_add_f32 v147, v147, v142
v_add_f32 v147, v147, v143
v_cvt_pk_bf16_f32 v127, v142, v143
v_mfma_f32_32x32x16_bf16 v[48:63], a[220:223], v[252:255], v[48:63]
s_add_u32 s35, s29, s42
s_and_b32 s35, s35, 15
s_add_u32 s29, s29, 1
s_cmp_eq_u32 s29, 12
s_cselect_b32 s29, 0, s29
v_cmp_nge_f32 vcc, s46, v147
s_cbranch_vccnz L_tramp_Ap0b
L_back_Ap0b:
v_add_f32 v145, v145, v147
s_waitcnt vmcnt(4)
s_barrier
v_mfma_f32_32x32x16_bf16 a[64:79], a[224:227], v[120:123], a[64:79]
ds_read_b128 a[192:195], v10 offset:34816
ds_read_b128 a[196:199], v11 offset:34816
ds_read_b128 a[200:203], v10 offset:34880
ds_read_b128 a[204:207], v11 offset:34880
s_mul_i32 s73, s35, 36864
s_add_u32 s73, s73, s32
s_lshr_b32 s34, s35, 2
s_and_b32 s35, s35, 3
s_mul_i32 s9, s34, 34816
v_mfma_f32_32x32x16_bf16 a[80:95], a[232:235], v[120:123], a[80:95]
ds_read_b128 a[208:211], v10 offset:34944
ds_read_b128 a[212:215], v11 offset:34944
ds_read_b128 a[216:219], v10 offset:35008
ds_read_b128 a[220:223], v11 offset:35008
s_mul_i32 s37, s35, 6144
s_add_u32 s9, s9, s37
s_mul_i32 s34, s34, 6144
s_add_u32 s34, s34, 139264
s_cmp_eq_u32 s35, 3
s_cselect_b32 s9, s34, s9
v_mfma_f32_32x32x16_bf16 a[96:111], a[240:243], v[120:123], a[96:111]
s_add_u32 s35, s29, s42
s_and_b32 s35, s35, 15
s_add_u32 s29, s29, 1
s_cmp_eq_u32 s29, 12
s_cselect_b32 s29, 0, s29
v_exp_f32 v136, v48
v_exp_f32 v137, v49
v_exp_f32 v138, v50
v_mfma_f32_32x32x16_bf16 a[112:127], a[248:251], v[120:123], a[112:127]
s_mul_i32 s74, s35, 36864
s_add_u32 s74, s74, s32
s_lshr_b32 s34, s35, 2
s_and_b32 s35, s35, 3
s_mul_i32 s10, s34, 34816
v_add_f32 v147, v136, v137
v_cvt_pk_bf16_f32 v128, v136, v137
v_exp_f32 v139, v51
v_mfma_f32_32x32x16_bf16 a[64:79], a[228:231], v[124:127], a[64:79]
s_mul_i32 s37, s35, 6144
s_add_u32 s10, s10, s37
s_mul_i32 s34, s34, 6144
s_add_u32 s34, s34, 139264
s_cmp_eq_u32 s35, 3
s_cselect_b32 s10, s34, s10
v_add_f32 v147, v147, v138
v_exp_f32 v140, v52
v_mfma_f32_32x32x16_bf16 a[80:95], a[236:239], v[124:127], a[80:95]
s_add_u32 s35, s29, s42
s_and_b32 s35, s35, 15
s_add_u32 s29, s29, 1
s_cmp_eq_u32 s29, 12
s_cselect_b32 s29, 0, s29
v_add_f32 v147, v147, v139
v_cvt_pk_bf16_f32 v129, v138, v139
v_exp_f32 v141, v53
v_mfma_f32_32x32x16_bf16 a[96:111], a[244:247], v[124:127], a[96:111]
s_mul_i32 s75, s35, 36864
s_add_u32 s75, s75, s32
s_lshr_b32 s34, s35, 2
s_and_b32 s35, s35, 3
s_mul_i32 s11, s34, 34816
v_add_f32 v147, v147, v140
v_exp_f32 v142, v54
v_add_f32 v147, v147, v141
v_cvt_pk_bf16_f32 v130, v140, v141
v_mfma_f32_32x32x16_bf16 a[112:127], a[252:255], v[124:127], a[112:127]
s_mul_i32 s37, s35, 6144
s_add_u32 s11, s11, s37
s_mul_i32 s34, s34, 6144
s_add_u32 s34, s34, 139264
s_cmp_eq_u32 s35, 3
s_cselect_b32 s11, s34, s11
v_exp_f32 v143, v55
v_add_f32 v147, v147, v142
v_exp_f32 v136, v56
s_waitcnt lgkmcnt(0)
v_mfma_f32_32x32x16_bf16 v[16:31], a[192:195], v[160:163], v[64:79]
v_add_f32 v147, v147, v143
v_cvt_pk_bf16_f32 v131, v142, v143
v_exp_f32 v137, v57
v_mfma_f32_32x32x16_bf16 v[16:31], a[196:199], v[164:167], v[16:31]
v_add_f32 v147, v147, v136
v_exp_f32 v138, v58
v_mfma_f32_32x32x16_bf16 v[16:31], a[200:203], v[168:171], v[16:31]
v_add_f32 v147, v147, v137
v_cvt_pk_bf16_f32 v132, v136, v137
v_exp_f32 v139, v59
v_add_f32 v147, v147, v138
v_mfma_f32_32x32x16_bf16 v[16:31], a[204:207], v[172:175], v[16:31]
v_exp_f32 v140, v60
v_add_f32 v147, v147, v139
v_cvt_pk_bf16_f32 v133, v138, v139
v_mfma_f32_32x32x16_bf16 v[16:31], a[208:211], v[176:179], v[16:31]
s_lshl_b32 s34, s95, 3
v_mov_b32 v157, s34
global_load_dword v158, v157, s[98:99] sc1
v_exp_f32 v141, v61
v_add_f32 v147, v147, v140
v_exp_f32 v142, v62
v_mfma_f32_32x32x16_bf16 v[16:31], a[212:215], v[180:183], v[16:31]
v_add_f32 v147, v147, v141
v_cvt_pk_bf16_f32 v134, v140, v141
v_exp_f32 v143, v63
v_mfma_f32_32x32x16_bf16 v[16:31], a[216:219], v[184:187], v[16:31]
v_add_f32 v147, v147, v142
v_add_f32 v147, v147, v143
v_cvt_pk_bf16_f32 v135, v142, v143
v_mfma_f32_32x32x16_bf16 v[16:31], a[220:223], v[188:191], v[16:31]
v_cmp_nge_f32 vcc, s46, v147
s_cbranch_vccnz L_tramp_Ap0c
L_back_Ap0c:
v_add_f32 v146, v146, v147
s_waitcnt vmcnt(0)
s_barrier
v_mfma_f32_32x32x16_bf16 a[128:143], a[224:227], v[128:131], a[128:143]
ds_read_b64_tr_b16 a[224:225], v12 offset:34816
ds_read_b64_tr_b16 a[226:227], v12 offset:36864
s_add_u32 m0, s38, 18432
s_add_u32 s36, s33, 0
buffer_load_dwordx4 v3, s[4:7], s36 offen offset:0  lds
v_mfma_f32_32x32x16_bf16 a[144:159], a[232:235], v[128:131], a[144:159]
ds_read_b64_tr_b16 a[232:233], v13 offset:34816
ds_read_b64_tr_b16 a[234:235], v13 offset:36864
v_mfma_f32_32x32x16_bf16 a[160:175], a[240:243], v[128:131], a[160:175]
ds_read_b64_tr_b16 a[240:241], v14 offset:34816
buffer_load_dwordx4 v4, s[4:7], s36 offen offset:1024  lds
v_exp_f32 v136, v16
v_exp_f32 v137, v17
v_exp_f32 v138, v18
v_mfma_f32_32x32x16_bf16 a[176:191], a[248:251], v[128:131], a[176:191]
ds_read_b64_tr_b16 a[242:243], v14 offset:36864
v_add_f32 v147, v136, v137
v_cvt_pk_bf16_f32 v112, v136, v137
v_exp_f32 v139, v19
v_mfma_f32_32x32x16_bf16 a[128:143], a[228:231], v[132:135], a[128:143]
ds_read_b64_tr_b16 a[248:249], v15 offset:34816
buffer_load_dwordx4 v5, s[4:7], s36 offen offset:2048  lds
v_add_f32 v147, v147, v138
v_exp_f32 v140, v20
v_mfma_f32_32x32x16_bf16 a[144:159], a[236:239], v[132:135], a[144:159]
ds_read_b64_tr_b16 a[250:251], v15 offset:36864
v_add_f32 v147, v147, v139
v_cvt_pk_bf16_f32 v113, v138, v139
v_exp_f32 v141, v21
v_mfma_f32_32x32x16_bf16 a[160:175], a[244:247], v[132:135], a[160:175]
ds_read_b64_tr_b16 a[228:229], v12 offset:38912
buffer_load_dwordx4 v6, s[4:7], s36 offen offset:3072  lds
v_add_f32 v147, v147, v140
v_exp_f32 v142, v22
v_add_f32 v147, v147, v141
v_cvt_pk_bf16_f32 v114, v140, v141
v_mfma_f32_32x32x16_bf16 a[176:191], a[252:255], v[132:135], a[176:191]
ds_read_b64_tr_b16 a[230:231], v12 offset:40960
v_exp_f32 v143, v23
v_add_f32 v147, v147, v142
v_exp_f32 v136, v24
v_mfma_f32_32x32x16_bf16 v[32:47], a[192:195], v[192:195], v[80:95]
ds_read_b64_tr_b16 a[236:237], v13 offset:38912
s_add_u32 m0, s38, 22528
s_add_u32 s36, s41, 0
buffer_load_dwordx4 v3, s[4:7], s36 offen offset:0  lds
v_add_f32 v147, v147, v143
v_cvt_pk_bf16_f32 v115, v142, v143
v_exp_f32 v137, v25
v_mfma_f32_32x32x16_bf16 v[32:47], a[196:199], v[196:199], v[32:47]
ds_read_b64_tr_b16 a[238:239], v13 offset:40960
v_add_f32 v147, v147, v136
v_exp_f32 v138, v26
v_mfma_f32_32x32x16_bf16 v[32:47], a[200:203], v[200:203], v[32:47]
ds_read_b64_tr_b16 a[244:245], v14 offset:38912
buffer_load_dwordx4 v4, s[4:7], s36 offen offset:1024  lds
v_add_f32 v147, v147, v137
v_cvt_pk_bf16_f32 v116, v136, v137
v_exp_f32 v139, v27
v_add_f32 v147, v147, v138
v_mfma_f32_32x32x16_bf16 v[32:47], a[204:207], v[204:207], v[32:47]
ds_read_b64_tr_b16 a[246:247], v14 offset:40960
v_exp_f32 v140, v28
v_add_f32 v147, v147, v139
v_cvt_pk_bf16_f32 v117, v138, v139
v_mfma_f32_32x32x16_bf16 v[32:47], a[208:211], v[208:211], v[32:47]
ds_read_b64_tr_b16 a[252:253], v15 offset:38912
buffer_load_dwordx4 v5, s[4:7], s36 offen offset:2048  lds
v_exp_f32 v141, v29
v_add_f32 v147, v147, v140
v_exp_f32 v142, v30
v_mfma_f32_32x32x16_bf16 v[32:47], a[212:215], v[212:215], v[32:47]
ds_read_b64_tr_b16 a[254:255], v15 offset:40960
v_add_f32 v147, v147, v141
v_cvt_pk_bf16_f32 v118, v140, v141
v_exp_f32 v143, v31
v_mfma_f32_32x32x16_bf16 v[32:47], a[216:219], v[216:219], v[32:47]
buffer_load_dwordx4 v6, s[4:7], s36 offen offset:3072  lds
v_add_f32 v147, v147, v142
v_add_f32 v147, v147, v143
v_cvt_pk_bf16_f32 v119, v142, v143
v_mfma_f32_32x32x16_bf16 v[32:47], a[220:223], v[220:223], v[32:47]
v_cmp_nge_f32 vcc, s46, v147
s_cbranch_vccnz L_tramp_Ap1a
L_back_Ap1a:
v_add_f32 v144, v144, v147
s_waitcnt lgkmcnt(4)
v_mfma_f32_32x32x16_bf16 a[0:15], a[224:227], v[112:115], a[0:15]
s_add_u32 m0, s38, 26624
s_add_u32 s36, s33, 36864
buffer_load_dwordx4 v3, s[4:7], s36 offen offset:0  lds
v_mfma_f32_32x32x16_bf16 a[16:31], a[232:235], v[112:115], a[16:31]
s_nop 0
v_mfma_f32_32x32x16_bf16 a[32:47], a[240:243], v[112:115], a[32:47]
buffer_load_dwordx4 v4, s[4:7], s36 offen offset:1024  lds
v_exp_f32 v136, v32
v_exp_f32 v137, v33
v_exp_f32 v138, v34
v_mfma_f32_32x32x16_bf16 a[48:63], a[248:251], v[112:115], a[48:63]
v_add_f32 v147, v136, v137
v_cvt_pk_bf16_f32 v120, v136, v137
v_exp_f32 v139, v35
v_mfma_f32_32x32x16_bf16 a[0:15], a[228:231], v[116:119], a[0:15]
buffer_load_dwordx4 v5, s[4:7], s36 offen offset:2048  lds
v_add_f32 v147, v147, v138
v_exp_f32 v140, v36
v_mfma_f32_32x32x16_bf16 a[16:31], a[236:239], v[116:119], a[16:31]
v_add_f32 v147, v147, v139
v_cvt_pk_bf16_f32 v121, v138, v139
v_exp_f32 v141, v37
s_waitcnt lgkmcnt(0)
v_mfma_f32_32x32x16_bf16 a[32:47], a[244:247], v[116:119], a[32:47]
buffer_load_dwordx4 v6, s[4:7], s36 offen offset:3072  lds
v_add_f32 v147, v147, v140
v_exp_f32 v142, v38
v_add_f32 v147, v147, v141
v_cvt_pk_bf16_f32 v122, v140, v141
v_mfma_f32_32x32x16_bf16 a[48:63], a[252:255], v[116:119], a[48:63]
v_exp_f32 v143, v39
v_add_f32 v147, v147, v142
v_exp_f32 v136, v40
v_mfma_f32_32x32x16_bf16 v[48:63], a[192:195], v[224:227], v[96:111]
s_add_u32 m0, s38, 30720
s_add_u32 s36, s41, 36864
buffer_load_dwordx4 v3, s[4:7], s36 offen offset:0  lds
v_add_f32 v147, v147, v143
v_cvt_pk_bf16_f32 v123, v142, v143
v_exp_f32 v137, v41
v_mfma_f32_32x32x16_bf16 v[48:63], a[196:199], v[228:231], v[48:63]
v_add_f32 v147, v147, v136
v_exp_f32 v138, v42
v_mfma_f32_32x32x16_bf16 v[48:63], a[200:203], v[232:235], v[48:63]
buffer_load_dwordx4 v4, s[4:7], s36 offen offset:1024  lds
v_add_f32 v147, v147, v137
v_cvt_pk_bf16_f32 v124, v136, v137
v_exp_f32 v139, v43
v_add_f32 v147, v147, v138
v_mfma_f32_32x32x16_bf16 v[48:63], a[204:207], v[236:239], v[48:63]
v_exp_f32 v140, v44
v_add_f32 v147, v147, v139
v_cvt_pk_bf16_f32 v125, v138, v139
v_mfma_f32_32x32x16_bf16 v[48:63], a[208:211], v[240:243], v[48:63]
buffer_load_dwordx4 v5, s[4:7], s36 offen offset:2048  lds
v_exp_f32 v141, v45
v_add_f32 v147, v147, v140
v_exp_f32 v142, v46
v_mfma_f32_32x32x16_bf16 v[48:63], a[212:215], v[244:247], v[48:63]
v_add_f32 v147, v147, v141
v_cvt_pk_bf16_f32 v126, v140, v141
v_exp_f32 v143, v47
v_mfma_f32_32x32x16_bf16 v[48:63], a[216:219], v[248:251], v[48:63]
buffer_load_dwordx4 v6, s[4:7], s36 offen offset:3072  lds
v_add_f32 v147, v147, v142
v_add_f32 v147, v147, v143
v_cvt_pk_bf16_f32 v127, v142, v143
v_mfma_f32_32x32x16_bf16 v[48:63], a[220:223], v[252:255], v[48:63]
v_cmp_nge_f32 vcc, s46, v147
s_cbranch_vccnz L_tramp_Ap1b
L_back_Ap1b:
v_add_f32 v145, v145, v147
s_barrier
v_mfma_f32_32x32x16_bf16 a[64:79], a[224:227], v[120:123], a[64:79]
v_mfma_f32_32x32x16_bf16 a[80:95], a[232:235], v[120:123], a[80:95]
s_nop 4
v_mfma_f32_32x32x16_bf16 a[96:111], a[240:243], v[120:123], a[96:111]
v_exp_f32 v136, v48
v_exp_f32 v137, v49
v_exp_f32 v138, v50
v_add_f32 v147, v136, v137
v_cvt_pk_bf16_f32 v128, v136, v137
v_exp_f32 v139, v51
v_add_f32 v147, v147, v138
v_mfma_f32_32x32x16_bf16 a[112:127], a[248:251], v[120:123], a[112:127]
v_exp_f32 v140, v52
v_add_f32 v147, v147, v139
v_cvt_pk_bf16_f32 v129, v138, v139
v_exp_f32 v141, v53
v_add_f32 v147, v147, v140
v_exp_f32 v142, v54
v_add_f32 v147, v147, v141
v_cvt_pk_bf16_f32 v130, v140, v141
v_mfma_f32_32x32x16_bf16 a[64:79], a[228:231], v[124:127], a[64:79]
v_exp_f32 v143, v55
v_add_f32 v147, v147, v142
v_exp_f32 v136, v56
v_add_f32 v147, v147, v143
v_cvt_pk_bf16_f32 v131, v142, v143
v_exp_f32 v137, v57
v_add_f32 v147, v147, v136
v_exp_f32 v138, v58
v_mfma_f32_32x32x16_bf16 a[80:95], a[236:239], v[124:127], a[80:95]
v_add_f32 v147, v147, v137
v_cvt_pk_bf16_f32 v132, v136, v137
v_exp_f32 v139, v59
v_add_f32 v147, v147, v138
v_exp_f32 v140, v60
v_add_f32 v147, v147, v139
v_cvt_pk_bf16_f32 v133, v138, v139
v_exp_f32 v141, v61
v_mfma_f32_32x32x16_bf16 a[96:111], a[244:247], v[124:127], a[96:111]
v_add_f32 v147, v147, v140
v_exp_f32 v142, v62
v_add_f32 v147, v147, v141
v_cvt_pk_bf16_f32 v134, v140, v141
v_exp_f32 v143, v63
v_add_f32 v147, v147, v142
v_add_f32 v147, v147, v143
v_cvt_pk_bf16_f32 v135, v142, v143
v_mfma_f32_32x32x16_bf16 a[112:127], a[252:255], v[124:127], a[112:127]
v_cmp_nge_f32 vcc, s46, v147
s_cbranch_vccnz L_tramp_Ap1c
L_back_Ap1c:
v_add_f32 v146, v146, v147
s_branch L_attn_done
L_enterB:
s_and_b32 s94, s3, 0
s_add_u32 s94, s94, 10
.p2align 6
L_mainB:
s_waitcnt vmcnt(16)
v_mfma_f32_32x32x16_bf16 a[128:143], a[224:227], v[128:131], a[128:143]
ds_read_b64_tr_b16 a[224:225], v12 offset:16896
ds_read_b64_tr_b16 a[226:227], v12 offset:18944
s_add_u32 m0, s38, 16896
s_nop 0
buffer_load_dwordx4 v8, s[12:15], s44 offen offset:0 nt lds
v_mfma_f32_32x32x16_bf16 a[144:159], a[232:235], v[128:131], a[144:159]
ds_read_b64_tr_b16 a[232:233], v13 offset:16896
ds_read_b64_tr_b16 a[234:235], v13 offset:18944
v_mfma_f32_32x32x16_bf16 a[160:175], a[240:243], v[128:131], a[160:175]
ds_read_b64_tr_b16 a[240:241], v14 offset:16896
v_exp_f32 v136, v16
v_exp_f32 v137, v17
v_exp_f32 v138, v18
v_mfma_f32_32x32x16_bf16 a[176:191], a[248:251], v[128:131], a[176:191]
ds_read_b64_tr_b16 a[242:243], v14 offset:18944
s_add_u32 m0, s38, 16960
s_nop 0
buffer_load_dwordx4 v8, s[12:15], s44 offen offset:1024 nt lds
v_add_f32 v147, v136, v137
v_cvt_pk_bf16_f32 v112, v136, v137
v_exp_f32 v139, v19
v_mfma_f32_32x32x16_bf16 a[128:143], a[228:231], v[132:135], a[128:143]
ds_read_b64_tr_b16 a[248:249], v15 offset:16896
v_add_f32 v147, v147, v138
v_exp_f32 v140, v20
v_mfma_f32_32x32x16_bf16 a[144:159], a[236:239], v[132:135], a[144:159]
ds_read_b64_tr_b16 a[250:251], v15 offset:18944
v_add_f32 v147, v147, v139
v_cvt_pk_bf16_f32 v113, v138, v139
v_exp_f32 v141, v21
v_mfma_f32_32x32x16_bf16 a[160:175], a[244:247], v[132:135], a[160:175]
ds_read_b64_tr_b16 a[228:229], v12 offset:20992
s_add_u32 m0, s38, 17024
s_nop 0
buffer_load_dwordx4 v8, s[12:15], s44 offen offset:2048 nt lds
v_add_f32 v147, v147, v140
v_exp_f32 v142, v22
v_add_f32 v147, v147, v141
v_cvt_pk_bf16_f32 v114, v140, v141
v_mfma_f32_32x32x16_bf16 a[176:191], a[252:255], v[132:135], a[176:191]
ds_read_b64_tr_b16 a[230:231], v12 offset:23040
v_exp_f32 v143, v23
v_add_f32 v147, v147, v142
v_exp_f32 v136, v24
v_mfma_f32_32x32x16_bf16 v[32:47], a[192:195], v[192:195], v[80:95]
ds_read_b64_tr_b16 a[236:237], v13 offset:20992
v_add_f32 v147, v147, v143
v_cvt_pk_bf16_f32 v115, v142, v143
v_exp_f32 v137, v25
v_mfma_f32_32x32x16_bf16 v[32:47], a[196:199], v[196:199], v[32:47]
ds_read_b64_tr_b16 a[238:239], v13 offset:23040
s_add_u32 m0, s38, 17088
s_nop 0
buffer_load_dwordx4 v8, s[12:15], s44 offen offset:3072 nt lds
v_add_f32 v147, v147, v136
v_exp_f32 v138, v26
v_mfma_f32_32x32x16_bf16 v[32:47], a[200:203], v[200:203], v[32:47]
ds_read_b64_tr_b16 a[244:245], v14 offset:20992
v_add_f32 v147, v147, v137
v_cvt_pk_bf16_f32 v116, v136, v137
v_exp_f32 v139, v27
v_add_f32 v147, v147, v138
v_mfma_f32_32x32x16_bf16 v[32:47], a[204:207], v[204:207], v[32:47]
ds_read_b64_tr_b16 a[246:247], v14 offset:23040
v_exp_f32 v140, v28
v_add_f32 v147, v147, v139
v_cvt_pk_bf16_f32 v117, v138, v139
v_mfma_f32_32x32x16_bf16 v[32:47], a[208:211], v[208:211], v[32:47]
ds_read_b64_tr_b16 a[252:253], v15 offset:20992
s_add_u32 m0, s38, 21248
s_nop 0
buffer_load_dwordx4 v8, s[12:15], s45 offen offset:0 nt lds
v_exp_f32 v141, v29
v_add_f32 v147, v147, v140
v_exp_f32 v142, v30
v_mfma_f32_32x32x16_bf16 v[32:47], a[212:215], v[212:215], v[32:47]
ds_read_b64_tr_b16 a[254:255], v15 offset:23040
v_add_f32 v147, v147, v141
v_cvt_pk_bf16_f32 v118, v140, v141
v_exp_f32 v143, v31
v_mfma_f32_32x32x16_bf16 v[32:47], a[216:219], v[216:219], v[32:47]
v_add_f32 v147, v147, v142
v_add_f32 v147, v147, v143
v_cvt_pk_bf16_f32 v119, v142, v143
v_mfma_f32_32x32x16_bf16 v[32:47], a[220:223], v[220:223], v[32:47]
s_add_u32 m0, s38, 21312
s_nop 0
buffer_load_dwordx4 v8, s[12:15], s45 offen offset:1024 nt lds
v_cmp_nge_f32 vcc, s46, v147
s_cbranch_vccnz L_tramp_Bs0a
L_back_Bs0a:
v_add_f32 v144, v144, v147
s_waitcnt lgkmcnt(4)
v_mfma_f32_32x32x16_bf16 a[0:15], a[224:227], v[112:115], a[0:15]
v_mfma_f32_32x32x16_bf16 a[16:31], a[232:235], v[112:115], a[16:31]
s_nop 1
v_mfma_f32_32x32x16_bf16 a[32:47], a[240:243], v[112:115], a[32:47]
s_add_u32 m0, s38, 21376
s_nop 0
buffer_load_dwordx4 v8, s[12:15], s45 offen offset:2048 nt lds
v_exp_f32 v136, v32
v_exp_f32 v137, v33
v_exp_f32 v138, v34
v_mfma_f32_32x32x16_bf16 a[48:63], a[248:251], v[112:115], a[48:63]
v_add_f32 v147, v136, v137
v_cvt_pk_bf16_f32 v120, v136, v137
v_exp_f32 v139, v35
v_mfma_f32_32x32x16_bf16 a[0:15], a[228:231], v[116:119], a[0:15]
v_add_f32 v147, v147, v138
v_exp_f32 v140, v36
v_mfma_f32_32x32x16_bf16 a[16:31], a[236:239], v[116:119], a[16:31]
s_add_u32 m0, s38, 21440
s_nop 0
buffer_load_dwordx4 v8, s[12:15], s45 offen offset:3072 nt lds
v_add_f32 v147, v147, v139
v_cvt_pk_bf16_f32 v121, v138, v139
v_exp_f32 v141, v37
s_waitcnt lgkmcnt(0)
v_mfma_f32_32x32x16_bf16 a[32:47], a[244:247], v[116:119], a[32:47]
v_add_f32 v147, v147, v140
v_exp_f32 v142, v38
v_add_f32 v147, v147, v141
v_cvt_pk_bf16_f32 v122, v140, v141
v_mfma_f32_32x32x16_bf16 a[48:63], a[252:255], v[116:119], a[48:63]
v_exp_f32 v143, v39
v_add_f32 v147, v147, v142
v_exp_f32 v136, v40
v_mfma_f32_32x32x16_bf16 v[48:63], a[192:195], v[224:227], v[96:111]
s_add_u32 m0, s38, 25600
s_nop 0
buffer_load_dwordx4 v9, s[16:19], s44 offen offset:0 nt lds
v_add_f32 v147, v147, v143
v_cvt_pk_bf16_f32 v123, v142, v143
v_exp_f32 v137, v41
v_mfma_f32_32x32x16_bf16 v[48:63], a[196:199], v[228:231], v[48:63]
v_add_f32 v147, v147, v136
v_exp_f32 v138, v42
v_mfma_f32_32x32x16_bf16 v[48:63], a[200:203], v[232:235], v[48:63]
v_add_f32 v147, v147, v137
v_cvt_pk_bf16_f32 v124, v136, v137
v_exp_f32 v139, v43
v_add_f32 v147, v147, v138
v_mfma_f32_32x32x16_bf16 v[48:63], a[204:207], v[236:239], v[48:63]
buffer_load_dwordx4 v9, s[16:19], s44 offen offset:1024 nt lds
v_exp_f32 v140, v44
v_add_f32 v147, v147, v139
v_cvt_pk_bf16_f32 v125, v138, v139
v_mfma_f32_32x32x16_bf16 v[48:63], a[208:211], v[240:243], v[48:63]
v_exp_f32 v141, v45
v_add_f32 v147, v147, v140
v_exp_f32 v142, v46
v_mfma_f32_32x32x16_bf16 v[48:63], a[212:215], v[244:247], v[48:63]
v_add_f32 v147, v147, v141
v_cvt_pk_bf16_f32 v126, v140, v141
v_exp_f32 v143, v47
v_mfma_f32_32x32x16_bf16 v[48:63], a[216:219], v[248:251], v[48:63]
buffer_load_dwordx4 v9, s[16:19], s44 offen offset:2048 nt lds
v_add_f32 v147, v147, v142
v_add_f32 v147, v147, v143
v_cvt_pk_bf16_f32 v127, v142, v143
v_mfma_f32_32x32x16_bf16 v[48:63], a[220:223], v[252:255], v[48:63]
v_cmp_nge_f32 vcc, s46, v147
s_cbranch_vccnz L_tramp_Bs0b
L_back_Bs0b:
v_add_f32 v145, v145, v147
s_waitcnt vmcnt(19)
v_mfma_f32_32x32x16_bf16 a[64:79], a[224:227], v[120:123], a[64:79]
ds_read_b128 a[192:195], v10 offset:0
ds_read_b128 a[196:199], v11 offset:0
ds_read_b128 a[200:203], v10 offset:64
ds_read_b128 a[204:207], v11 offset:64
v_mfma_f32_32x32x16_bf16 a[80:95], a[232:235], v[120:123], a[80:95]
ds_read_b128 a[208:211], v10 offset:128
ds_read_b128 a[212:215], v11 offset:128
ds_read_b128 a[216:219], v10 offset:192
ds_read_b128 a[220:223], v11 offset:192
buffer_load_dwordx4 v9, s[16:19], s44 offen offset:3072 nt lds
v_mfma_f32_32x32x16_bf16 a[96:111], a[240:243], v[120:123], a[96:111]
v_exp_f32 v136, v48
v_exp_f32 v137, v49
v_exp_f32 v138, v50
v_mfma_f32_32x32x16_bf16 a[112:127], a[248:251], v[120:123], a[112:127]
v_add_f32 v147, v136, v137
v_cvt_pk_bf16_f32 v128, v136, v137
v_exp_f32 v139, v51
v_mfma_f32_32x32x16_bf16 a[64:79], a[228:231], v[124:127], a[64:79]
s_add_u32 m0, s38, 29696
s_nop 0
buffer_load_dwordx4 v9, s[16:19], s45 offen offset:0 nt lds
v_add_f32 v147, v147, v138
v_exp_f32 v140, v52
v_mfma_f32_32x32x16_bf16 a[80:95], a[236:239], v[124:127], a[80:95]
v_add_f32 v147, v147, v139
v_cvt_pk_bf16_f32 v129, v138, v139
v_exp_f32 v141, v53
v_mfma_f32_32x32x16_bf16 a[96:111], a[244:247], v[124:127], a[96:111]
v_add_f32 v147, v147, v140
v_exp_f32 v142, v54
v_add_f32 v147, v147, v141
v_cvt_pk_bf16_f32 v130, v140, v141
v_mfma_f32_32x32x16_bf16 a[112:127], a[252:255], v[124:127], a[112:127]
buffer_load_dwordx4 v9, s[16:19], s45 offen offset:1024 nt lds
v_exp_f32 v143, v55
v_add_f32 v147, v147, v142
v_exp_f32 v136, v56
s_waitcnt lgkmcnt(0)
v_mfma_f32_32x32x16_bf16 v[16:31], a[192:195], v[160:163], v[64:79]
v_add_f32 v147, v147, v143
v_cvt_pk_bf16_f32 v131, v142, v143
v_exp_f32 v137, v57
v_mfma_f32_32x32x16_bf16 v[16:31], a[196:199], v[164:167], v[16:31]
v_add_f32 v147, v147, v136
v_exp_f32 v138, v58
v_mfma_f32_32x32x16_bf16 v[16:31], a[200:203], v[168:171], v[16:31]
buffer_load_dwordx4 v9, s[16:19], s45 offen offset:2048 nt lds
v_add_f32 v147, v147, v137
v_cvt_pk_bf16_f32 v132, v136, v137
v_exp_f32 v139, v59
v_add_f32 v147, v147, v138
v_mfma_f32_32x32x16_bf16 v[16:31], a[204:207], v[172:175], v[16:31]
v_exp_f32 v140, v60
v_add_f32 v147, v147, v139
v_cvt_pk_bf16_f32 v133, v138, v139
v_mfma_f32_32x32x16_bf16 v[16:31], a[208:211], v[176:179], v[16:31]
v_exp_f32 v141, v61
v_add_f32 v147, v147, v140
v_exp_f32 v142, v62
v_mfma_f32_32x32x16_bf16 v[16:31], a[212:215], v[180:183], v[16:31]
buffer_load_dwordx4 v9, s[16:19], s45 offen offset:3072 nt lds
v_add_f32 v147, v147, v141
v_cvt_pk_bf16_f32 v134, v140, v141
v_exp_f32 v143, v63
v_mfma_f32_32x32x16_bf16 v[16:31], a[216:219], v[184:187], v[16:31]
s_add_u32 s44, s44, 8192
s_and_b32 s44, s44, 0x3ffff
s_add_u32 s45, s44, 4096
s_and_b32 s45, s45, 0x3ffff
v_add_f32 v147, v147, v142
v_add_f32 v147, v147, v143
v_cvt_pk_bf16_f32 v135, v142, v143
v_mfma_f32_32x32x16_bf16 v[16:31], a[220:223], v[188:191], v[16:31]
v_cmp_nge_f32 vcc, s46, v147
s_cbranch_vccnz L_tramp_Bs0c
L_back_Bs0c:
v_add_f32 v146, v146, v147
s_waitcnt vmcnt(16)
v_mfma_f32_32x32x16_bf16 a[128:143], a[224:227], v[128:131], a[128:143]
ds_read_b64_tr_b16 a[224:225], v12 offset:0
ds_read_b64_tr_b16 a[226:227], v12 offset:2048
s_add_u32 m0, s38, 0
s_nop 0
buffer_load_dwordx4 v8, s[12:15], s44 offen offset:0 nt lds
v_mfma_f32_32x32x16_bf16 a[144:159], a[232:235], v[128:131], a[144:159]
ds_read_b64_tr_b16 a[232:233], v13 offset:0
ds_read_b64_tr_b16 a[234:235], v13 offset:2048
v_mfma_f32_32x32x16_bf16 a[160:175], a[240:243], v[128:131], a[160:175]
ds_read_b64_tr_b16 a[240:241], v14 offset:0
v_exp_f32 v136, v16
v_exp_f32 v137, v17
v_exp_f32 v138, v18
v_mfma_f32_32x32x16_bf16 a[176:191], a[248:251], v[128:131], a[176:191]
ds_read_b64_tr_b16 a[242:243], v14 offset:2048
s_add_u32 m0, s38, 64
s_nop 0
buffer_load_dwordx4 v8, s[12:15], s44 offen offset:1024 nt lds
v_add_f32 v147, v136, v137
v_cvt_pk_bf16_f32 v112, v136, v137
v_exp_f32 v139, v19
v_mfma_f32_32x32x16_bf16 a[128:143], a[228:231], v[132:135], a[128:143]
ds_read_b64_tr_b16 a[248:249], v15 offset:0
v_add_f32 v147, v147, v138
v_exp_f32 v140, v20
v_mfma_f32_32x32x16_bf16 a[144:159], a[236:239], v[132:135], a[144:159]
ds_read_b64_tr_b16 a[250:251], v15 offset:2048
v_add_f32 v147, v147, v139
v_cvt_pk_bf16_f32 v113, v138, v139
v_exp_f32 v141, v21
v_mfma_f32_32x32x16_bf16 a[160:175], a[244:247], v[132:135], a[160:175]
ds_read_b64_tr_b16 a[228:229], v12 offset:4096
s_add_u32 m0, s38, 128
s_nop 0
buffer_load_dwordx4 v8, s[12:15], s44 offen offset:2048 nt lds
v_add_f32 v147, v147, v140
v_exp_f32 v142, v22
v_add_f32 v147, v147, v141
v_cvt_pk_bf16_f32 v114, v140, v141
v_mfma_f32_32x32x16_bf16 a[176:191], a[252:255], v[132:135], a[176:191]
ds_read_b64_tr_b16 a[230:231], v12 offset:6144
v_exp_f32 v143, v23
v_add_f32 v147, v147, v142
v_exp_f32 v136, v24
v_mfma_f32_32x32x16_bf16 v[32:47], a[192:195], v[192:195], v[80:95]
ds_read_b64_tr_b16 a[236:237], v13 offset:4096
v_add_f32 v147, v147, v143
v_cvt_pk_bf16_f32 v115, v142, v143
v_exp_f32 v137, v25
v_mfma_f32_32x32x16_bf16 v[32:47], a[196:199], v[196:199], v[32:47]
ds_read_b64_tr_b16 a[238:239], v13 offset:6144
s_add_u32 m0, s38, 192
s_nop 0
buffer_load_dwordx4 v8, s[12:15], s44 offen offset:3072 nt lds
v_add_f32 v147, v147, v136
v_exp_f32 v138, v26
v_mfma_f32_32x32x16_bf16 v[32:47], a[200:203], v[200:203], v[32:47]
ds_read_b64_tr_b16 a[244:245], v14 offset:4096
v_add_f32 v147, v147, v137
v_cvt_pk_bf16_f32 v116, v136, v137
v_exp_f32 v139, v27
v_add_f32 v147, v147, v138
v_mfma_f32_32x32x16_bf16 v[32:47], a[204:207], v[204:207], v[32:47]
ds_read_b64_tr_b16 a[246:247], v14 offset:6144
v_exp_f32 v140, v28
v_add_f32 v147, v147, v139
v_cvt_pk_bf16_f32 v117, v138, v139
v_mfma_f32_32x32x16_bf16 v[32:47], a[208:211], v[208:211], v[32:47]
ds_read_b64_tr_b16 a[252:253], v15 offset:4096
s_add_u32 m0, s38, 4352
s_nop 0
buffer_load_dwordx4 v8, s[12:15], s45 offen offset:0 nt lds
v_exp_f32 v141, v29
v_add_f32 v147, v147, v140
v_exp_f32 v142, v30
v_mfma_f32_32x32x16_bf16 v[32:47], a[212:215], v[212:215], v[32:47]
ds_read_b64_tr_b16 a[254:255], v15 offset:6144
v_add_f32 v147, v147, v141
v_cvt_pk_bf16_f32 v118, v140, v141
v_exp_f32 v143, v31
v_mfma_f32_32x32x16_bf16 v[32:47], a[216:219], v[216:219], v[32:47]
v_add_f32 v147, v147, v142
v_add_f32 v147, v147, v143
v_cvt_pk_bf16_f32 v119, v142, v143
v_mfma_f32_32x32x16_bf16 v[32:47], a[220:223], v[220:223], v[32:47]
s_add_u32 m0, s38, 4416
s_nop 0
buffer_load_dwordx4 v8, s[12:15], s45 offen offset:1024 nt lds
v_cmp_nge_f32 vcc, s46, v147
s_cbranch_vccnz L_tramp_Bs1a
L_back_Bs1a:
v_add_f32 v144, v144, v147
s_waitcnt lgkmcnt(4)
v_mfma_f32_32x32x16_bf16 a[0:15], a[224:227], v[112:115], a[0:15]
v_mfma_f32_32x32x16_bf16 a[16:31], a[232:235], v[112:115], a[16:31]
s_nop 1
v_mfma_f32_32x32x16_bf16 a[32:47], a[240:243], v[112:115], a[32:47]
s_add_u32 m0, s38, 4480
s_nop 0
buffer_load_dwordx4 v8, s[12:15], s45 offen offset:2048 nt lds
v_exp_f32 v136, v32
v_exp_f32 v137, v33
v_exp_f32 v138, v34
v_mfma_f32_32x32x16_bf16 a[48:63], a[248:251], v[112:115], a[48:63]
v_add_f32 v147, v136, v137
v_cvt_pk_bf16_f32 v120, v136, v137
v_exp_f32 v139, v35
v_mfma_f32_32x32x16_bf16 a[0:15], a[228:231], v[116:119], a[0:15]
v_add_f32 v147, v147, v138
v_exp_f32 v140, v36
v_mfma_f32_32x32x16_bf16 a[16:31], a[236:239], v[116:119], a[16:31]
s_add_u32 m0, s38, 4544
s_nop 0
buffer_load_dwordx4 v8, s[12:15], s45 offen offset:3072 nt lds
v_add_f32 v147, v147, v139
v_cvt_pk_bf16_f32 v121, v138, v139
v_exp_f32 v141, v37
s_waitcnt lgkmcnt(0)
v_mfma_f32_32x32x16_bf16 a[32:47], a[244:247], v[116:119], a[32:47]
v_add_f32 v147, v147, v140
v_exp_f32 v142, v38
v_add_f32 v147, v147, v141
v_cvt_pk_bf16_f32 v122, v140, v141
v_mfma_f32_32x32x16_bf16 a[48:63], a[252:255], v[116:119], a[48:63]
v_exp_f32 v143, v39
v_add_f32 v147, v147, v142
v_exp_f32 v136, v40
v_mfma_f32_32x32x16_bf16 v[48:63], a[192:195], v[224:227], v[96:111]
s_add_u32 m0, s38, 8704
s_nop 0
buffer_load_dwordx4 v9, s[16:19], s44 offen offset:0 nt lds
v_add_f32 v147, v147, v143
v_cvt_pk_bf16_f32 v123, v142, v143
v_exp_f32 v137, v41
v_mfma_f32_32x32x16_bf16 v[48:63], a[196:199], v[228:231], v[48:63]
v_add_f32 v147, v147, v136
v_exp_f32 v138, v42
v_mfma_f32_32x32x16_bf16 v[48:63], a[200:203], v[232:235], v[48:63]
v_add_f32 v147, v147, v137
v_cvt_pk_bf16_f32 v124, v136, v137
v_exp_f32 v139, v43
v_add_f32 v147, v147, v138
v_mfma_f32_32x32x16_bf16 v[48:63], a[204:207], v[236:239], v[48:63]
buffer_load_dwordx4 v9, s[16:19], s44 offen offset:1024 nt lds
v_exp_f32 v140, v44
v_add_f32 v147, v147, v139
v_cvt_pk_bf16_f32 v125, v138, v139
v_mfma_f32_32x32x16_bf16 v[48:63], a[208:211], v[240:243], v[48:63]
v_exp_f32 v141, v45
v_add_f32 v147, v147, v140
v_exp_f32 v142, v46
v_mfma_f32_32x32x16_bf16 v[48:63], a[212:215], v[244:247], v[48:63]
v_add_f32 v147, v147, v141
v_cvt_pk_bf16_f32 v126, v140, v141
v_exp_f32 v143, v47
v_mfma_f32_32x32x16_bf16 v[48:63], a[216:219], v[248:251], v[48:63]
buffer_load_dwordx4 v9, s[16:19], s44 offen offset:2048 nt lds
v_add_f32 v147, v147, v142
v_add_f32 v147, v147, v143
v_cvt_pk_bf16_f32 v127, v142, v143
v_mfma_f32_32x32x16_bf16 v[48:63], a[220:223], v[252:255], v[48:63]
v_cmp_nge_f32 vcc, s46, v147
s_cbranch_vccnz L_tramp_Bs1b
L_back_Bs1b:
v_add_f32 v145, v145, v147
s_waitcnt vmcnt(19)
v_mfma_f32_32x32x16_bf16 a[64:79], a[224:227], v[120:123], a[64:79]
ds_read_b128 a[192:195], v10 offset:16896
ds_read_b128 a[196:199], v11 offset:16896
ds_read_b128 a[200:203], v10 offset:16960
ds_read_b128 a[204:207], v11 offset:16960
v_mfma_f32_32x32x16_bf16 a[80:95], a[232:235], v[120:123], a[80:95]
ds_read_b128 a[208:211], v10 offset:17024
ds_read_b128 a[212:215], v11 offset:17024
ds_read_b128 a[216:219], v10 offset:17088
ds_read_b128 a[220:223], v11 offset:17088
buffer_load_dwordx4 v9, s[16:19], s44 offen offset:3072 nt lds
v_mfma_f32_32x32x16_bf16 a[96:111], a[240:243], v[120:123], a[96:111]
v_exp_f32 v136, v48
v_exp_f32 v137, v49
v_exp_f32 v138, v50
v_mfma_f32_32x32x16_bf16 a[112:127], a[248:251], v[120:123], a[112:127]
v_add_f32 v147, v136, v137
v_cvt_pk_bf16_f32 v128, v136, v137
v_exp_f32 v139, v51
v_mfma_f32_32x32x16_bf16 a[64:79], a[228:231], v[124:127], a[64:79]
s_add_u32 m0, s38, 12800
s_nop 0
buffer_load_dwordx4 v9, s[16:19], s45 offen offset:0 nt lds
v_add_f32 v147, v147, v138
v_exp_f32 v140, v52
v_mfma_f32_32x32x16_bf16 a[80:95], a[236:239], v[124:127], a[80:95]
v_add_f32 v147, v147, v139
v_cvt_pk_bf16_f32 v129, v138, v139
v_exp_f32 v141, v53
v_mfma_f32_32x32x16_bf16 a[96:111], a[244:247], v[124:127], a[96:111]
v_add_f32 v147, v147, v140
v_exp_f32 v142, v54
v_add_f32 v147, v147, v141
v_cvt_pk_bf16_f32 v130, v140, v141
v_mfma_f32_32x32x16_bf16 a[112:127], a[252:255], v[124:127], a[112:127]
buffer_load_dwordx4 v9, s[16:19], s45 offen offset:1024 nt lds
v_exp_f32 v143, v55
v_add_f32 v147, v147, v142
v_exp_f32 v136, v56
s_waitcnt lgkmcnt(0)
v_mfma_f32_32x32x16_bf16 v[16:31], a[192:195], v[160:163], v[64:79]
v_add_f32 v147, v147, v143
v_cvt_pk_bf16_f32 v131, v142, v143
v_exp_f32 v137, v57
v_mfma_f32_32x32x16_bf16 v[16:31], a[196:199], v[164:167], v[16:31]
v_add_f32 v147, v147, v136
v_exp_f32 v138, v58
v_mfma_f32_32x32x16_bf16 v[16:31], a[200:203], v[168:171], v[16:31]
buffer_load_dwordx4 v9, s[16:19], s45 offen offset:2048 nt lds
v_add_f32 v147, v147, v137
v_cvt_pk_bf16_f32 v132, v136, v137
v_exp_f32 v139, v59
v_add_f32 v147, v147, v138
v_mfma_f32_32x32x16_bf16 v[16:31], a[204:207], v[172:175], v[16:31]
v_exp_f32 v140, v60
v_add_f32 v147, v147, v139
v_cvt_pk_bf16_f32 v133, v138, v139
v_mfma_f32_32x32x16_bf16 v[16:31], a[208:211], v[176:179], v[16:31]
v_exp_f32 v141, v61
v_add_f32 v147, v147, v140
v_exp_f32 v142, v62
v_mfma_f32_32x32x16_bf16 v[16:31], a[212:215], v[180:183], v[16:31]
buffer_load_dwordx4 v9, s[16:19], s45 offen offset:3072 nt lds
v_add_f32 v147, v147, v141
v_cvt_pk_bf16_f32 v134, v140, v141
v_exp_f32 v143, v63
v_mfma_f32_32x32x16_bf16 v[16:31], a[216:219], v[184:187], v[16:31]
s_add_u32 s44, s44, 8192
s_and_b32 s44, s44, 0x3ffff
s_add_u32 s45, s44, 4096
s_and_b32 s45, s45, 0x3ffff
v_add_f32 v147, v147, v142
v_add_f32 v147, v147, v143
v_cvt_pk_bf16_f32 v135, v142, v143
v_mfma_f32_32x32x16_bf16 v[16:31], a[220:223], v[188:191], v[16:31]
v_cmp_nge_f32 vcc, s46, v147
s_cbranch_vccnz L_tramp_Bs1c
L_back_Bs1c:
v_add_f32 v146, v146, v147
L_tailB:
s_add_u32 s40, s40, 1
s_cmp_ge_u32 s40, s94
s_cbranch_scc1 L_freeB
s_cmp_ge_u32 s40, 1
s_cbranch_scc1 L_mainBT
L_freeB:
s_cmp_lt_u32 s40, 15
s_cbranch_scc1 L_mainB
s_branch L_lastB
.p2align 6
L_mainBT:
s_waitcnt vmcnt(16)
v_mfma_f32_32x32x16_bf16 a[128:143], a[224:227], v[128:131], a[128:143]
ds_read_b64_tr_b16 a[224:225], v12 offset:16896
ds_read_b64_tr_b16 a[226:227], v12 offset:18944
s_waitcnt vmcnt(5)
s_add_u32 m0, s38, 16896
s_nop 0
buffer_load_dwordx4 v8, s[12:15], s44 offen offset:0 nt lds
v_mfma_f32_32x32x16_bf16 a[144:159], a[232:235], v[128:131], a[144:159]
ds_read_b64_tr_b16 a[232:233], v13 offset:16896
ds_read_b64_tr_b16 a[234:235], v13 offset:18944
v_mfma_f32_32x32x16_bf16 a[160:175], a[240:243], v[128:131], a[160:175]
ds_read_b64_tr_b16 a[240:241], v14 offset:16896
v_exp_f32 v136, v16
v_exp_f32 v137, v17
v_exp_f32 v138, v18
v_mfma_f32_32x32x16_bf16 a[176:191], a[248:251], v[128:131], a[176:191]
ds_read_b64_tr_b16 a[242:243], v14 offset:18944
s_waitcnt vmcnt(5)
s_add_u32 m0, s38, 16960
s_nop 0
buffer_load_dwordx4 v8, s[12:15], s44 offen offset:1024 nt lds
v_add_f32 v147, v136, v137
v_cvt_pk_bf16_f32 v112, v136, v137
v_exp_f32 v139, v19
v_mfma_f32_32x32x16_bf16 a[128:143], a[228:231], v[132:135], a[128:143]
ds_read_b64_tr_b16 a[248:249], v15 offset:16896
v_add_f32 v147, v147, v138
v_exp_f32 v140, v20
v_mfma_f32_32x32x16_bf16 a[144:159], a[236:239], v[132:135], a[144:159]
ds_read_b64_tr_b16 a[250:251], v15 offset:18944
v_add_f32 v147, v147, v139
v_cvt_pk_bf16_f32 v113, v138, v139
v_exp_f32 v141, v21
v_mfma_f32_32x32x16_bf16 a[160:175], a[244:247], v[132:135], a[160:175]
ds_read_b64_tr_b16 a[228:229], v12 offset:20992
s_waitcnt vmcnt(5)
s_add_u32 m0, s38, 17024
s_nop 0
buffer_load_dwordx4 v8, s[12:15], s44 offen offset:2048 nt lds
v_add_f32 v147, v147, v140
v_exp_f32 v142, v22
v_add_f32 v147, v147, v141
v_cvt_pk_bf16_f32 v114, v140, v141
v_mfma_f32_32x32x16_bf16 a[176:191], a[252:255], v[132:135], a[176:191]
ds_read_b64_tr_b16 a[230:231], v12 offset:23040
v_exp_f32 v143, v23
v_add_f32 v147, v147, v142
v_exp_f32 v136, v24
v_mfma_f32_32x32x16_bf16 v[32:47], a[192:195], v[192:195], v[80:95]
ds_read_b64_tr_b16 a[236:237], v13 offset:20992
v_add_f32 v147, v147, v143
v_cvt_pk_bf16_f32 v115, v142, v143
v_exp_f32 v137, v25
v_mfma_f32_32x32x16_bf16 v[32:47], a[196:199], v[196:199], v[32:47]
ds_read_b64_tr_b16 a[238:239], v13 offset:23040
s_waitcnt vmcnt(5)
s_add_u32 m0, s38, 17088
s_nop 0
buffer_load_dwordx4 v8, s[12:15], s44 offen offset:3072 nt lds
v_add_f32 v147, v147, v136
v_exp_f32 v138, v26
v_mfma_f32_32x32x16_bf16 v[32:47], a[200:203], v[200:203], v[32:47]
ds_read_b64_tr_b16 a[244:245], v14 offset:20992
v_add_f32 v147, v147, v137
v_cvt_pk_bf16_f32 v116, v136, v137
v_exp_f32 v139, v27
v_add_f32 v147, v147, v138
v_mfma_f32_32x32x16_bf16 v[32:47], a[204:207], v[204:207], v[32:47]
ds_read_b64_tr_b16 a[246:247], v14 offset:23040
v_exp_f32 v140, v28
v_add_f32 v147, v147, v139
v_cvt_pk_bf16_f32 v117, v138, v139
v_mfma_f32_32x32x16_bf16 v[32:47], a[208:211], v[208:211], v[32:47]
ds_read_b64_tr_b16 a[252:253], v15 offset:20992
s_waitcnt vmcnt(5)
s_add_u32 m0, s38, 21248
s_nop 0
buffer_load_dwordx4 v8, s[12:15], s45 offen offset:0 nt lds
v_exp_f32 v141, v29
v_add_f32 v147, v147, v140
v_exp_f32 v142, v30
v_mfma_f32_32x32x16_bf16 v[32:47], a[212:215], v[212:215], v[32:47]
ds_read_b64_tr_b16 a[254:255], v15 offset:23040
v_add_f32 v147, v147, v141
v_cvt_pk_bf16_f32 v118, v140, v141
v_exp_f32 v143, v31
v_mfma_f32_32x32x16_bf16 v[32:47], a[216:219], v[216:219], v[32:47]
v_add_f32 v147, v147, v142
v_add_f32 v147, v147, v143
v_cvt_pk_bf16_f32 v119, v142, v143
v_mfma_f32_32x32x16_bf16 v[32:47], a[220:223], v[220:223], v[32:47]
s_waitcnt vmcnt(5)
s_add_u32 m0, s38, 21312
s_nop 0
buffer_load_dwordx4 v8, s[12:15], s45 offen offset:1024 nt lds
v_cmp_nge_f32 vcc, s46, v147
s_cbranch_vccnz L_tramp_BTs0a
L_back_BTs0a:
v_add_f32 v144, v144, v147
s_waitcnt lgkmcnt(4)
v_mfma_f32_32x32x16_bf16 a[0:15], a[224:227], v[112:115], a[0:15]
v_mfma_f32_32x32x16_bf16 a[16:31], a[232:235], v[112:115], a[16:31]
s_nop 0
v_mfma_f32_32x32x16_bf16 a[32:47], a[240:243], v[112:115], a[32:47]
s_waitcnt vmcnt(5)
s_add_u32 m0, s38, 21376
s_nop 0
buffer_load_dwordx4 v8, s[12:15], s45 offen offset:2048 nt lds
v_exp_f32 v136, v32
v_exp_f32 v137, v33
v_exp_f32 v138, v34
v_mfma_f32_32x32x16_bf16 a[48:63], a[248:251], v[112:115], a[48:63]
v_add_f32 v147, v136, v137
v_cvt_pk_bf16_f32 v120, v136, v137
v_exp_f32 v139, v35
v_mfma_f32_32x32x16_bf16 a[0:15], a[228:231], v[116:119], a[0:15]
v_add_f32 v147, v147, v138
v_exp_f32 v140, v36
v_mfma_f32_32x32x16_bf16 a[16:31], a[236:239], v[116:119], a[16:31]
s_waitcnt vmcnt(5)
s_add_u32 m0, s38, 21440
s_nop 0
buffer_load_dwordx4 v8, s[12:15], s45 offen offset:3072 nt lds
v_add_f32 v147, v147, v139
v_cvt_pk_bf16_f32 v121, v138, v139
v_exp_f32 v141, v37
s_waitcnt lgkmcnt(0)
v_mfma_f32_32x32x16_bf16 a[32:47], a[244:247], v[116:119], a[32:47]
v_add_f32 v147, v147, v140
v_exp_f32 v142, v38
v_add_f32 v147, v147, v141
v_cvt_pk_bf16_f32 v122, v140, v141
v_mfma_f32_32x32x16_bf16 a[48:63], a[252:255], v[116:119], a[48:63]
v_exp_f32 v143, v39
v_add_f32 v147, v147, v142
v_exp_f32 v136, v40
v_mfma_f32_32x32x16_bf16 v[48:63], a[192:195], v[224:227], v[96:111]
s_waitcnt vmcnt(5)
s_add_u32 m0, s38, 25600
s_nop 0
buffer_load_dwordx4 v9, s[16:19], s44 offen offset:0 nt lds
v_add_f32 v147, v147, v143
v_cvt_pk_bf16_f32 v123, v142, v143
v_exp_f32 v137, v41
v_mfma_f32_32x32x16_bf16 v[48:63], a[196:199], v[228:231], v[48:63]
v_add_f32 v147, v147, v136
v_exp_f32 v138, v42
v_mfma_f32_32x32x16_bf16 v[48:63], a[200:203], v[232:235], v[48:63]
v_add_f32 v147, v147, v137
v_cvt_pk_bf16_f32 v124, v136, v137
v_exp_f32 v139, v43
v_add_f32 v147, v147, v138
v_mfma_f32_32x32x16_bf16 v[48:63], a[204:207], v[236:239], v[48:63]
s_waitcnt vmcnt(5)
buffer_load_dwordx4 v9, s[16:19], s44 offen offset:1024 nt lds
v_exp_f32 v140, v44
v_add_f32 v147, v147, v139
v_cvt_pk_bf16_f32 v125, v138, v139
v_mfma_f32_32x32x16_bf16 v[48:63], a[208:211], v[240:243], v[48:63]
v_exp_f32 v141, v45
v_add_f32 v147, v147, v140
v_exp_f32 v142, v46
v_mfma_f32_32x32x16_bf16 v[48:63], a[212:215], v[244:247], v[48:63]
v_add_f32 v147, v147, v141
v_cvt_pk_bf16_f32 v126, v140, v141
v_exp_f32 v143, v47
v_mfma_f32_32x32x16_bf16 v[48:63], a[216:219], v[248:251], v[48:63]
s_waitcnt vmcnt(5)
buffer_load_dwordx4 v9, s[16:19], s44 offen offset:2048 nt lds
v_add_f32 v147, v147, v142
v_add_f32 v147, v147, v143
v_cvt_pk_bf16_f32 v127, v142, v143
v_mfma_f32_32x32x16_bf16 v[48:63], a[220:223], v[252:255], v[48:63]
v_cmp_nge_f32 vcc, s46, v147
s_cbranch_vccnz L_tramp_BTs0b
L_back_BTs0b:
v_add_f32 v145, v145, v147
s_waitcnt vmcnt(19)
v_mfma_f32_32x32x16_bf16 a[64:79], a[224:227], v[120:123], a[64:79]
ds_read_b128 a[192:195], v10 offset:0
ds_read_b128 a[196:199], v11 offset:0
ds_read_b128 a[200:203], v10 offset:64
ds_read_b128 a[204:207], v11 offset:64
v_mfma_f32_32x32x16_bf16 a[80:95], a[232:235], v[120:123], a[80:95]
ds_read_b128 a[208:211], v10 offset:128
ds_read_b128 a[212:215], v11 offset:128
ds_read_b128 a[216:219], v10 offset:192
ds_read_b128 a[220:223], v11 offset:192
s_waitcnt vmcnt(5)
buffer_load_dwordx4 v9, s[16:19], s44 offen offset:3072 nt lds
v_mfma_f32_32x32x16_bf16 a[96:111], a[240:243], v[120:123], a[96:111]
v_exp_f32 v136, v48
v_exp_f32 v137, v49
v_exp_f32 v138, v50
v_mfma_f32_32x32x16_bf16 a[112:127], a[248:251], v[120:123], a[112:127]
v_add_f32 v147, v136, v137
v_cvt_pk_bf16_f32 v128, v136, v137
v_exp_f32 v139, v51
v_mfma_f32_32x32x16_bf16 a[64:79], a[228:231], v[124:127], a[64:79]
s_waitcnt vmcnt(5)
s_add_u32 m0, s38, 29696
s_nop 0
buffer_load_dwordx4 v9, s[16:19], s45 offen offset:0 nt lds
v_add_f32 v147, v147, v138
v_exp_f32 v140, v52
v_mfma_f32_32x32x16_bf16 a[80:95], a[236:239], v[124:127], a[80:95]
v_add_f32 v147, v147, v139
v_cvt_pk_bf16_f32 v129, v138, v139
v_exp_f32 v141, v53
v_mfma_f32_32x32x16_bf16 a[96:111], a[244:247], v[124:127], a[96:111]
v_add_f32 v147, v147, v140
v_exp_f32 v142, v54
v_add_f32 v147, v147, v141
v_cvt_pk_bf16_f32 v130, v140, v141
v_mfma_f32_32x32x16_bf16 a[112:127], a[252:255], v[124:127], a[112:127]
s_waitcnt vmcnt(5)
buffer_load_dwordx4 v9, s[16:19], s45 offen offset:1024 nt lds
v_exp_f32 v143, v55
v_add_f32 v147, v147, v142
v_exp_f32 v136, v56
s_waitcnt lgkmcnt(0)
v_mfma_f32_32x32x16_bf16 v[16:31], a[192:195], v[160:163], v[64:79]
v_add_f32 v147, v147, v143
v_cvt_pk_bf16_f32 v131, v142, v143
v_exp_f32 v137, v57
v_mfma_f32_32x32x16_bf16 v[16:31], a[196:199], v[164:167], v[16:31]
v_add_f32 v147, v147, v136
v_exp_f32 v138, v58
v_mfma_f32_32x32x16_bf16 v[16:31], a[200:203], v[168:171], v[16:31]
s_waitcnt vmcnt(5)
buffer_load_dwordx4 v9, s[16:19], s45 offen offset:2048 nt lds
v_add_f32 v147, v147, v137
v_cvt_pk_bf16_f32 v132, v136, v137
v_exp_f32 v139, v59
v_add_f32 v147, v147, v138
v_mfma_f32_32x32x16_bf16 v[16:31], a[204:207], v[172:175], v[16:31]
v_exp_f32 v140, v60
v_add_f32 v147, v147, v139
v_cvt_pk_bf16_f32 v133, v138, v139
v_mfma_f32_32x32x16_bf16 v[16:31], a[208:211], v[176:179], v[16:31]
v_exp_f32 v141, v61
v_add_f32 v147, v147, v140
v_exp_f32 v142, v62
v_mfma_f32_32x32x16_bf16 v[16:31], a[212:215], v[180:183], v[16:31]
s_waitcnt vmcnt(5)
buffer_load_dwordx4 v9, s[16:19], s45 offen offset:3072 nt lds
v_add_f32 v147, v147, v141
v_cvt_pk_bf16_f32 v134, v140, v141
v_exp_f32 v143, v63
v_mfma_f32_32x32x16_bf16 v[16:31], a[216:219], v[184:187], v[16:31]
s_add_u32 s44, s44, 8192
s_and_b32 s44, s44, 0x3ffff
s_add_u32 s45, s44, 4096
s_and_b32 s45, s45, 0x3ffff
v_add_f32 v147, v147, v142
v_add_f32 v147, v147, v143
v_cvt_pk_bf16_f32 v135, v142, v143
v_mfma_f32_32x32x16_bf16 v[16:31], a[220:223], v[188:191], v[16:31]
v_cmp_nge_f32 vcc, s46, v147
s_cbranch_vccnz L_tramp_BTs0c
L_back_BTs0c:
v_add_f32 v146, v146, v147
s_waitcnt vmcnt(16)
v_mfma_f32_32x32x16_bf16 a[128:143], a[224:227], v[128:131], a[128:143]
ds_read_b64_tr_b16 a[224:225], v12 offset:0
ds_read_b64_tr_b16 a[226:227], v12 offset:2048
s_waitcnt vmcnt(5)
s_add_u32 m0, s38, 0
s_nop 0
buffer_load_dwordx4 v8, s[12:15], s44 offen offset:0 nt lds
v_mfma_f32_32x32x16_bf16 a[144:159], a[232:235], v[128:131], a[144:159]
ds_read_b64_tr_b16 a[232:233], v13 offset:0
ds_read_b64_tr_b16 a[234:235], v13 offset:2048
v_mfma_f32_32x32x16_bf16 a[160:175], a[240:243], v[128:131], a[160:175]
ds_read_b64_tr_b16 a[240:241], v14 offset:0
v_exp_f32 v136, v16
v_exp_f32 v137, v17
v_exp_f32 v138, v18
v_mfma_f32_32x32x16_bf16 a[176:191], a[248:251], v[128:131], a[176:191]
ds_read_b64_tr_b16 a[242:243], v14 offset:2048
s_waitcnt vmcnt(5)
s_add_u32 m0, s38, 64
s_nop 0
buffer_load_dwordx4 v8, s[12:15], s44 offen offset:1024 nt lds
v_add_f32 v147, v136, v137
v_cvt_pk_bf16_f32 v112, v136, v137
v_exp_f32 v139, v19
v_mfma_f32_32x32x16_bf16 a[128:143], a[228:231], v[132:135], a[128:143]
ds_read_b64_tr_b16 a[248:249], v15 offset:0
v_add_f32 v147, v147, v138
v_exp_f32 v140, v20
v_mfma_f32_32x32x16_bf16 a[144:159], a[236:239], v[132:135], a[144:159]
ds_read_b64_tr_b16 a[250:251], v15 offset:2048
v_add_f32 v147, v147, v139
v_cvt_pk_bf16_f32 v113, v138, v139
v_exp_f32 v141, v21
v_mfma_f32_32x32x16_bf16 a[160:175], a[244:247], v[132:135], a[160:175]
ds_read_b64_tr_b16 a[228:229], v12 offset:4096
s_waitcnt vmcnt(5)
s_add_u32 m0, s38, 128
s_nop 0
buffer_load_dwordx4 v8, s[12:15], s44 offen offset:2048 nt lds
v_add_f32 v147, v147, v140
v_exp_f32 v142, v22
v_add_f32 v147, v147, v141
v_cvt_pk_bf16_f32 v114, v140, v141
v_mfma_f32_32x32x16_bf16 a[176:191], a[252:255], v[132:135], a[176:191]
ds_read_b64_tr_b16 a[230:231], v12 offset:6144
v_exp_f32 v143, v23
v_add_f32 v147, v147, v142
v_exp_f32 v136, v24
v_mfma_f32_32x32x16_bf16 v[32:47], a[192:195], v[192:195], v[80:95]
ds_read_b64_tr_b16 a[236:237], v13 offset:4096
v_add_f32 v147, v147, v143
v_cvt_pk_bf16_f32 v115, v142, v143
v_exp_f32 v137, v25
v_mfma_f32_32x32x16_bf16 v[32:47], a[196:199], v[196:199], v[32:47]
ds_read_b64_tr_b16 a[238:239], v13 offset:6144
s_waitcnt vmcnt(5)
s_add_u32 m0, s38, 192
s_nop 0
buffer_load_dwordx4 v8, s[12:15], s44 offen offset:3072 nt lds
v_add_f32 v147, v147, v136
v_exp_f32 v138, v26
v_mfma_f32_32x32x16_bf16 v[32:47], a[200:203], v[200:203], v[32:47]
ds_read_b64_tr_b16 a[244:245], v14 offset:4096
v_add_f32 v147, v147, v137
v_cvt_pk_bf16_f32 v116, v136, v137
v_exp_f32 v139, v27
v_add_f32 v147, v147, v138
v_mfma_f32_32x32x16_bf16 v[32:47], a[204:207], v[204:207], v[32:47]
ds_read_b64_tr_b16 a[246:247], v14 offset:6144
v_exp_f32 v140, v28
v_add_f32 v147, v147, v139
v_cvt_pk_bf16_f32 v117, v138, v139
v_mfma_f32_32x32x16_bf16 v[32:47], a[208:211], v[208:211], v[32:47]
ds_read_b64_tr_b16 a[252:253], v15 offset:4096
s_waitcnt vmcnt(5)
s_add_u32 m0, s38, 4352
s_nop 0
buffer_load_dwordx4 v8, s[12:15], s45 offen offset:0 nt lds
v_exp_f32 v141, v29
v_add_f32 v147, v147, v140
v_exp_f32 v142, v30
v_mfma_f32_32x32x16_bf16 v[32:47], a[212:215], v[212:215], v[32:47]
ds_read_b64_tr_b16 a[254:255], v15 offset:6144
v_add_f32 v147, v147, v141
v_cvt_pk_bf16_f32 v118, v140, v141
v_exp_f32 v143, v31
v_mfma_f32_32x32x16_bf16 v[32:47], a[216:219], v[216:219], v[32:47]
v_add_f32 v147, v147, v142
v_add_f32 v147, v147, v143
v_cvt_pk_bf16_f32 v119, v142, v143
v_mfma_f32_32x32x16_bf16 v[32:47], a[220:223], v[220:223], v[32:47]
s_waitcnt vmcnt(5)
s_add_u32 m0, s38, 4416
s_nop 0
buffer_load_dwordx4 v8, s[12:15], s45 offen offset:1024 nt lds
v_cmp_nge_f32 vcc, s46, v147
s_cbranch_vccnz L_tramp_BTs1a
L_back_BTs1a:
v_add_f32 v144, v144, v147
s_waitcnt lgkmcnt(4)
v_mfma_f32_32x32x16_bf16 a[0:15], a[224:227], v[112:115], a[0:15]
v_mfma_f32_32x32x16_bf16 a[16:31], a[232:235], v[112:115], a[16:31]
s_nop 0
v_mfma_f32_32x32x16_bf16 a[32:47], a[240:243], v[112:115], a[32:47]
s_waitcnt vmcnt(5)
s_add_u32 m0, s38, 4480
s_nop 0
buffer_load_dwordx4 v8, s[12:15], s45 offen offset:2048 nt lds
v_exp_f32 v136, v32
v_exp_f32 v137, v33
v_exp_f32 v138, v34
v_mfma_f32_32x32x16_bf16 a[48:63], a[248:251], v[112:115], a[48:63]
v_add_f32 v147, v136, v137
v_cvt_pk_bf16_f32 v120, v136, v137
v_exp_f32 v139, v35
v_mfma_f32_32x32x16_bf16 a[0:15], a[228:231], v[116:119], a[0:15]
v_add_f32 v147, v147, v138
v_exp_f32 v140, v36
v_mfma_f32_32x32x16_bf16 a[16:31], a[236:239], v[116:119], a[16:31]
s_waitcnt vmcnt(5)
s_add_u32 m0, s38, 4544
s_nop 0
buffer_load_dwordx4 v8, s[12:15], s45 offen offset:3072 nt lds
v_add_f32 v147, v147, v139
v_cvt_pk_bf16_f32 v121, v138, v139
v_exp_f32 v141, v37
s_waitcnt lgkmcnt(0)
v_mfma_f32_32x32x16_bf16 a[32:47], a[244:247], v[116:119], a[32:47]
v_add_f32 v147, v147, v140
v_exp_f32 v142, v38
v_add_f32 v147, v147, v141
v_cvt_pk_bf16_f32 v122, v140, v141
v_mfma_f32_32x32x16_bf16 a[48:63], a[252:255], v[116:119], a[48:63]
v_exp_f32 v143, v39
v_add_f32 v147, v147, v142
v_exp_f32 v136, v40
v_mfma_f32_32x32x16_bf16 v[48:63], a[192:195], v[224:227], v[96:111]
s_waitcnt vmcnt(5)
s_add_u32 m0, s38, 8704
s_nop 0
buffer_load_dwordx4 v9, s[16:19], s44 offen offset:0 nt lds
v_add_f32 v147, v147, v143
v_cvt_pk_bf16_f32 v123, v142, v143
v_exp_f32 v137, v41
v_mfma_f32_32x32x16_bf16 v[48:63], a[196:199], v[228:231], v[48:63]
v_add_f32 v147, v147, v136
v_exp_f32 v138, v42
v_mfma_f32_32x32x16_bf16 v[48:63], a[200:203], v[232:235], v[48:63]
v_add_f32 v147, v147, v137
v_cvt_pk_bf16_f32 v124, v136, v137
v_exp_f32 v139, v43
v_add_f32 v147, v147, v138
v_mfma_f32_32x32x16_bf16 v[48:63], a[204:207], v[236:239], v[48:63]
s_waitcnt vmcnt(5)
buffer_load_dwordx4 v9, s[16:19], s44 offen offset:1024 nt lds
v_exp_f32 v140, v44
v_add_f32 v147, v147, v139
v_cvt_pk_bf16_f32 v125, v138, v139
v_mfma_f32_32x32x16_bf16 v[48:63], a[208:211], v[240:243], v[48:63]
v_exp_f32 v141, v45
v_add_f32 v147, v147, v140
v_exp_f32 v142, v46
v_mfma_f32_32x32x16_bf16 v[48:63], a[212:215], v[244:247], v[48:63]
v_add_f32 v147, v147, v141
v_cvt_pk_bf16_f32 v126, v140, v141
v_exp_f32 v143, v47
v_mfma_f32_32x32x16_bf16 v[48:63], a[216:219], v[248:251], v[48:63]
s_waitcnt vmcnt(5)
buffer_load_dwordx4 v9, s[16:19], s44 offen offset:2048 nt lds
v_add_f32 v147, v147, v142
v_add_f32 v147, v147, v143
v_cvt_pk_bf16_f32 v127, v142, v143
v_mfma_f32_32x32x16_bf16 v[48:63], a[220:223], v[252:255], v[48:63]
v_cmp_nge_f32 vcc, s46, v147
s_cbranch_vccnz L_tramp_BTs1b
L_back_BTs1b:
v_add_f32 v145, v145, v147
s_waitcnt vmcnt(19)
v_mfma_f32_32x32x16_bf16 a[64:79], a[224:227], v[120:123], a[64:79]
ds_read_b128 a[192:195], v10 offset:16896
ds_read_b128 a[196:199], v11 offset:16896
ds_read_b128 a[200:203], v10 offset:16960
ds_read_b128 a[204:207], v11 offset:16960
v_mfma_f32_32x32x16_bf16 a[80:95], a[232:235], v[120:123], a[80:95]
ds_read_b128 a[208:211], v10 offset:17024
ds_read_b128 a[212:215], v11 offset:17024
ds_read_b128 a[216:219], v10 offset:17088
ds_read_b128 a[220:223], v11 offset:17088
s_waitcnt vmcnt(5)
buffer_load_dwordx4 v9, s[16:19], s44 offen offset:3072 nt lds
v_mfma_f32_32x32x16_bf16 a[96:111], a[240:243], v[120:123], a[96:111]
v_exp_f32 v136, v48
v_exp_f32 v137, v49
v_exp_f32 v138, v50
v_mfma_f32_32x32x16_bf16 a[112:127], a[248:251], v[120:123], a[112:127]
v_add_f32 v147, v136, v137
v_cvt_pk_bf16_f32 v128, v136, v137
v_exp_f32 v139, v51
v_mfma_f32_32x32x16_bf16 a[64:79], a[228:231], v[124:127], a[64:79]
s_waitcnt vmcnt(5)
s_add_u32 m0, s38, 12800
s_nop 0
buffer_load_dwordx4 v9, s[16:19], s45 offen offset:0 nt lds
v_add_f32 v147, v147, v138
v_exp_f32 v140, v52
v_mfma_f32_32x32x16_bf16 a[80:95], a[236:239], v[124:127], a[80:95]
v_add_f32 v147, v147, v139
v_cvt_pk_bf16_f32 v129, v138, v139
v_exp_f32 v141, v53
v_mfma_f32_32x32x16_bf16 a[96:111], a[244:247], v[124:127], a[96:111]
v_add_f32 v147, v147, v140
v_exp_f32 v142, v54
v_add_f32 v147, v147, v141
v_cvt_pk_bf16_f32 v130, v140, v141
v_mfma_f32_32x32x16_bf16 a[112:127], a[252:255], v[124:127], a[112:127]
s_waitcnt vmcnt(5)
buffer_load_dwordx4 v9, s[16:19], s45 offen offset:1024 nt lds
v_exp_f32 v143, v55
v_add_f32 v147, v147, v142
v_exp_f32 v136, v56
s_waitcnt lgkmcnt(0)
v_mfma_f32_32x32x16_bf16 v[16:31], a[192:195], v[160:163], v[64:79]
v_add_f32 v147, v147, v143
v_cvt_pk_bf16_f32 v131, v142, v143
v_exp_f32 v137, v57
v_mfma_f32_32x32x16_bf16 v[16:31], a[196:199], v[164:167], v[16:31]
v_add_f32 v147, v147, v136
v_exp_f32 v138, v58
v_mfma_f32_32x32x16_bf16 v[16:31], a[200:203], v[168:171], v[16:31]
s_waitcnt vmcnt(5)
buffer_load_dwordx4 v9, s[16:19], s45 offen offset:2048 nt lds
v_add_f32 v147, v147, v137
v_cvt_pk_bf16_f32 v132, v136, v137
v_exp_f32 v139, v59
v_add_f32 v147, v147, v138
v_mfma_f32_32x32x16_bf16 v[16:31], a[204:207], v[172:175], v[16:31]
v_exp_f32 v140, v60
v_add_f32 v147, v147, v139
v_cvt_pk_bf16_f32 v133, v138, v139
v_mfma_f32_32x32x16_bf16 v[16:31], a[208:211], v[176:179], v[16:31]
v_exp_f32 v141, v61
v_add_f32 v147, v147, v140
v_exp_f32 v142, v62
v_mfma_f32_32x32x16_bf16 v[16:31], a[212:215], v[180:183], v[16:31]
s_waitcnt vmcnt(5)
buffer_load_dwordx4 v9, s[16:19], s45 offen offset:3072 nt lds
v_add_f32 v147, v147, v141
v_cvt_pk_bf16_f32 v134, v140, v141
v_exp_f32 v143, v63
v_mfma_f32_32x32x16_bf16 v[16:31], a[216:219], v[184:187], v[16:31]
s_add_u32 s44, s44, 8192
s_and_b32 s44, s44, 0x3ffff
s_add_u32 s45, s44, 4096
s_and_b32 s45, s45, 0x3ffff
v_add_f32 v147, v147, v142
v_add_f32 v147, v147, v143
v_cvt_pk_bf16_f32 v135, v142, v143
v_mfma_f32_32x32x16_bf16 v[16:31], a[220:223], v[188:191], v[16:31]
v_cmp_nge_f32 vcc, s46, v147
s_cbranch_vccnz L_tramp_BTs1c
L_back_BTs1c:
v_add_f32 v146, v146, v147
s_branch L_tailB
L_lastB:
s_waitcnt vmcnt(16)
v_mfma_f32_32x32x16_bf16 a[128:143], a[224:227], v[128:131], a[128:143]
ds_read_b64_tr_b16 a[224:225], v12 offset:16896
ds_read_b64_tr_b16 a[226:227], v12 offset:18944
v_mfma_f32_32x32x16_bf16 a[144:159], a[232:235], v[128:131], a[144:159]
ds_read_b64_tr_b16 a[232:233], v13 offset:16896
ds_read_b64_tr_b16 a[234:235], v13 offset:18944
v_mfma_f32_32x32x16_bf16 a[160:175], a[240:243], v[128:131], a[160:175]
ds_read_b64_tr_b16 a[240:241], v14 offset:16896
v_exp_f32 v136, v16
v_exp_f32 v137, v17
v_exp_f32 v138, v18
v_mfma_f32_32x32x16_bf16 a[176:191], a[248:251], v[128:131], a[176:191]
ds_read_b64_tr_b16 a[242:243], v14 offset:18944
s_lshr_b32 s29, s27, 1
s_mul_i32 s29, s29, 3
s_lshr_b32 s29, s29, 1
s_lshl_b32 s42, s3, 2
s_add_u32 s42, s42, 4
v_add_f32 v147, v136, v137
v_cvt_pk_bf16_f32 v112, v136, v137
v_exp_f32 v139, v19
v_mfma_f32_32x32x16_bf16 a[128:143], a[228:231], v[132:135], a[128:143]
ds_read_b64_tr_b16 a[248:249], v15 offset:16896
s_add_u32 s35, s29, s42
s_and_b32 s35, s35, 15
s_add_u32 s29, s29, 1
s_cmp_eq_u32 s29, 12
s_cselect_b32 s29, 0, s29
v_add_f32 v147, v147, v138
v_exp_f32 v140, v20
v_mfma_f32_32x32x16_bf16 a[144:159], a[236:239], v[132:135], a[144:159]
ds_read_b64_tr_b16 a[250:251], v15 offset:18944
s_mul_i32 s64, s35, 36864
s_add_u32 s64, s64, s32
s_lshr_b32 s34, s35, 2
s_and_b32 s35, s35, 3
s_mul_i32 s76, s34, 34816
v_add_f32 v147, v147, v139
v_cvt_pk_bf16_f32 v113, v138, v139
v_exp_f32 v141, v21
v_mfma_f32_32x32x16_bf16 a[160:175], a[244:247], v[132:135], a[160:175]
ds_read_b64_tr_b16 a[228:229], v12 offset:20992
s_mul_i32 s37, s35, 6144
s_add_u32 s76, s76, s37
s_mul_i32 s34, s34, 6144
s_add_u32 s34, s34, 139264
s_cmp_eq_u32 s35, 3
s_cselect_b32 s76, s34, s76
v_add_f32 v147, v147, v140
v_exp_f32 v142, v22
v_add_f32 v147, v147, v141
v_cvt_pk_bf16_f32 v114, v140, v141
v_mfma_f32_32x32x16_bf16 a[176:191], a[252:255], v[132:135], a[176:191]
ds_read_b64_tr_b16 a[230:231], v12 offset:23040
s_add_u32 s35, s29, s42
s_and_b32 s35, s35, 15
s_add_u32 s29, s29, 1
s_cmp_eq_u32 s29, 12
s_cselect_b32 s29, 0, s29
v_exp_f32 v143, v23
v_add_f32 v147, v147, v142
v_exp_f32 v136, v24
v_mfma_f32_32x32x16_bf16 v[32:47], a[192:195], v[192:195], v[80:95]
ds_read_b64_tr_b16 a[236:237], v13 offset:20992
s_mul_i32 s65, s35, 36864
s_add_u32 s65, s65, s32
s_lshr_b32 s34, s35, 2
s_and_b32 s35, s35, 3
s_mul_i32 s77, s34, 34816
v_add_f32 v147, v147, v143
v_cvt_pk_bf16_f32 v115, v142, v143
v_exp_f32 v137, v25
v_mfma_f32_32x32x16_bf16 v[32:47], a[196:199], v[196:199], v[32:47]
ds_read_b64_tr_b16 a[238:239], v13 offset:23040
s_mul_i32 s37, s35, 6144
s_add_u32 s77, s77, s37
s_mul_i32 s34, s34, 6144
s_add_u32 s34, s34, 139264
s_cmp_eq_u32 s35, 3
s_cselect_b32 s77, s34, s77
v_add_f32 v147, v147, v136
v_exp_f32 v138, v26
v_mfma_f32_32x32x16_bf16 v[32:47], a[200:203], v[200:203], v[32:47]
ds_read_b64_tr_b16 a[244:245], v14 offset:20992
s_add_u32 s35, s29, s42
s_and_b32 s35, s35, 15
s_add_u32 s29, s29, 1
s_cmp_eq_u32 s29, 12
s_cselect_b32 s29, 0, s29
v_add_f32 v147, v147, v137
v_cvt_pk_bf16_f32 v116, v136, v137
v_exp_f32 v139, v27
v_add_f32 v147, v147, v138
v_mfma_f32_32x32x16_bf16 v[32:47], a[204:207], v[204:207], v[32:47]
ds_read_b64_tr_b16 a[246:247], v14 offset:23040
s_mul_i32 s66, s35, 36864
s_add_u32 s66, s66, s32
s_lshr_b32 s34, s35, 2
s_and_b32 s35, s35, 3
s_mul_i32 s78, s34, 34816
v_exp_f32 v140, v28
v_add_f32 v147, v147, v139
v_cvt_pk_bf16_f32 v117, v138, v139
v_mfma_f32_32x32x16_bf16 v[32:47], a[208:211], v[208:211], v[32:47]
ds_read_b64_tr_b16 a[252:253], v15 offset:20992
s_mul_i32 s37, s35, 6144
s_add_u32 s78, s78, s37
s_mul_i32 s34, s34, 6144
s_add_u32 s34, s34, 139264
s_cmp_eq_u32 s35, 3
s_cselect_b32 s78, s34, s78
v_exp_f32 v141, v29
v_add_f32 v147, v147, v140
v_exp_f32 v142, v30
v_mfma_f32_32x32x16_bf16 v[32:47], a[212:215], v[212:215], v[32:47]
ds_read_b64_tr_b16 a[254:255], v15 offset:23040
s_add_u32 s35, s29, s42
s_and_b32 s35, s35, 15
s_add_u32 s29, s29, 1
s_cmp_eq_u32 s29, 12
s_cselect_b32 s29, 0, s29
v_add_f32 v147, v147, v141
v_cvt_pk_bf16_f32 v118, v140, v141
v_exp_f32 v143, v31
v_mfma_f32_32x32x16_bf16 v[32:47], a[216:219], v[216:219], v[32:47]
s_mul_i32 s67, s35, 36864
s_add_u32 s67, s67, s32
s_lshr_b32 s34, s35, 2
s_and_b32 s35, s35, 3
s_mul_i32 s79, s34, 34816
v_add_f32 v147, v147, v142
v_add_f32 v147, v147, v143
v_cvt_pk_bf16_f32 v119, v142, v143
v_mfma_f32_32x32x16_bf16 v[32:47], a[220:223], v[220:223], v[32:47]
s_mul_i32 s37, s35, 6144
s_add_u32 s79, s79, s37
s_mul_i32 s34, s34, 6144
s_add_u32 s34, s34, 139264
s_cmp_eq_u32 s35, 3
s_cselect_b32 s79, s34, s79
v_cmp_nge_f32 vcc, s46, v147
s_cbranch_vccnz L_tramp_Bp0a
L_back_Bp0a:
v_add_f32 v144, v144, v147
s_waitcnt lgkmcnt(4)
v_mfma_f32_32x32x16_bf16 a[0:15], a[224:227], v[112:115], a[0:15]
s_add_u32 s35, s29, s42
s_and_b32 s35, s35, 15
s_add_u32 s29, s29, 1
s_cmp_eq_u32 s29, 12
s_cselect_b32 s29, 0, s29
v_mfma_f32_32x32x16_bf16 a[16:31], a[232:235], v[112:115], a[16:31]
s_mul_i32 s68, s35, 36864
s_add_u32 s68, s68, s32
s_lshr_b32 s34, s35, 2
s_and_b32 s35, s35, 3
s_mul_i32 s80, s34, 34816
v_mfma_f32_32x32x16_bf16 a[32:47], a[240:243], v[112:115], a[32:47]
s_mul_i32 s37, s35, 6144
s_add_u32 s80, s80, s37
s_mul_i32 s34, s34, 6144
s_add_u32 s34, s34, 139264
s_cmp_eq_u32 s35, 3
s_cselect_b32 s80, s34, s80
v_exp_f32 v136, v32
v_exp_f32 v137, v33
v_exp_f32 v138, v34
v_mfma_f32_32x32x16_bf16 a[48:63], a[248:251], v[112:115], a[48:63]
s_add_u32 s35, s29, s42
s_and_b32 s35, s35, 15
s_add_u32 s29, s29, 1
s_cmp_eq_u32 s29, 12
s_cselect_b32 s29, 0, s29
v_add_f32 v147, v136, v137
v_cvt_pk_bf16_f32 v120, v136, v137
v_exp_f32 v139, v35
v_mfma_f32_32x32x16_bf16 a[0:15], a[228:231], v[116:119], a[0:15]
s_mul_i32 s69, s35, 36864
s_add_u32 s69, s69, s32
s_lshr_b32 s34, s35, 2
s_and_b32 s35, s35, 3
s_mul_i32 s81, s34, 34816
v_add_f32 v147, v147, v138
v_exp_f32 v140, v36
v_mfma_f32_32x32x16_bf16 a[16:31], a[236:239], v[116:119], a[16:31]
s_mul_i32 s37, s35, 6144
s_add_u32 s81, s81, s37
s_mul_i32 s34, s34, 6144
s_add_u32 s34, s34, 139264
s_cmp_eq_u32 s35, 3
s_cselect_b32 s81, s34, s81
v_add_f32 v147, v147, v139
v_cvt_pk_bf16_f32 v121, v138, v139
v_exp_f32 v141, v37
s_waitcnt lgkmcnt(0)
v_mfma_f32_32x32x16_bf16 a[32:47], a[244:247], v[116:119], a[32:47]
s_add_u32 s35, s29, s42
s_and_b32 s35, s35, 15
s_add_u32 s29, s29, 1
s_cmp_eq_u32 s29, 12
s_cselect_b32 s29, 0, s29
v_add_f32 v147, v147, v140
v_exp_f32 v142, v38
v_add_f32 v147, v147, v141
v_cvt_pk_bf16_f32 v122, v140, v141
v_mfma_f32_32x32x16_bf16 a[48:63], a[252:255], v[116:119], a[48:63]
s_mul_i32 s70, s35, 36864
s_add_u32 s70, s70, s32
s_lshr_b32 s34, s35, 2
s_and_b32 s35, s35, 3
s_mul_i32 s82, s34, 34816
v_exp_f32 v143, v39
v_add_f32 v147, v147, v142
v_exp_f32 v136, v40
v_mfma_f32_32x32x16_bf16 v[48:63], a[192:195], v[224:227], v[96:111]
s_mul_i32 s37, s35, 6144
s_add_u32 s82, s82, s37
s_mul_i32 s34, s34, 6144
s_add_u32 s34, s34, 139264
s_cmp_eq_u32 s35, 3
s_cselect_b32 s82, s34, s82
v_add_f32 v147, v147, v143
v_cvt_pk_bf16_f32 v123, v142, v143
v_exp_f32 v137, v41
v_mfma_f32_32x32x16_bf16 v[48:63], a[196:199], v[228:231], v[48:63]
s_add_u32 s35, s29, s42
s_and_b32 s35, s35, 15
s_add_u32 s29, s29, 1
s_cmp_eq_u32 s29, 12
s_cselect_b32 s29, 0, s29
v_add_f32 v147, v147, v136
v_exp_f32 v138, v42
v_mfma_f32_32x32x16_bf16 v[48:63], a[200:203], v[232:235], v[48:63]
s_mul_i32 s71, s35, 36864
s_add_u32 s71, s71, s32
s_lshr_b32 s34, s35, 2
s_and_b32 s35, s35, 3
s_mul_i32 s83, s34, 34816
v_add_f32 v147, v147, v137
v_cvt_pk_bf16_f32 v124, v136, v137
v_exp_f32 v139, v43
v_add_f32 v147, v147, v138
v_mfma_f32_32x32x16_bf16 v[48:63], a[204:207], v[236:239], v[48:63]
s_mul_i32 s37, s35, 6144
s_add_u32 s83, s83, s37
s_mul_i32 s34, s34, 6144
s_add_u32 s34, s34, 139264
s_cmp_eq_u32 s35, 3
s_cselect_b32 s83, s34, s83
v_exp_f32 v140, v44
v_add_f32 v147, v147, v139
v_cvt_pk_bf16_f32 v125, v138, v139
v_mfma_f32_32x32x16_bf16 v[48:63], a[208:211], v[240:243], v[48:63]
s_add_u32 s35, s29, s42
s_and_b32 s35, s35, 15
s_add_u32 s29, s29, 1
s_cmp_eq_u32 s29, 12
s_cselect_b32 s29, 0, s29
v_exp_f32 v141, v45
v_add_f32 v147, v147, v140
v_exp_f32 v142, v46
v_mfma_f32_32x32x16_bf16 v[48:63], a[212:215], v[244:247], v[48:63]
s_mul_i32 s72, s35, 36864
s_add_u32 s72, s72, s32
s_lshr_b32 s34, s35, 2
s_and_b32 s35, s35, 3
s_mul_i32 s8, s34, 34816
v_add_f32 v147, v147, v141
v_cvt_pk_bf16_f32 v126, v140, v141
v_exp_f32 v143, v47
v_mfma_f32_32x32x16_bf16 v[48:63], a[216:219], v[248:251], v[48:63]
s_mul_i32 s37, s35, 6144
s_add_u32 s8, s8, s37
s_mul_i32 s34, s34, 6144
s_add_u32 s34, s34, 139264
s_cmp_eq_u32 s35, 3
s_cselect_b32 s8, s34, s8
v_add_f32 v147, v147, v142
v_add_f32 v147, v147, v143
v_cvt_pk_bf16_f32 v127, v142, v143
v_mfma_f32_32x32x16_bf16 v[48:63], a[220:223], v[252:255], v[48:63]
s_add_u32 s35, s29, s42
s_and_b32 s35, s35, 15
s_add_u32 s29, s29, 1
s_cmp_eq_u32 s29, 12
s_cselect_b32 s29, 0, s29
v_cmp_nge_f32 vcc, s46, v147
s_cbranch_vccnz L_tramp_Bp0b
L_back_Bp0b:
v_add_f32 v145, v145, v147
s_waitcnt vmcnt(8)
v_mfma_f32_32x32x16_bf16 a[64:79], a[224:227], v[120:123], a[64:79]
ds_read_b128 a[192:195], v10 offset:0
ds_read_b128 a[196:199], v11 offset:0
ds_read_b128 a[200:203], v10 offset:64
ds_read_b128 a[204:207], v11 offset:64
s_mul_i32 s73, s35, 36864
s_add_u32 s73, s73, s32
s_lshr_b32 s34, s35, 2
s_and_b32 s35, s35, 3
s_mul_i32 s9, s34, 34816
v_mfma_f32_32x32x16_bf16 a[80:95], a[232:235], v[120:123], a[80:95]
ds_read_b128 a[208:211], v10 offset:128
ds_read_b128 a[212:215], v11 offset:128
ds_read_b128 a[216:219], v10 offset:192
ds_read_b128 a[220:223], v11 offset:192
s_mul_i32 s37, s35, 6144
s_add_u32 s9, s9, s37
s_mul_i32 s34, s34, 6144
s_add_u32 s34, s34, 139264
s_cmp_eq_u32 s35, 3
s_cselect_b32 s9, s34, s9
v_mfma_f32_32x32x16_bf16 a[96:111], a[240:243], v[120:123], a[96:111]
s_add_u32 s35, s29, s42
s_and_b32 s35, s35, 15
s_add_u32 s29, s29, 1
s_cmp_eq_u32 s29, 12
s_cselect_b32 s29, 0, s29
v_exp_f32 v136, v48
v_exp_f32 v137, v49
v_exp_f32 v138, v50
v_mfma_f32_32x32x16_bf16 a[112:127], a[248:251], v[120:123], a[112:127]
s_mul_i32 s74, s35, 36864
s_add_u32 s74, s74, s32
s_lshr_b32 s34, s35, 2
s_and_b32 s35, s35, 3
s_mul_i32 s10, s34, 34816
v_add_f32 v147, v136, v137
v_cvt_pk_bf16_f32 v128, v136, v137
v_exp_f32 v139, v51
v_mfma_f32_32x32x16_bf16 a[64:79], a[228:231], v[124:127], a[64:79]
s_mul_i32 s37, s35, 6144
s_add_u32 s10, s10, s37
s_mul_i32 s34, s34, 6144
s_add_u32 s34, s34, 139264
s_cmp_eq_u32 s35, 3
s_cselect_b32 s10, s34, s10
v_add_f32 v147, v147, v138
v_exp_f32 v140, v52
v_mfma_f32_32x32x16_bf16 a[80:95], a[236:239], v[124:127], a[80:95]
s_add_u32 s35, s29, s42
s_and_b32 s35, s35, 15
s_add_u32 s29, s29, 1
s_cmp_eq_u32 s29, 12
s_cselect_b32 s29, 0, s29
v_add_f32 v147, v147, v139
v_cvt_pk_bf16_f32 v129, v138, v139
v_exp_f32 v141, v53
v_mfma_f32_32x32x16_bf16 a[96:111], a[244:247], v[124:127], a[96:111]
s_mul_i32 s75, s35, 36864
s_add_u32 s75, s75, s32
s_lshr_b32 s34, s35, 2
s_and_b32 s35, s35, 3
s_mul_i32 s11, s34, 34816
v_add_f32 v147, v147, v140
v_exp_f32 v142, v54
v_add_f32 v147, v147, v141
v_cvt_pk_bf16_f32 v130, v140, v141
v_mfma_f32_32x32x16_bf16 a[112:127], a[252:255], v[124:127], a[112:127]
s_mul_i32 s37, s35, 6144
s_add_u32 s11, s11, s37
s_mul_i32 s34, s34, 6144
s_add_u32 s34, s34, 139264
s_cmp_eq_u32 s35, 3
s_cselect_b32 s11, s34, s11
v_exp_f32 v143, v55
v_add_f32 v147, v147, v142
v_exp_f32 v136, v56
s_waitcnt lgkmcnt(0)
v_mfma_f32_32x32x16_bf16 v[16:31], a[192:195], v[160:163], v[64:79]
v_add_f32 v147, v147, v143
v_cvt_pk_bf16_f32 v131, v142, v143
v_exp_f32 v137, v57
v_mfma_f32_32x32x16_bf16 v[16:31], a[196:199], v[164:167], v[16:31]
v_add_f32 v147, v147, v136
v_exp_f32 v138, v58
v_mfma_f32_32x32x16_bf16 v[16:31], a[200:203], v[168:171], v[16:31]
v_add_f32 v147, v147, v137
v_cvt_pk_bf16_f32 v132, v136, v137
v_exp_f32 v139, v59
v_add_f32 v147, v147, v138
v_mfma_f32_32x32x16_bf16 v[16:31], a[204:207], v[172:175], v[16:31]
v_exp_f32 v140, v60
v_add_f32 v147, v147, v139
v_cvt_pk_bf16_f32 v133, v138, v139
v_mfma_f32_32x32x16_bf16 v[16:31], a[208:211], v[176:179], v[16:31]
s_lshl_b32 s34, s95, 3
v_mov_b32 v157, s34
global_load_dword v158, v157, s[98:99] sc1
v_exp_f32 v141, v61
v_add_f32 v147, v147, v140
v_exp_f32 v142, v62
v_mfma_f32_32x32x16_bf16 v[16:31], a[212:215], v[180:183], v[16:31]
v_add_f32 v147, v147, v141
v_cvt_pk_bf16_f32 v134, v140, v141
v_exp_f32 v143, v63
v_mfma_f32_32x32x16_bf16 v[16:31], a[216:219], v[184:187], v[16:31]
v_add_f32 v147, v147, v142
v_add_f32 v147, v147, v143
v_cvt_pk_bf16_f32 v135, v142, v143
v_mfma_f32_32x32x16_bf16 v[16:31], a[220:223], v[188:191], v[16:31]
v_cmp_nge_f32 vcc, s46, v147
s_cbranch_vccnz L_tramp_Bp0c
L_back_Bp0c:
v_add_f32 v146, v146, v147
s_waitcnt vmcnt(0)
v_mfma_f32_32x32x16_bf16 a[128:143], a[224:227], v[128:131], a[128:143]
ds_read_b64_tr_b16 a[224:225], v12 offset:0
ds_read_b64_tr_b16 a[226:227], v12 offset:2048
s_add_u32 m0, s38, 18432
s_add_u32 s36, s33, 0
buffer_load_dwordx4 v3, s[4:7], s36 offen offset:0  lds
v_mfma_f32_32x32x16_bf16 a[144:159], a[232:235], v[128:131], a[144:159]
ds_read_b64_tr_b16 a[232:233], v13 offset:0
ds_read_b64_tr_b16 a[234:235], v13 offset:2048
v_mfma_f32_32x32x16_bf16 a[160:175], a[240:243], v[128:131], a[160:175]
ds_read_b64_tr_b16 a[240:241], v14 offset:0
buffer_load_dwordx4 v4, s[4:7], s36 offen offset:1024  lds
v_exp_f32 v136, v16
v_exp_f32 v137, v17
v_exp_f32 v138, v18
v_mfma_f32_32x32x16_bf16 a[176:191], a[248:251], v[128:131], a[176:191]
ds_read_b64_tr_b16 a[242:243], v14 offset:2048
v_add_f32 v147, v136, v137
v_cvt_pk_bf16_f32 v112, v136, v137
v_exp_f32 v139, v19
v_mfma_f32_32x32x16_bf16 a[128:143], a[228:231], v[132:135], a[128:143]
ds_read_b64_tr_b16 a[248:249], v15 offset:0
buffer_load_dwordx4 v5, s[4:7], s36 offen offset:2048  lds
v_add_f32 v147, v147, v138
v_exp_f32 v140, v20
v_mfma_f32_32x32x16_bf16 a[144:159], a[236:239], v[132:135], a[144:159]
ds_read_b64_tr_b16 a[250:251], v15 offset:2048
v_add_f32 v147, v147, v139
v_cvt_pk_bf16_f32 v113, v138, v139
v_exp_f32 v141, v21
v_mfma_f32_32x32x16_bf16 a[160:175], a[244:247], v[132:135], a[160:175]
ds_read_b64_tr_b16 a[228:229], v12 offset:4096
buffer_load_dwordx4 v6, s[4:7], s36 offen offset:3072  lds
v_add_f32 v147, v147, v140
v_exp_f32 v142, v22
v_add_f32 v147, v147, v141
v_cvt_pk_bf16_f32 v114, v140, v141
v_mfma_f32_32x32x16_bf16 a[176:191], a[252:255], v[132:135], a[176:191]
ds_read_b64_tr_b16 a[230:231], v12 offset:6144
v_exp_f32 v143, v23
v_add_f32 v147, v147, v142
v_exp_f32 v136, v24
v_mfma_f32_32x32x16_bf16 v[32:47], a[192:195], v[192:195], v[80:95]
ds_read_b64_tr_b16 a[236:237], v13 offset:4096
s_add_u32 m0, s38, 22528
s_add_u32 s36, s41, 0
buffer_load_dwordx4 v3, s[4:7], s36 offen offset:0  lds
v_add_f32 v147, v147, v143
v_cvt_pk_bf16_f32 v115, v142, v143
v_exp_f32 v137, v25
v_mfma_f32_32x32x16_bf16 v[32:47], a[196:199], v[196:199], v[32:47]
ds_read_b64_tr_b16 a[238:239], v13 offset:6144
v_add_f32 v147, v147, v136
v_exp_f32 v138, v26
v_mfma_f32_32x32x16_bf16 v[32:47], a[200:203], v[200:203], v[32:47]
ds_read_b64_tr_b16 a[244:245], v14 offset:4096
buffer_load_dwordx4 v4, s[4:7], s36 offen offset:1024  lds
v_add_f32 v147, v147, v137
v_cvt_pk_bf16_f32 v116, v136, v137
v_exp_f32 v139, v27
v_add_f32 v147, v147, v138
v_mfma_f32_32x32x16_bf16 v[32:47], a[204:207], v[204:207], v[32:47]
ds_read_b64_tr_b16 a[246:247], v14 offset:6144
v_exp_f32 v140, v28
v_add_f32 v147, v147, v139
v_cvt_pk_bf16_f32 v117, v138, v139
v_mfma_f32_32x32x16_bf16 v[32:47], a[208:211], v[208:211], v[32:47]
ds_read_b64_tr_b16 a[252:253], v15 offset:4096
buffer_load_dwordx4 v5, s[4:7], s36 offen offset:2048  lds
v_exp_f32 v141, v29
v_add_f32 v147, v147, v140
v_exp_f32 v142, v30
v_mfma_f32_32x32x16_bf16 v[32:47], a[212:215], v[212:215], v[32:47]
ds_read_b64_tr_b16 a[254:255], v15 offset:6144
v_add_f32 v147, v147, v141
v_cvt_pk_bf16_f32 v118, v140, v141
v_exp_f32 v143, v31
v_mfma_f32_32x32x16_bf16 v[32:47], a[216:219], v[216:219], v[32:47]
buffer_load_dwordx4 v6, s[4:7], s36 offen offset:3072  lds
v_add_f32 v147, v147, v142
v_add_f32 v147, v147, v143
v_cvt_pk_bf16_f32 v119, v142, v143
v_mfma_f32_32x32x16_bf16 v[32:47], a[220:223], v[220:223], v[32:47]
v_cmp_nge_f32 vcc, s46, v147
s_cbranch_vccnz L_tramp_Bp1a
L_back_Bp1a:
v_add_f32 v144, v144, v147
s_waitcnt lgkmcnt(4)
v_mfma_f32_32x32x16_bf16 a[0:15], a[224:227], v[112:115], a[0:15]
s_add_u32 m0, s38, 26624
s_add_u32 s36, s33, 36864
buffer_load_dwordx4 v3, s[4:7], s36 offen offset:0  lds
v_mfma_f32_32x32x16_bf16 a[16:31], a[232:235], v[112:115], a[16:31]
s_nop 0
v_mfma_f32_32x32x16_bf16 a[32:47], a[240:243], v[112:115], a[32:47]
buffer_load_dwordx4 v4, s[4:7], s36 offen offset:1024  lds
v_exp_f32 v136, v32
v_exp_f32 v137, v33
v_exp_f32 v138, v34
v_mfma_f32_32x32x16_bf16 a[48:63], a[248:251], v[112:115], a[48:63]
v_add_f32 v147, v136, v137
v_cvt_pk_bf16_f32 v120, v136, v137
v_exp_f32 v139, v35
v_mfma_f32_32x32x16_bf16 a[0:15], a[228:231], v[116:119], a[0:15]
buffer_load_dwordx4 v5, s[4:7], s36 offen offset:2048  lds
v_add_f32 v147, v147, v138
v_exp_f32 v140, v36
v_mfma_f32_32x32x16_bf16 a[16:31], a[236:239], v[116:119], a[16:31]
v_add_f32 v147, v147, v139
v_cvt_pk_bf16_f32 v121, v138, v139
v_exp_f32 v141, v37
s_waitcnt lgkmcnt(0)
v_mfma_f32_32x32x16_bf16 a[32:47], a[244:247], v[116:119], a[32:47]
buffer_load_dwordx4 v6, s[4:7], s36 offen offset:3072  lds
v_add_f32 v147, v147, v140
v_exp_f32 v142, v38
v_add_f32 v147, v147, v141
v_cvt_pk_bf16_f32 v122, v140, v141
v_mfma_f32_32x32x16_bf16 a[48:63], a[252:255], v[116:119], a[48:63]
v_exp_f32 v143, v39
v_add_f32 v147, v147, v142
v_exp_f32 v136, v40
v_mfma_f32_32x32x16_bf16 v[48:63], a[192:195], v[224:227], v[96:111]
s_add_u32 m0, s38, 30720
s_add_u32 s36, s41, 36864
buffer_load_dwordx4 v3, s[4:7], s36 offen offset:0  lds
v_add_f32 v147, v147, v143
v_cvt_pk_bf16_f32 v123, v142, v143
v_exp_f32 v137, v41
v_mfma_f32_32x32x16_bf16 v[48:63], a[196:199], v[228:231], v[48:63]
v_add_f32 v147, v147, v136
v_exp_f32 v138, v42
v_mfma_f32_32x32x16_bf16 v[48:63], a[200:203], v[232:235], v[48:63]
buffer_load_dwordx4 v4, s[4:7], s36 offen offset:1024  lds
v_add_f32 v147, v147, v137
v_cvt_pk_bf16_f32 v124, v136, v137
v_exp_f32 v139, v43
v_add_f32 v147, v147, v138
v_mfma_f32_32x32x16_bf16 v[48:63], a[204:207], v[236:239], v[48:63]
v_exp_f32 v140, v44
v_add_f32 v147, v147, v139
v_cvt_pk_bf16_f32 v125, v138, v139
v_mfma_f32_32x32x16_bf16 v[48:63], a[208:211], v[240:243], v[48:63]
buffer_load_dwordx4 v5, s[4:7], s36 offen offset:2048  lds
v_exp_f32 v141, v45
v_add_f32 v147, v147, v140
v_exp_f32 v142, v46
v_mfma_f32_32x32x16_bf16 v[48:63], a[212:215], v[244:247], v[48:63]
v_add_f32 v147, v147, v141
v_cvt_pk_bf16_f32 v126, v140, v141
v_exp_f32 v143, v47
v_mfma_f32_32x32x16_bf16 v[48:63], a[216:219], v[248:251], v[48:63]
buffer_load_dwordx4 v6, s[4:7], s36 offen offset:3072  lds
v_add_f32 v147, v147, v142
v_add_f32 v147, v147, v143
v_cvt_pk_bf16_f32 v127, v142, v143
v_mfma_f32_32x32x16_bf16 v[48:63], a[220:223], v[252:255], v[48:63]
v_cmp_nge_f32 vcc, s46, v147
s_cbranch_vccnz L_tramp_Bp1b
L_back_Bp1b:
v_add_f32 v145, v145, v147
v_mfma_f32_32x32x16_bf16 a[64:79], a[224:227], v[120:123], a[64:79]
v_mfma_f32_32x32x16_bf16 a[80:95], a[232:235], v[120:123], a[80:95]
s_nop 5
v_mfma_f32_32x32x16_bf16 a[96:111], a[240:243], v[120:123], a[96:111]
v_exp_f32 v136, v48
v_exp_f32 v137, v49
v_exp_f32 v138, v50
v_add_f32 v147, v136, v137
v_cvt_pk_bf16_f32 v128, v136, v137
v_exp_f32 v139, v51
v_add_f32 v147, v147, v138
v_mfma_f32_32x32x16_bf16 a[112:127], a[248:251], v[120:123], a[112:127]
v_exp_f32 v140, v52
v_add_f32 v147, v147, v139
v_cvt_pk_bf16_f32 v129, v138, v139
v_exp_f32 v141, v53
v_add_f32 v147, v147, v140
v_exp_f32 v142, v54
v_add_f32 v147, v147, v141
v_cvt_pk_bf16_f32 v130, v140, v141
v_mfma_f32_32x32x16_bf16 a[64:79], a[228:231], v[124:127], a[64:79]
v_exp_f32 v143, v55
v_add_f32 v147, v147, v142
v_exp_f32 v136, v56
v_add_f32 v147, v147, v143
v_cvt_pk_bf16_f32 v131, v142, v143
v_exp_f32 v137, v57
v_add_f32 v147, v147, v136
v_exp_f32 v138, v58
v_mfma_f32_32x32x16_bf16 a[80:95], a[236:239], v[124:127], a[80:95]
v_add_f32 v147, v147, v137
v_cvt_pk_bf16_f32 v132, v136, v137
v_exp_f32 v139, v59
v_add_f32 v147, v147, v138
v_exp_f32 v140, v60
v_add_f32 v147, v147, v139
v_cvt_pk_bf16_f32 v133, v138, v139
v_exp_f32 v141, v61
v_mfma_f32_32x32x16_bf16 a[96:111], a[244:247], v[124:127], a[96:111]
v_add_f32 v147, v147, v140
v_exp_f32 v142, v62
v_add_f32 v147, v147, v141
v_cvt_pk_bf16_f32 v134, v140, v141
v_exp_f32 v143, v63
v_add_f32 v147, v147, v142
v_add_f32 v147, v147, v143
v_cvt_pk_bf16_f32 v135, v142, v143
v_mfma_f32_32x32x16_bf16 a[112:127], a[252:255], v[124:127], a[112:127]
v_cmp_nge_f32 vcc, s46, v147
s_cbranch_vccnz L_tramp_Bp1c
L_back_Bp1c:
v_add_f32 v146, v146, v147
L_attn_done:
v_mfma_f32_32x32x16_bf16 a[128:143], a[224:227], v[128:131], a[128:143]
v_mov_b32 v148, v144
v_mov_b32 v149, v145
v_mov_b32 v150, v146
v_lshlrev_b32 v1, 4, v7
v_add_u32 v2, s38, v1
v_permlane32_swap_b32 v144, v148
v_permlane32_swap_b32 v145, v149
v_mfma_f32_32x32x16_bf16 a[144:159], a[232:235], v[128:131], a[144:159]
v_permlane32_swap_b32 v146, v150
s_mul_i32 s34, s3, 6144
s_add_u32 s34, s34, 139264
v_add_u32 v14, s34, v1
v_add_f32 v144, v144, v148
v_add_f32 v145, v145, v149
v_mfma_f32_32x32x16_bf16 a[160:175], a[240:243], v[128:131], a[160:175]
v_add_f32 v146, v146, v150
v_rcp_f32 v16, v144
v_rcp_f32 v18, v145
v_rcp_f32 v20, v146
v_bfe_u32 v12, v7, 4, 1
v_and_b32 v13, 1, v7
v_mfma_f32_32x32x16_bf16 a[176:191], a[248:251], v[128:131], a[176:191]
v_lshlrev_b32 v13, 5, v13
v_lshl_add_u32 v13, v12, 4, v13
v_bfe_u32 v12, v7, 1, 1
v_lshl_add_u32 v13, v12, 3, v13
v_lshrrev_b32 v12, 5, v7
v_bfe_u32 v15, v7, 2, 2
v_mfma_f32_32x32x16_bf16 a[128:143], a[228:231], v[132:135], a[128:143]
v_lshl_add_u32 v12, v12, 2, v15
v_lshl_add_u32 v13, v12, 7, v13
v_add_u32 v13, 18432, v13
v_lshrrev_b32 v15, 1, v15
v_lshl_add_u32 v12, v15, 6, v13
v_xor_b32 v15, 1, v15
v_mfma_f32_32x32x16_bf16 a[144:159], a[236:239], v[132:135], a[144:159]
v_lshl_add_u32 v13, v15, 6, v13
v_add_u32 v8, s38, v12
v_add_u32 v9, s38, v13
s_mul_i32 s50, s25, 110592
s_mul_i32 s51, s3, 3072
s_add_u32 s51, s51, s50
v_mfma_f32_32x32x16_bf16 a[160:175], a[244:247], v[132:135], a[160:175]
s_add_u32 s51, s51, 98304
s_mul_i32 s34, s3, 24576
s_add_u32 s50, s50, s34
s_and_b32 s34, s27, 1
s_lshl_b32 s34, s34, 12
s_add_u32 s50, s50, s34
v_mfma_f32_32x32x16_bf16 a[176:191], a[252:255], v[132:135], a[176:191]
s_lshl_b32 s34, s34, 1
s_sub_u32 s39, 4096, s34
s_ashr_i32 s44, s39, 5
v_mov_b32 v17, v16
v_mov_b32 v19, v18
v_mov_b32 v21, v20
v_readfirstlane_b32 s40, v158
s_waitcnt vmcnt(8)
ds_read_b64_tr_b16 a[192:193], v8 offset:0
ds_read_b64_tr_b16 a[194:195], v8 offset:1024
ds_read_b64_tr_b16 a[196:197], v9 offset:0
ds_read_b64_tr_b16 a[198:199], v9 offset:1024
ds_read_b64_tr_b16 a[200:201], v8 offset:4096
ds_read_b64_tr_b16 a[202:203], v8 offset:5120
ds_read_b64_tr_b16 a[204:205], v9 offset:4096
ds_read_b64_tr_b16 a[206:207], v9 offset:5120
v_accvgpr_read_b32 v24, a0
v_accvgpr_read_b32 v25, a1
v_accvgpr_read_b32 v26, a2
v_accvgpr_read_b32 v27, a3
v_accvgpr_read_b32 v28, a4
v_accvgpr_read_b32 v29, a5
v_accvgpr_read_b32 v30, a6
v_accvgpr_read_b32 v31, a7
v_mul_f32 v24, v24, v16
v_mul_f32 v25, v25, v16
v_mul_f32 v26, v26, v16
v_mul_f32 v27, v27, v16
v_mul_f32 v28, v28, v16
v_mul_f32 v29, v29, v16
v_mul_f32 v30, v30, v16
v_mul_f32 v31, v31, v16
v_cvt_pk_bf16_f32 v40, v24, v25
v_cvt_pk_bf16_f32 v41, v26, v27
v_cvt_pk_bf16_f32 v42, v28, v29
v_cvt_pk_bf16_f32 v43, v30, v31
ds_write_b128 v2, v[40:43] offset:0
v_accvgpr_read_b32 v32, a64
v_accvgpr_read_b32 v33, a65
v_accvgpr_read_b32 v34, a66
v_accvgpr_read_b32 v35, a67
v_accvgpr_read_b32 v36, a68
v_accvgpr_read_b32 v37, a69
v_accvgpr_read_b32 v38, a70
v_accvgpr_read_b32 v39, a71
v_mul_f32 v32, v32, v18
v_mul_f32 v33, v33, v18
v_mul_f32 v34, v34, v18
v_mul_f32 v35, v35, v18
v_mul_f32 v36, v36, v18
v_mul_f32 v37, v37, v18
v_mul_f32 v38, v38, v18
v_mul_f32 v39, v39, v18
v_cvt_pk_bf16_f32 v44, v32, v33
v_cvt_pk_bf16_f32 v45, v34, v35
v_cvt_pk_bf16_f32 v46, v36, v37
v_cvt_pk_bf16_f32 v47, v38, v39
ds_write_b128 v2, v[44:47] offset:1024
v_accvgpr_read_b32 v24, a128
v_accvgpr_read_b32 v25, a129
v_accvgpr_read_b32 v26, a130
v_accvgpr_read_b32 v27, a131
v_accvgpr_read_b32 v28, a132
v_accvgpr_read_b32 v29, a133
v_accvgpr_read_b32 v30, a134
v_accvgpr_read_b32 v31, a135
v_mul_f32 v24, v24, v20
v_mul_f32 v25, v25, v20
v_mul_f32 v26, v26, v20
v_mul_f32 v27, v27, v20
v_mul_f32 v28, v28, v20
v_mul_f32 v29, v29, v20
v_mul_f32 v30, v30, v20
v_mul_f32 v31, v31, v20
v_cvt_pk_bf16_f32 v48, v24, v25
v_cvt_pk_bf16_f32 v49, v26, v27
v_cvt_pk_bf16_f32 v50, v28, v29
v_cvt_pk_bf16_f32 v51, v30, v31
ds_write_b128 v2, v[48:51] offset:2048
s_waitcnt vmcnt(8) lgkmcnt(3)
v_mfma_f32_32x32x16_bf16 v[64:79], a[192:195], v[40:43], 0
ds_read_b64_tr_b16 a[208:209], v8 offset:2048
ds_read_b64_tr_b16 a[210:211], v8 offset:3072
v_accvgpr_read_b32 v32, a8
v_accvgpr_read_b32 v33, a9
v_accvgpr_read_b32 v34, a10
v_accvgpr_read_b32 v35, a11
v_accvgpr_read_b32 v36, a12
v_accvgpr_read_b32 v37, a13
v_mfma_f32_32x32x16_bf16 v[96:111], a[192:195], v[44:47], 0
ds_read_b64_tr_b16 a[212:213], v9 offset:2048
v_accvgpr_read_b32 v38, a14
v_accvgpr_read_b32 v39, a15
v_mul_f32 v32, v32, v16
v_mul_f32 v33, v33, v16
v_mul_f32 v34, v34, v16
v_mul_f32 v35, v35, v16
v_mfma_f32_32x32x16_bf16 v[128:143], a[192:195], v[48:51], 0
ds_read_b64_tr_b16 a[214:215], v9 offset:3072
v_mul_f32 v36, v36, v16
v_mul_f32 v37, v37, v16
v_mul_f32 v38, v38, v16
v_mul_f32 v39, v39, v16
v_cvt_pk_bf16_f32 v52, v32, v33
v_cvt_pk_bf16_f32 v53, v34, v35
v_mfma_f32_32x32x16_bf16 v[80:95], a[196:199], v[40:43], 0
ds_read_b64_tr_b16 a[216:217], v8 offset:6144
v_cvt_pk_bf16_f32 v54, v36, v37
v_cvt_pk_bf16_f32 v55, v38, v39
ds_write_b128 v2, v[52:55] offset:3072
v_accvgpr_read_b32 v24, a72
v_accvgpr_read_b32 v25, a73
v_mfma_f32_32x32x16_bf16 v[112:127], a[196:199], v[44:47], 0
ds_read_b64_tr_b16 a[218:219], v8 offset:7168
v_accvgpr_read_b32 v26, a74
v_accvgpr_read_b32 v27, a75
v_accvgpr_read_b32 v28, a76
v_accvgpr_read_b32 v29, a77
v_accvgpr_read_b32 v30, a78
v_accvgpr_read_b32 v31, a79
v_mfma_f32_32x32x16_bf16 v[144:159], a[196:199], v[48:51], 0
ds_read_b64_tr_b16 a[220:221], v9 offset:6144
v_mul_f32 v24, v24, v18
v_mul_f32 v25, v25, v18
v_mul_f32 v26, v26, v18
v_mul_f32 v27, v27, v18
v_mul_f32 v28, v28, v18
v_mul_f32 v29, v29, v18
v_mfma_f32_32x32x16_bf16 v[160:175], a[200:203], v[40:43], 0
ds_read_b64_tr_b16 a[222:223], v9 offset:7168
v_mul_f32 v30, v30, v18
v_mul_f32 v31, v31, v18
v_cvt_pk_bf16_f32 v56, v24, v25
v_cvt_pk_bf16_f32 v57, v26, v27
v_cvt_pk_bf16_f32 v58, v28, v29
v_cvt_pk_bf16_f32 v59, v30, v31
v_mfma_f32_32x32x16_bf16 v[192:207], a[200:203], v[44:47], 0
ds_write_b128 v2, v[56:59] offset:4096
v_accvgpr_read_b32 v32, a136
v_accvgpr_read_b32 v33, a137
v_accvgpr_read_b32 v34, a138
v_accvgpr_read_b32 v35, a139
v_mfma_f32_32x32x16_bf16 v[224:239], a[200:203], v[48:51], 0
v_accvgpr_read_b32 v36, a140
v_accvgpr_read_b32 v37, a141
v_accvgpr_read_b32 v38, a142
v_accvgpr_read_b32 v39, a143
v_mul_f32 v32, v32, v20
v_mul_f32 v33, v33, v20
v_mfma_f32_32x32x16_bf16 v[176:191], a[204:207], v[40:43], 0
v_mul_f32 v34, v34, v20
v_mul_f32 v35, v35, v20
v_mul_f32 v36, v36, v20
v_mul_f32 v37, v37, v20
v_mul_f32 v38, v38, v20
v_mul_f32 v39, v39, v20
v_mfma_f32_32x32x16_bf16 v[208:223], a[204:207], v[44:47], 0
v_cvt_pk_bf16_f32 v60, v32, v33
v_cvt_pk_bf16_f32 v61, v34, v35
v_cvt_pk_bf16_f32 v62, v36, v37
v_cvt_pk_bf16_f32 v63, v38, v39
ds_write_b128 v2, v[60:63] offset:5120
v_mfma_f32_32x32x16_bf16 v[240:255], a[204:207], v[48:51], 0
s_waitcnt vmcnt(0) lgkmcnt(2)
v_mfma_f32_32x32x16_bf16 v[64:79], a[208:211], v[52:55], v[64:79]
ds_read_b64_tr_b16 a[192:193], v8 offset:8192
ds_read_b64_tr_b16 a[194:195], v8 offset:9216
s_add_u32 m0, s38, 18432
s_add_u32 s36, s33, 73728
buffer_load_dwordx4 v3, s[4:7], s36 offen offset:0  lds
v_accvgpr_read_b32 v24, a16
v_accvgpr_read_b32 v25, a17
v_accvgpr_read_b32 v26, a18
v_accvgpr_read_b32 v27, a19
v_accvgpr_read_b32 v28, a20
v_accvgpr_read_b32 v29, a21
v_mfma_f32_32x32x16_bf16 v[96:111], a[208:211], v[56:59], v[96:111]
ds_read_b64_tr_b16 a[196:197], v9 offset:8192
buffer_load_dwordx4 v4, s[4:7], s36 offen offset:1024  lds
v_accvgpr_read_b32 v30, a22
v_accvgpr_read_b32 v31, a23
v_mul_f32 v24, v24, v16
v_mul_f32 v25, v25, v16
v_mul_f32 v26, v26, v16
v_mul_f32 v27, v27, v16
v_mfma_f32_32x32x16_bf16 v[128:143], a[208:211], v[60:63], v[128:143]
ds_read_b64_tr_b16 a[198:199], v9 offset:9216
buffer_load_dwordx4 v5, s[4:7], s36 offen offset:2048  lds
v_mul_f32 v28, v28, v16
v_mul_f32 v29, v29, v16
v_mul_f32 v30, v30, v16
v_mul_f32 v31, v31, v16
v_cvt_pk_bf16_f32 v40, v24, v25
v_cvt_pk_bf16_f32 v41, v26, v27
v_mfma_f32_32x32x16_bf16 v[80:95], a[212:215], v[52:55], v[80:95]
ds_read_b64_tr_b16 a[200:201], v8 offset:12288
buffer_load_dwordx4 v6, s[4:7], s36 offen offset:3072  lds
v_cvt_pk_bf16_f32 v42, v28, v29
v_cvt_pk_bf16_f32 v43, v30, v31
ds_write_b128 v2, v[40:43] offset:6144
v_accvgpr_read_b32 v32, a80
v_accvgpr_read_b32 v33, a81
v_mfma_f32_32x32x16_bf16 v[112:127], a[212:215], v[56:59], v[112:127]
ds_read_b64_tr_b16 a[202:203], v8 offset:13312
s_add_u32 m0, s38, 22528
s_add_u32 s36, s41, 73728
buffer_load_dwordx4 v3, s[4:7], s36 offen offset:0  lds
v_accvgpr_read_b32 v34, a82
v_accvgpr_read_b32 v35, a83
v_accvgpr_read_b32 v36, a84
v_accvgpr_read_b32 v37, a85
v_accvgpr_read_b32 v38, a86
v_accvgpr_read_b32 v39, a87
v_mfma_f32_32x32x16_bf16 v[144:159], a[212:215], v[60:63], v[144:159]
ds_read_b64_tr_b16 a[204:205], v9 offset:12288
buffer_load_dwordx4 v4, s[4:7], s36 offen offset:1024  lds
v_mul_f32 v32, v32, v18
v_mul_f32 v33, v33, v18
v_mul_f32 v34, v34, v18
v_mul_f32 v35, v35, v18
v_mul_f32 v36, v36, v18
v_mul_f32 v37, v37, v18
v_mfma_f32_32x32x16_bf16 v[160:175], a[216:219], v[52:55], v[160:175]
ds_read_b64_tr_b16 a[206:207], v9 offset:13312
buffer_load_dwordx4 v5, s[4:7], s36 offen offset:2048  lds
v_mul_f32 v38, v38, v18
v_mul_f32 v39, v39, v18
v_cvt_pk_bf16_f32 v44, v32, v33
v_cvt_pk_bf16_f32 v45, v34, v35
v_cvt_pk_bf16_f32 v46, v36, v37
v_cvt_pk_bf16_f32 v47, v38, v39
v_mfma_f32_32x32x16_bf16 v[192:207], a[216:219], v[56:59], v[192:207]
buffer_load_dwordx4 v6, s[4:7], s36 offen offset:3072  lds
ds_write_b128 v2, v[44:47] offset:7168
v_accvgpr_read_b32 v24, a144
v_accvgpr_read_b32 v25, a145
v_accvgpr_read_b32 v26, a146
v_accvgpr_read_b32 v27, a147
v_mfma_f32_32x32x16_bf16 v[224:239], a[216:219], v[60:63], v[224:239]
v_accvgpr_read_b32 v28, a148
v_accvgpr_read_b32 v29, a149
v_accvgpr_read_b32 v30, a150
v_accvgpr_read_b32 v31, a151
v_mul_f32 v24, v24, v20
v_mul_f32 v25, v25, v20
v_mfma_f32_32x32x16_bf16 v[176:191], a[220:223], v[52:55], v[176:191]
v_mul_f32 v26, v26, v20
v_mul_f32 v27, v27, v20
v_mul_f32 v28, v28, v20
v_mul_f32 v29, v29, v20
v_mul_f32 v30, v30, v20
v_mul_f32 v31, v31, v20
v_mfma_f32_32x32x16_bf16 v[208:223], a[220:223], v[56:59], v[208:223]
v_cvt_pk_bf16_f32 v48, v24, v25
v_cvt_pk_bf16_f32 v49, v26, v27
v_cvt_pk_bf16_f32 v50, v28, v29
v_cvt_pk_bf16_f32 v51, v30, v31
ds_write_b128 v2, v[48:51] offset:8192
v_mfma_f32_32x32x16_bf16 v[240:255], a[220:223], v[60:63], v[240:255]
s_waitcnt vmcnt(8) lgkmcnt(2)
v_mfma_f32_32x32x16_bf16 v[64:79], a[192:195], v[40:43], v[64:79]
ds_read_b64_tr_b16 a[208:209], v8 offset:10240
ds_read_b64_tr_b16 a[210:211], v8 offset:11264
v_accvgpr_read_b32 v32, a24
v_accvgpr_read_b32 v33, a25
v_accvgpr_read_b32 v34, a26
v_accvgpr_read_b32 v35, a27
v_accvgpr_read_b32 v36, a28
v_accvgpr_read_b32 v37, a29
v_mfma_f32_32x32x16_bf16 v[96:111], a[192:195], v[44:47], v[96:111]
ds_read_b64_tr_b16 a[212:213], v9 offset:10240
v_accvgpr_read_b32 v38, a30
v_accvgpr_read_b32 v39, a31
v_mul_f32 v32, v32, v16
v_mul_f32 v33, v33, v16
v_mul_f32 v34, v34, v16
v_mul_f32 v35, v35, v16
v_mfma_f32_32x32x16_bf16 v[128:143], a[192:195], v[48:51], v[128:143]
ds_read_b64_tr_b16 a[214:215], v9 offset:11264
v_mul_f32 v36, v36, v16
v_mul_f32 v37, v37, v16
v_mul_f32 v38, v38, v16
v_mul_f32 v39, v39, v16
v_cvt_pk_bf16_f32 v52, v32, v33
v_cvt_pk_bf16_f32 v53, v34, v35
v_mfma_f32_32x32x16_bf16 v[80:95], a[196:199], v[40:43], v[80:95]
ds_read_b64_tr_b16 a[216:217], v8 offset:14336
v_cvt_pk_bf16_f32 v54, v36, v37
v_cvt_pk_bf16_f32 v55, v38, v39
ds_write_b128 v2, v[52:55] offset:9216
v_accvgpr_read_b32 v24, a88
v_accvgpr_read_b32 v25, a89
v_mfma_f32_32x32x16_bf16 v[112:127], a[196:199], v[44:47], v[112:127]
ds_read_b64_tr_b16 a[218:219], v8 offset:15360
v_accvgpr_read_b32 v26, a90
v_accvgpr_read_b32 v27, a91
v_accvgpr_read_b32 v28, a92
v_accvgpr_read_b32 v29, a93
v_accvgpr_read_b32 v30, a94
v_accvgpr_read_b32 v31, a95
v_mfma_f32_32x32x16_bf16 v[144:159], a[196:199], v[48:51], v[144:159]
ds_read_b64_tr_b16 a[220:221], v9 offset:14336
v_mul_f32 v24, v24, v18
v_mul_f32 v25, v25, v18
v_mul_f32 v26, v26, v18
v_mul_f32 v27, v27, v18
v_mul_f32 v28, v28, v18
v_mul_f32 v29, v29, v18
v_mfma_f32_32x32x16_bf16 v[160:175], a[200:203], v[40:43], v[160:175]
ds_read_b64_tr_b16 a[222:223], v9 offset:15360
v_mul_f32 v30, v30, v18
v_mul_f32 v31, v31, v18
v_cvt_pk_bf16_f32 v56, v24, v25
v_cvt_pk_bf16_f32 v57, v26, v27
v_cvt_pk_bf16_f32 v58, v28, v29
v_cvt_pk_bf16_f32 v59, v30, v31
v_mfma_f32_32x32x16_bf16 v[192:207], a[200:203], v[44:47], v[192:207]
ds_write_b128 v2, v[56:59] offset:10240
v_accvgpr_read_b32 v32, a152
v_accvgpr_read_b32 v33, a153
v_accvgpr_read_b32 v34, a154
v_accvgpr_read_b32 v35, a155
v_mfma_f32_32x32x16_bf16 v[224:239], a[200:203], v[48:51], v[224:239]
v_accvgpr_read_b32 v36, a156
v_accvgpr_read_b32 v37, a157
v_accvgpr_read_b32 v38, a158
v_accvgpr_read_b32 v39, a159
v_mul_f32 v32, v32, v20
v_mul_f32 v33, v33, v20
v_mfma_f32_32x32x16_bf16 v[176:191], a[204:207], v[40:43], v[176:191]
v_mul_f32 v34, v34, v20
v_mul_f32 v35, v35, v20
v_mul_f32 v36, v36, v20
v_mul_f32 v37, v37, v20
v_mul_f32 v38, v38, v20
v_mul_f32 v39, v39, v20
v_mfma_f32_32x32x16_bf16 v[208:223], a[204:207], v[44:47], v[208:223]
v_cvt_pk_bf16_f32 v60, v32, v33
v_cvt_pk_bf16_f32 v61, v34, v35
v_cvt_pk_bf16_f32 v62, v36, v37
v_cvt_pk_bf16_f32 v63, v38, v39
ds_write_b128 v2, v[60:63] offset:11264
v_mfma_f32_32x32x16_bf16 v[240:255], a[204:207], v[48:51], v[240:255]
s_waitcnt vmcnt(0) lgkmcnt(2)
v_mfma_f32_32x32x16_bf16 v[64:79], a[208:211], v[52:55], v[64:79]
ds_read_b64_tr_b16 a[192:193], v8 offset:0
ds_read_b64_tr_b16 a[194:195], v8 offset:1024
s_add_u32 m0, s38, 26624
s_add_u32 s36, s33, 110592
buffer_load_dwordx4 v3, s[4:7], s36 offen offset:0  lds
v_accvgpr_read_b32 v24, a32
v_accvgpr_read_b32 v25, a33
v_accvgpr_read_b32 v26, a34
v_accvgpr_read_b32 v27, a35
v_accvgpr_read_b32 v28, a36
v_accvgpr_read_b32 v29, a37
v_mfma_f32_32x32x16_bf16 v[96:111], a[208:211], v[56:59], v[96:111]
ds_read_b64_tr_b16 a[196:197], v9 offset:0
buffer_load_dwordx4 v4, s[4:7], s36 offen offset:1024  lds
v_accvgpr_read_b32 v30, a38
v_accvgpr_read_b32 v31, a39
v_mul_f32 v24, v24, v16
v_mul_f32 v25, v25, v16
v_mul_f32 v26, v26, v16
v_mul_f32 v27, v27, v16
v_mfma_f32_32x32x16_bf16 v[128:143], a[208:211], v[60:63], v[128:143]
ds_read_b64_tr_b16 a[198:199], v9 offset:1024
buffer_load_dwordx4 v5, s[4:7], s36 offen offset:2048  lds
v_mul_f32 v28, v28, v16
v_mul_f32 v29, v29, v16
v_mul_f32 v30, v30, v16
v_mul_f32 v31, v31, v16
v_cvt_pk_bf16_f32 v40, v24, v25
v_cvt_pk_bf16_f32 v41, v26, v27
v_mfma_f32_32x32x16_bf16 v[80:95], a[212:215], v[52:55], v[80:95]
ds_read_b64_tr_b16 a[200:201], v8 offset:4096
buffer_load_dwordx4 v6, s[4:7], s36 offen offset:3072  lds
v_cvt_pk_bf16_f32 v42, v28, v29
v_cvt_pk_bf16_f32 v43, v30, v31
ds_write_b128 v2, v[40:43] offset:12288
v_accvgpr_read_b32 v32, a96
v_accvgpr_read_b32 v33, a97
v_mfma_f32_32x32x16_bf16 v[112:127], a[212:215], v[56:59], v[112:127]
ds_read_b64_tr_b16 a[202:203], v8 offset:5120
s_add_u32 m0, s38, 30720
s_add_u32 s36, s41, 110592
buffer_load_dwordx4 v3, s[4:7], s36 offen offset:0  lds
v_accvgpr_read_b32 v34, a98
v_accvgpr_read_b32 v35, a99
v_accvgpr_read_b32 v36, a100
v_accvgpr_read_b32 v37, a101
v_accvgpr_read_b32 v38, a102
v_accvgpr_read_b32 v39, a103
v_mfma_f32_32x32x16_bf16 v[144:159], a[212:215], v[60:63], v[144:159]
ds_read_b64_tr_b16 a[204:205], v9 offset:4096
buffer_load_dwordx4 v4, s[4:7], s36 offen offset:1024  lds
v_mul_f32 v32, v32, v18
v_mul_f32 v33, v33, v18
v_mul_f32 v34, v34, v18
v_mul_f32 v35, v35, v18
v_mul_f32 v36, v36, v18
v_mul_f32 v37, v37, v18
v_mfma_f32_32x32x16_bf16 v[160:175], a[216:219], v[52:55], v[160:175]
ds_read_b64_tr_b16 a[206:207], v9 offset:5120
buffer_load_dwordx4 v5, s[4:7], s36 offen offset:2048  lds
v_mul_f32 v38, v38, v18
v_mul_f32 v39, v39, v18
v_cvt_pk_bf16_f32 v44, v32, v33
v_cvt_pk_bf16_f32 v45, v34, v35
v_cvt_pk_bf16_f32 v46, v36, v37
v_cvt_pk_bf16_f32 v47, v38, v39
v_mfma_f32_32x32x16_bf16 v[192:207], a[216:219], v[56:59], v[192:207]
buffer_load_dwordx4 v6, s[4:7], s36 offen offset:3072  lds
ds_write_b128 v2, v[44:47] offset:13312
v_accvgpr_read_b32 v24, a160
v_accvgpr_read_b32 v25, a161
v_accvgpr_read_b32 v26, a162
v_accvgpr_read_b32 v27, a163
v_mfma_f32_32x32x16_bf16 v[224:239], a[216:219], v[60:63], v[224:239]
v_accvgpr_read_b32 v28, a164
v_accvgpr_read_b32 v29, a165
v_accvgpr_read_b32 v30, a166
v_accvgpr_read_b32 v31, a167
v_mul_f32 v24, v24, v20
v_mul_f32 v25, v25, v20
v_mfma_f32_32x32x16_bf16 v[176:191], a[220:223], v[52:55], v[176:191]
v_mul_f32 v26, v26, v20
v_mul_f32 v27, v27, v20
v_mul_f32 v28, v28, v20
v_mul_f32 v29, v29, v20
v_mul_f32 v30, v30, v20
v_mul_f32 v31, v31, v20
v_mfma_f32_32x32x16_bf16 v[208:223], a[220:223], v[56:59], v[208:223]
v_cvt_pk_bf16_f32 v48, v24, v25
v_cvt_pk_bf16_f32 v49, v26, v27
v_cvt_pk_bf16_f32 v50, v28, v29
v_cvt_pk_bf16_f32 v51, v30, v31
ds_write_b128 v2, v[48:51] offset:14336
v_mfma_f32_32x32x16_bf16 v[240:255], a[220:223], v[60:63], v[240:255]
s_waitcnt vmcnt(8) lgkmcnt(2)
v_mfma_f32_32x32x16_bf16 v[64:79], a[192:195], v[40:43], v[64:79]
ds_read_b64_tr_b16 a[208:209], v8 offset:2048
ds_read_b64_tr_b16 a[210:211], v8 offset:3072
v_accvgpr_read_b32 v32, a40
v_accvgpr_read_b32 v33, a41
v_accvgpr_read_b32 v34, a42
v_accvgpr_read_b32 v35, a43
v_accvgpr_read_b32 v36, a44
v_accvgpr_read_b32 v37, a45
v_mfma_f32_32x32x16_bf16 v[96:111], a[192:195], v[44:47], v[96:111]
ds_read_b64_tr_b16 a[212:213], v9 offset:2048
v_accvgpr_read_b32 v38, a46
v_accvgpr_read_b32 v39, a47
v_mul_f32 v32, v32, v16
v_mul_f32 v33, v33, v16
v_mul_f32 v34, v34, v16
v_mul_f32 v35, v35, v16
v_mfma_f32_32x32x16_bf16 v[128:143], a[192:195], v[48:51], v[128:143]
ds_read_b64_tr_b16 a[214:215], v9 offset:3072
v_mul_f32 v36, v36, v16
v_mul_f32 v37, v37, v16
v_mul_f32 v38, v38, v16
v_mul_f32 v39, v39, v16
v_cvt_pk_bf16_f32 v52, v32, v33
v_cvt_pk_bf16_f32 v53, v34, v35
v_mfma_f32_32x32x16_bf16 v[80:95], a[196:199], v[40:43], v[80:95]
ds_read_b64_tr_b16 a[216:217], v8 offset:6144
v_cvt_pk_bf16_f32 v54, v36, v37
v_cvt_pk_bf16_f32 v55, v38, v39
ds_write_b128 v2, v[52:55] offset:15360
v_accvgpr_read_b32 v24, a104
v_accvgpr_read_b32 v25, a105
v_mfma_f32_32x32x16_bf16 v[112:127], a[196:199], v[44:47], v[112:127]
ds_read_b64_tr_b16 a[218:219], v8 offset:7168
v_accvgpr_read_b32 v26, a106
v_accvgpr_read_b32 v27, a107
v_accvgpr_read_b32 v28, a108
v_accvgpr_read_b32 v29, a109
v_accvgpr_read_b32 v30, a110
v_accvgpr_read_b32 v31, a111
v_mfma_f32_32x32x16_bf16 v[144:159], a[196:199], v[48:51], v[144:159]
ds_read_b64_tr_b16 a[220:221], v9 offset:6144
v_mul_f32 v24, v24, v18
v_mul_f32 v25, v25, v18
v_mul_f32 v26, v26, v18
v_mul_f32 v27, v27, v18
v_mul_f32 v28, v28, v18
v_mul_f32 v29, v29, v18
v_mfma_f32_32x32x16_bf16 v[160:175], a[200:203], v[40:43], v[160:175]
ds_read_b64_tr_b16 a[222:223], v9 offset:7168
v_mul_f32 v30, v30, v18
v_mul_f32 v31, v31, v18
v_cvt_pk_bf16_f32 v56, v24, v25
v_cvt_pk_bf16_f32 v57, v26, v27
v_cvt_pk_bf16_f32 v58, v28, v29
v_cvt_pk_bf16_f32 v59, v30, v31
v_mfma_f32_32x32x16_bf16 v[192:207], a[200:203], v[44:47], v[192:207]
ds_write_b128 v2, v[56:59] offset:16384
v_accvgpr_read_b32 v32, a168
v_accvgpr_read_b32 v33, a169
v_accvgpr_read_b32 v34, a170
v_accvgpr_read_b32 v35, a171
v_mfma_f32_32x32x16_bf16 v[224:239], a[200:203], v[48:51], v[224:239]
v_accvgpr_read_b32 v36, a172
v_accvgpr_read_b32 v37, a173
v_accvgpr_read_b32 v38, a174
v_accvgpr_read_b32 v39, a175
v_mul_f32 v32, v32, v20
v_mul_f32 v33, v33, v20
v_mfma_f32_32x32x16_bf16 v[176:191], a[204:207], v[40:43], v[176:191]
v_mul_f32 v34, v34, v20
v_mul_f32 v35, v35, v20
v_mul_f32 v36, v36, v20
v_mul_f32 v37, v37, v20
v_mul_f32 v38, v38, v20
v_mul_f32 v39, v39, v20
v_mfma_f32_32x32x16_bf16 v[208:223], a[204:207], v[44:47], v[208:223]
v_cvt_pk_bf16_f32 v60, v32, v33
v_cvt_pk_bf16_f32 v61, v34, v35
v_cvt_pk_bf16_f32 v62, v36, v37
v_cvt_pk_bf16_f32 v63, v38, v39
ds_write_b128 v2, v[60:63] offset:17408
v_mfma_f32_32x32x16_bf16 v[240:255], a[204:207], v[48:51], v[240:255]
s_waitcnt vmcnt(0) lgkmcnt(2)
v_mfma_f32_32x32x16_bf16 v[64:79], a[208:211], v[52:55], v[64:79]
ds_read_b64_tr_b16 a[192:193], v8 offset:8192
ds_read_b64_tr_b16 a[194:195], v8 offset:9216
s_add_u32 m0, s38, 18432
s_nop 0
buffer_load_dwordx4 v3, s[4:7], s64 offen offset:0  lds
v_accvgpr_read_b32 v24, a48
v_accvgpr_read_b32 v25, a49
v_accvgpr_read_b32 v26, a50
v_accvgpr_read_b32 v27, a51
v_accvgpr_read_b32 v28, a52
v_accvgpr_read_b32 v29, a53
v_mfma_f32_32x32x16_bf16 v[96:111], a[208:211], v[56:59], v[96:111]
ds_read_b64_tr_b16 a[196:197], v9 offset:8192
buffer_load_dwordx4 v4, s[4:7], s64 offen offset:1024  lds
v_accvgpr_read_b32 v30, a54
v_accvgpr_read_b32 v31, a55
v_mul_f32 v24, v24, v16
v_mul_f32 v25, v25, v16
v_mul_f32 v26, v26, v16
v_mul_f32 v27, v27, v16
v_mfma_f32_32x32x16_bf16 v[128:143], a[208:211], v[60:63], v[128:143]
ds_read_b64_tr_b16 a[198:199], v9 offset:9216
buffer_load_dwordx4 v5, s[4:7], s64 offen offset:2048  lds
v_mul_f32 v28, v28, v16
v_mul_f32 v29, v29, v16
v_mul_f32 v30, v30, v16
v_mul_f32 v31, v31, v16
v_cvt_pk_bf16_f32 v40, v24, v25
v_cvt_pk_bf16_f32 v41, v26, v27
v_mfma_f32_32x32x16_bf16 v[80:95], a[212:215], v[52:55], v[80:95]
ds_read_b64_tr_b16 a[200:201], v8 offset:12288
buffer_load_dwordx4 v6, s[4:7], s64 offen offset:3072  lds
v_cvt_pk_bf16_f32 v42, v28, v29
v_cvt_pk_bf16_f32 v43, v30, v31
ds_write_b128 v14, v[40:43] offset:0
v_accvgpr_read_b32 v32, a112
v_accvgpr_read_b32 v33, a113
v_mfma_f32_32x32x16_bf16 v[112:127], a[212:215], v[56:59], v[112:127]
ds_read_b64_tr_b16 a[202:203], v8 offset:13312
s_add_u32 m0, s38, 22528
s_nop 0
buffer_load_dwordx4 v3, s[4:7], s65 offen offset:0  lds
v_accvgpr_read_b32 v34, a114
v_accvgpr_read_b32 v35, a115
v_accvgpr_read_b32 v36, a116
v_accvgpr_read_b32 v37, a117
v_accvgpr_read_b32 v38, a118
v_accvgpr_read_b32 v39, a119
v_mfma_f32_32x32x16_bf16 v[144:159], a[212:215], v[60:63], v[144:159]
ds_read_b64_tr_b16 a[204:205], v9 offset:12288
buffer_load_dwordx4 v4, s[4:7], s65 offen offset:1024  lds
v_mul_f32 v32, v32, v18
v_mul_f32 v33, v33, v18
v_mul_f32 v34, v34, v18
v_mul_f32 v35, v35, v18
v_mul_f32 v36, v36, v18
v_mul_f32 v37, v37, v18
v_mfma_f32_32x32x16_bf16 v[160:175], a[216:219], v[52:55], v[160:175]
ds_read_b64_tr_b16 a[206:207], v9 offset:13312
buffer_load_dwordx4 v5, s[4:7], s65 offen offset:2048  lds
v_mul_f32 v38, v38, v18
v_mul_f32 v39, v39, v18
v_cvt_pk_bf16_f32 v44, v32, v33
v_cvt_pk_bf16_f32 v45, v34, v35
v_cvt_pk_bf16_f32 v46, v36, v37
v_cvt_pk_bf16_f32 v47, v38, v39
v_mfma_f32_32x32x16_bf16 v[192:207], a[216:219], v[56:59], v[192:207]
buffer_load_dwordx4 v6, s[4:7], s65 offen offset:3072  lds
ds_write_b128 v14, v[44:47] offset:1024
v_accvgpr_read_b32 v24, a176
v_accvgpr_read_b32 v25, a177
v_accvgpr_read_b32 v26, a178
v_accvgpr_read_b32 v27, a179
v_mfma_f32_32x32x16_bf16 v[224:239], a[216:219], v[60:63], v[224:239]
v_accvgpr_read_b32 v28, a180
v_accvgpr_read_b32 v29, a181
v_accvgpr_read_b32 v30, a182
v_accvgpr_read_b32 v31, a183
v_mul_f32 v24, v24, v20
v_mul_f32 v25, v25, v20
v_mfma_f32_32x32x16_bf16 v[176:191], a[220:223], v[52:55], v[176:191]
v_mul_f32 v26, v26, v20
v_mul_f32 v27, v27, v20
v_mul_f32 v28, v28, v20
v_mul_f32 v29, v29, v20
v_mul_f32 v30, v30, v20
v_mul_f32 v31, v31, v20
v_mfma_f32_32x32x16_bf16 v[208:223], a[220:223], v[56:59], v[208:223]
v_cvt_pk_bf16_f32 v48, v24, v25
v_cvt_pk_bf16_f32 v49, v26, v27
v_cvt_pk_bf16_f32 v50, v28, v29
v_cvt_pk_bf16_f32 v51, v30, v31
ds_write_b128 v14, v[48:51] offset:2048
v_mfma_f32_32x32x16_bf16 v[240:255], a[220:223], v[60:63], v[240:255]
s_waitcnt vmcnt(8) lgkmcnt(2)
v_mfma_f32_32x32x16_bf16 v[64:79], a[192:195], v[40:43], v[64:79]
ds_read_b64_tr_b16 a[208:209], v8 offset:10240
v_accvgpr_read_b32 v32, a56
v_accvgpr_read_b32 v33, a57
v_accvgpr_read_b32 v34, a58
v_accvgpr_read_b32 v35, a59
v_accvgpr_read_b32 v36, a60
v_accvgpr_read_b32 v37, a61
v_mfma_f32_32x32x16_bf16 v[96:111], a[192:195], v[44:47], v[96:111]
ds_read_b64_tr_b16 a[210:211], v8 offset:11264
v_accvgpr_read_b32 v38, a62
v_accvgpr_read_b32 v39, a63
v_mul_f32 v32, v32, v16
v_mul_f32 v33, v33, v16
v_mul_f32 v34, v34, v16
v_mul_f32 v35, v35, v16
v_mfma_f32_32x32x16_bf16 v[128:143], a[192:195], v[48:51], v[128:143]
ds_read_b64_tr_b16 a[212:213], v9 offset:10240
v_mul_f32 v36, v36, v16
v_mul_f32 v37, v37, v16
v_mul_f32 v38, v38, v16
v_mul_f32 v39, v39, v16
v_cvt_pk_bf16_f32 v52, v32, v33
v_cvt_pk_bf16_f32 v53, v34, v35
v_mfma_f32_32x32x16_bf16 v[80:95], a[196:199], v[40:43], v[80:95]
v_cvt_pk_bf16_f32 v54, v36, v37
v_cvt_pk_bf16_f32 v55, v38, v39
ds_write_b128 v14, v[52:55] offset:3072
v_accvgpr_read_b32 v24, a120
v_accvgpr_read_b32 v25, a121
v_mfma_f32_32x32x16_bf16 v[112:127], a[196:199], v[44:47], v[112:127]
ds_read_b64_tr_b16 a[214:215], v9 offset:11264
v_accvgpr_read_b32 v26, a122
v_accvgpr_read_b32 v27, a123
v_accvgpr_read_b32 v28, a124
v_accvgpr_read_b32 v29, a125
v_accvgpr_read_b32 v30, a126
v_accvgpr_read_b32 v31, a127
v_mfma_f32_32x32x16_bf16 v[144:159], a[196:199], v[48:51], v[144:159]
ds_read_b64_tr_b16 a[216:217], v8 offset:14336
v_mul_f32 v24, v24, v18
v_mul_f32 v25, v25, v18
v_mul_f32 v26, v26, v18
v_mul_f32 v27, v27, v18
v_mul_f32 v28, v28, v18
v_mul_f32 v29, v29, v18
v_mfma_f32_32x32x16_bf16 v[160:175], a[200:203], v[40:43], v[160:175]
ds_read_b64_tr_b16 a[218:219], v8 offset:15360
v_mul_f32 v30, v30, v18
v_mul_f32 v31, v31, v18
v_cvt_pk_bf16_f32 v56, v24, v25
v_cvt_pk_bf16_f32 v57, v26, v27
v_cvt_pk_bf16_f32 v58, v28, v29
v_cvt_pk_bf16_f32 v59, v30, v31
v_mfma_f32_32x32x16_bf16 v[192:207], a[200:203], v[44:47], v[192:207]
ds_write_b128 v14, v[56:59] offset:4096
v_accvgpr_read_b32 v32, a184
v_accvgpr_read_b32 v33, a185
v_accvgpr_read_b32 v34, a186
v_accvgpr_read_b32 v35, a187
v_mfma_f32_32x32x16_bf16 v[224:239], a[200:203], v[48:51], v[224:239]
ds_read_b64_tr_b16 a[220:221], v9 offset:14336
v_accvgpr_read_b32 v36, a188
v_accvgpr_read_b32 v37, a189
v_accvgpr_read_b32 v38, a190
v_accvgpr_read_b32 v39, a191
v_mul_f32 v32, v32, v20
v_mul_f32 v33, v33, v20
v_mfma_f32_32x32x16_bf16 v[176:191], a[204:207], v[40:43], v[176:191]
ds_read_b64_tr_b16 a[222:223], v9 offset:15360
v_mul_f32 v34, v34, v20
v_mul_f32 v35, v35, v20
v_mul_f32 v36, v36, v20
v_mul_f32 v37, v37, v20
v_mul_f32 v38, v38, v20
v_mul_f32 v39, v39, v20
v_mfma_f32_32x32x16_bf16 v[208:223], a[204:207], v[44:47], v[208:223]
v_cvt_pk_bf16_f32 v60, v32, v33
v_cvt_pk_bf16_f32 v61, v34, v35
v_cvt_pk_bf16_f32 v62, v36, v37
v_cvt_pk_bf16_f32 v63, v38, v39
ds_write_b128 v14, v[60:63] offset:5120
v_mfma_f32_32x32x16_bf16 v[240:255], a[204:207], v[48:51], v[240:255]
s_waitcnt vmcnt(4) lgkmcnt(0)
s_barrier
v_mfma_f32_32x32x16_bf16 v[64:79], a[208:211], v[52:55], v[64:79]
v_add_u32 v10, s76, v1
ds_read_b64_tr_b16 a[192:193], v8 offset:0
ds_read_b64_tr_b16 a[194:195], v8 offset:1024
s_add_u32 m0, s38, 26624
s_nop 0
buffer_load_dwordx4 v3, s[4:7], s66 offen offset:0  lds
v_mfma_f32_32x32x16_bf16 v[96:111], a[208:211], v[56:59], v[96:111]
ds_read_b64_tr_b16 a[196:197], v9 offset:0
buffer_load_dwordx4 v4, s[4:7], s66 offen offset:1024  lds
v_mfma_f32_32x32x16_bf16 v[128:143], a[208:211], v[60:63], v[128:143]
ds_read_b64_tr_b16 a[198:199], v9 offset:1024
buffer_load_dwordx4 v5, s[4:7], s66 offen offset:2048  lds
v_mfma_f32_32x32x16_bf16 v[80:95], a[212:215], v[52:55], v[80:95]
ds_read_b128 a[96:99], v10 offset:0
ds_read_b128 a[100:103], v10 offset:1024
buffer_load_dwordx4 v6, s[4:7], s66 offen offset:3072  lds
v_mfma_f32_32x32x16_bf16 v[112:127], a[212:215], v[56:59], v[112:127]
ds_read_b128 a[104:107], v10 offset:2048
s_add_u32 m0, s38, 30720
s_nop 0
buffer_load_dwordx4 v3, s[4:7], s67 offen offset:0  lds
v_mfma_f32_32x32x16_bf16 v[144:159], a[212:215], v[60:63], v[144:159]
ds_read_b64_tr_b16 a[200:201], v8 offset:2048
buffer_load_dwordx4 v4, s[4:7], s67 offen offset:1024  lds
v_mfma_f32_32x32x16_bf16 v[160:175], a[216:219], v[52:55], v[160:175]
ds_read_b64_tr_b16 a[202:203], v8 offset:3072
buffer_load_dwordx4 v5, s[4:7], s67 offen offset:2048  lds
v_mfma_f32_32x32x16_bf16 v[192:207], a[216:219], v[56:59], v[192:207]
ds_read_b64_tr_b16 a[204:205], v9 offset:2048
ds_read_b64_tr_b16 a[206:207], v9 offset:3072
buffer_load_dwordx4 v6, s[4:7], s67 offen offset:3072  lds
v_mfma_f32_32x32x16_bf16 v[224:239], a[216:219], v[60:63], v[224:239]
ds_read_b128 a[108:111], v10 offset:3072
v_mfma_f32_32x32x16_bf16 v[176:191], a[220:223], v[52:55], v[176:191]
ds_read_b128 a[112:115], v10 offset:4096
v_mfma_f32_32x32x16_bf16 v[208:223], a[220:223], v[56:59], v[208:223]
ds_read_b128 a[116:119], v10 offset:5120
v_mfma_f32_32x32x16_bf16 v[240:255], a[220:223], v[60:63], v[240:255]
s_waitcnt vmcnt(8) lgkmcnt(0)
v_mfma_f32_32x32x16_bf16 v[160:175], a[192:195], a[96:99], v[160:175]
v_add_u32 v11, s77, v1
ds_read_b64_tr_b16 a[208:209], v8 offset:4096
ds_read_b64_tr_b16 a[210:211], v8 offset:5120
v_mfma_f32_32x32x16_bf16 v[192:207], a[192:195], a[100:103], v[192:207]
ds_read_b64_tr_b16 a[212:213], v9 offset:4096
s_add_u32 m0, s38, 18432
s_nop 0
buffer_load_dwordx4 v3, s[4:7], s68 offen offset:0  lds
v_mfma_f32_32x32x16_bf16 v[224:239], a[192:195], a[104:107], v[224:239]
ds_read_b64_tr_b16 a[214:215], v9 offset:5120
v_mfma_f32_32x32x16_bf16 v[176:191], a[196:199], a[96:99], v[176:191]
ds_read_b128 a[120:123], v11 offset:0
ds_read_b128 a[124:127], v11 offset:1024
v_mfma_f32_32x32x16_bf16 v[208:223], a[196:199], a[100:103], v[208:223]
ds_read_b128 a[128:131], v11 offset:2048
buffer_load_dwordx4 v4, s[4:7], s68 offen offset:1024  lds
v_mfma_f32_32x32x16_bf16 v[240:255], a[196:199], a[104:107], v[240:255]
ds_read_b64_tr_b16 a[216:217], v8 offset:6144
v_mfma_f32_32x32x16_bf16 v[160:175], a[200:203], a[108:111], v[160:175]
ds_read_b64_tr_b16 a[218:219], v8 offset:7168
v_mfma_f32_32x32x16_bf16 v[192:207], a[200:203], a[112:115], v[192:207]
ds_read_b64_tr_b16 a[220:221], v9 offset:6144
ds_read_b64_tr_b16 a[222:223], v9 offset:7168
buffer_load_dwordx4 v5, s[4:7], s68 offen offset:2048  lds
v_mfma_f32_32x32x16_bf16 v[224:239], a[200:203], a[116:119], v[224:239]
ds_read_b128 a[132:135], v11 offset:3072
v_mfma_f32_32x32x16_bf16 v[176:191], a[204:207], a[108:111], v[176:191]
ds_read_b128 a[136:139], v11 offset:4096
v_mfma_f32_32x32x16_bf16 v[208:223], a[204:207], a[112:115], v[208:223]
ds_read_b128 a[140:143], v11 offset:5120
buffer_load_dwordx4 v6, s[4:7], s68 offen offset:3072  lds
v_mfma_f32_32x32x16_bf16 v[240:255], a[204:207], a[116:119], v[240:255]
s_waitcnt vmcnt(8) lgkmcnt(0)
v_mfma_f32_32x32x16_bf16 v[160:175], a[208:211], a[120:123], v[160:175]
v_add_u32 v10, s78, v1
ds_read_b64_tr_b16 a[192:193], v8 offset:8192
ds_read_b64_tr_b16 a[194:195], v8 offset:9216
v_cvt_pk_bf16_f32 v16, v64, v65
v_mfma_f32_32x32x16_bf16 v[192:207], a[208:211], a[124:127], v[192:207]
ds_read_b64_tr_b16 a[196:197], v9 offset:8192
s_add_u32 m0, s38, 22528
s_nop 0
buffer_load_dwordx4 v3, s[4:7], s69 offen offset:0  lds
v_cvt_pk_bf16_f32 v17, v66, v67
v_mfma_f32_32x32x16_bf16 v[224:239], a[208:211], a[128:131], v[224:239]
ds_read_b64_tr_b16 a[198:199], v9 offset:9216
v_cvt_pk_bf16_f32 v18, v68, v69
v_mfma_f32_32x32x16_bf16 v[176:191], a[212:215], a[120:123], v[176:191]
ds_read_b128 a[96:99], v10 offset:0
ds_read_b128 a[100:103], v10 offset:1024
v_cvt_pk_bf16_f32 v19, v70, v71
v_mfma_f32_32x32x16_bf16 v[208:223], a[212:215], a[124:127], v[208:223]
ds_read_b128 a[104:107], v10 offset:2048
buffer_load_dwordx4 v4, s[4:7], s69 offen offset:1024  lds
v_cvt_pk_bf16_f32 v20, v72, v73
v_mfma_f32_32x32x16_bf16 v[240:255], a[212:215], a[128:131], v[240:255]
ds_read_b64_tr_b16 a[200:201], v8 offset:10240
v_cvt_pk_bf16_f32 v21, v74, v75
v_mfma_f32_32x32x16_bf16 v[160:175], a[216:219], a[132:135], v[160:175]
ds_read_b64_tr_b16 a[202:203], v8 offset:11264
v_cvt_pk_bf16_f32 v22, v76, v77
v_mfma_f32_32x32x16_bf16 v[192:207], a[216:219], a[136:139], v[192:207]
ds_read_b64_tr_b16 a[204:205], v9 offset:10240
ds_read_b64_tr_b16 a[206:207], v9 offset:11264
buffer_load_dwordx4 v5, s[4:7], s69 offen offset:2048  lds
v_cvt_pk_bf16_f32 v23, v78, v79
v_mfma_f32_32x32x16_bf16 v[224:239], a[216:219], a[140:143], v[224:239]
ds_read_b128 a[108:111], v10 offset:3072
v_cvt_pk_bf16_f32 v24, v80, v81
v_mfma_f32_32x32x16_bf16 v[176:191], a[220:223], a[132:135], v[176:191]
ds_read_b128 a[112:115], v10 offset:4096
v_cvt_pk_bf16_f32 v25, v82, v83
v_mfma_f32_32x32x16_bf16 v[208:223], a[220:223], a[136:139], v[208:223]
ds_read_b128 a[116:119], v10 offset:5120
buffer_load_dwordx4 v6, s[4:7], s69 offen offset:3072  lds
v_cvt_pk_bf16_f32 v26, v84, v85
v_mfma_f32_32x32x16_bf16 v[240:255], a[220:223], a[140:143], v[240:255]
v_cvt_pk_bf16_f32 v27, v86, v87
s_waitcnt vmcnt(8) lgkmcnt(0)
v_mfma_f32_32x32x16_bf16 v[160:175], a[192:195], a[96:99], v[160:175]
v_add_u32 v11, s79, v1
ds_read_b64_tr_b16 a[208:209], v8 offset:12288
ds_read_b64_tr_b16 a[210:211], v8 offset:13312
v_cvt_pk_bf16_f32 v28, v88, v89
v_mfma_f32_32x32x16_bf16 v[192:207], a[192:195], a[100:103], v[192:207]
ds_read_b64_tr_b16 a[212:213], v9 offset:12288
s_add_u32 m0, s38, 26624
s_nop 0
buffer_load_dwordx4 v3, s[4:7], s70 offen offset:0  lds
v_cvt_pk_bf16_f32 v29, v90, v91
v_mfma_f32_32x32x16_bf16 v[224:239], a[192:195], a[104:107], v[224:239]
ds_read_b64_tr_b16 a[214:215], v9 offset:13312
v_cvt_pk_bf16_f32 v30, v92, v93
v_mfma_f32_32x32x16_bf16 v[176:191], a[196:199], a[96:99], v[176:191]
ds_read_b128 a[120:123], v11 offset:0
ds_read_b128 a[124:127], v11 offset:1024
v_cvt_pk_bf16_f32 v31, v94, v95
v_mfma_f32_32x32x16_bf16 v[208:223], a[196:199], a[100:103], v[208:223]
ds_read_b128 a[128:131], v11 offset:2048
buffer_load_dwordx4 v4, s[4:7], s70 offen offset:1024  lds
v_cvt_pk_bf16_f32 v32, v96, v97
v_mfma_f32_32x32x16_bf16 v[240:255], a[196:199], a[104:107], v[240:255]
ds_read_b64_tr_b16 a[216:217], v8 offset:14336
v_cvt_pk_bf16_f32 v33, v98, v99
v_mfma_f32_32x32x16_bf16 v[160:175], a[200:203], a[108:111], v[160:175]
ds_read_b64_tr_b16 a[218:219], v8 offset:15360
v_cvt_pk_bf16_f32 v34, v100, v101
v_mfma_f32_32x32x16_bf16 v[192:207], a[200:203], a[112:115], v[192:207]
ds_read_b64_tr_b16 a[220:221], v9 offset:14336
ds_read_b64_tr_b16 a[222:223], v9 offset:15360
buffer_load_dwordx4 v5, s[4:7], s70 offen offset:2048  lds
v_cvt_pk_bf16_f32 v35, v102, v103
v_mfma_f32_32x32x16_bf16 v[224:239], a[200:203], a[116:119], v[224:239]
ds_read_b128 a[132:135], v11 offset:3072
v_cvt_pk_bf16_f32 v36, v104, v105
v_mfma_f32_32x32x16_bf16 v[176:191], a[204:207], a[108:111], v[176:191]
ds_read_b128 a[136:139], v11 offset:4096
v_cvt_pk_bf16_f32 v37, v106, v107
v_mfma_f32_32x32x16_bf16 v[208:223], a[204:207], a[112:115], v[208:223]
ds_read_b128 a[140:143], v11 offset:5120
buffer_load_dwordx4 v6, s[4:7], s70 offen offset:3072  lds
v_cvt_pk_bf16_f32 v38, v108, v109
v_mfma_f32_32x32x16_bf16 v[240:255], a[204:207], a[116:119], v[240:255]
v_cvt_pk_bf16_f32 v39, v110, v111
s_waitcnt vmcnt(8) lgkmcnt(0)
v_mfma_f32_32x32x16_bf16 v[160:175], a[208:211], a[120:123], v[160:175]
v_add_u32 v10, s80, v1
ds_read_b64_tr_b16 a[192:193], v8 offset:0
ds_read_b64_tr_b16 a[194:195], v8 offset:1024
v_cvt_pk_bf16_f32 v40, v112, v113
v_mfma_f32_32x32x16_bf16 v[192:207], a[208:211], a[124:127], v[192:207]
ds_read_b64_tr_b16 a[196:197], v9 offset:0
s_add_u32 m0, s38, 30720
s_nop 0
buffer_load_dwordx4 v3, s[4:7], s71 offen offset:0  lds
v_cvt_pk_bf16_f32 v41, v114, v115
v_mfma_f32_32x32x16_bf16 v[224:239], a[208:211], a[128:131], v[224:239]
ds_read_b64_tr_b16 a[198:199], v9 offset:1024
v_cvt_pk_bf16_f32 v42, v116, v117
v_mfma_f32_32x32x16_bf16 v[176:191], a[212:215], a[120:123], v[176:191]
ds_read_b128 a[96:99], v10 offset:0
ds_read_b128 a[100:103], v10 offset:1024
v_cvt_pk_bf16_f32 v43, v118, v119
v_mfma_f32_32x32x16_bf16 v[208:223], a[212:215], a[124:127], v[208:223]
ds_read_b128 a[104:107], v10 offset:2048
buffer_load_dwordx4 v4, s[4:7], s71 offen offset:1024  lds
v_cvt_pk_bf16_f32 v44, v120, v121
v_mfma_f32_32x32x16_bf16 v[240:255], a[212:215], a[128:131], v[240:255]
ds_read_b64_tr_b16 a[200:201], v8 offset:2048
v_cvt_pk_bf16_f32 v45, v122, v123
v_mfma_f32_32x32x16_bf16 v[160:175], a[216:219], a[132:135], v[160:175]
ds_read_b64_tr_b16 a[202:203], v8 offset:3072
v_cvt_pk_bf16_f32 v46, v124, v125
v_mfma_f32_32x32x16_bf16 v[192:207], a[216:219], a[136:139], v[192:207]
ds_read_b64_tr_b16 a[204:205], v9 offset:2048
ds_read_b64_tr_b16 a[206:207], v9 offset:3072
buffer_load_dwordx4 v5, s[4:7], s71 offen offset:2048  lds
v_cvt_pk_bf16_f32 v47, v126, v127
v_mfma_f32_32x32x16_bf16 v[224:239], a[216:219], a[140:143], v[224:239]
ds_read_b128 a[108:111], v10 offset:3072
v_cvt_pk_bf16_f32 v48, v128, v129
v_mfma_f32_32x32x16_bf16 v[176:191], a[220:223], a[132:135], v[176:191]
ds_read_b128 a[112:115], v10 offset:4096
v_cvt_pk_bf16_f32 v49, v130, v131
v_mfma_f32_32x32x16_bf16 v[208:223], a[220:223], a[136:139], v[208:223]
ds_read_b128 a[116:119], v10 offset:5120
buffer_load_dwordx4 v6, s[4:7], s71 offen offset:3072  lds
v_cvt_pk_bf16_f32 v50, v132, v133
v_mfma_f32_32x32x16_bf16 v[240:255], a[220:223], a[140:143], v[240:255]
v_cvt_pk_bf16_f32 v51, v134, v135
s_waitcnt vmcnt(8) lgkmcnt(0)
v_mfma_f32_32x32x16_bf16 v[160:175], a[192:195], a[96:99], v[160:175]
v_add_u32 v11, s81, v1
ds_read_b64_tr_b16 a[208:209], v8 offset:4096
ds_read_b64_tr_b16 a[210:211], v8 offset:5120
v_cvt_pk_bf16_f32 v52, v136, v137
v_mfma_f32_32x32x16_bf16 v[192:207], a[192:195], a[100:103], v[192:207]
ds_read_b64_tr_b16 a[212:213], v9 offset:4096
s_add_u32 m0, s38, 18432
s_nop 0
buffer_load_dwordx4 v3, s[4:7], s72 offen offset:0  lds
v_cvt_pk_bf16_f32 v53, v138, v139
v_mfma_f32_32x32x16_bf16 v[224:239], a[192:195], a[104:107], v[224:239]
ds_read_b64_tr_b16 a[214:215], v9 offset:5120
v_cvt_pk_bf16_f32 v54, v140, v141
v_mfma_f32_32x32x16_bf16 v[176:191], a[196:199], a[96:99], v[176:191]
ds_read_b128 a[120:123], v11 offset:0
ds_read_b128 a[124:127], v11 offset:1024
v_cvt_pk_bf16_f32 v55, v142, v143
v_mfma_f32_32x32x16_bf16 v[208:223], a[196:199], a[100:103], v[208:223]
ds_read_b128 a[128:131], v11 offset:2048
buffer_load_dwordx4 v4, s[4:7], s72 offen offset:1024  lds
v_cvt_pk_bf16_f32 v56, v144, v145
v_mfma_f32_32x32x16_bf16 v[240:255], a[196:199], a[104:107], v[240:255]
ds_read_b64_tr_b16 a[216:217], v8 offset:6144
v_cvt_pk_bf16_f32 v57, v146, v147
v_mfma_f32_32x32x16_bf16 v[160:175], a[200:203], a[108:111], v[160:175]
ds_read_b64_tr_b16 a[218:219], v8 offset:7168
v_cvt_pk_bf16_f32 v58, v148, v149
v_mfma_f32_32x32x16_bf16 v[192:207], a[200:203], a[112:115], v[192:207]
ds_read_b64_tr_b16 a[220:221], v9 offset:6144
ds_read_b64_tr_b16 a[222:223], v9 offset:7168
buffer_load_dwordx4 v5, s[4:7], s72 offen offset:2048  lds
v_cvt_pk_bf16_f32 v59, v150, v151
v_mfma_f32_32x32x16_bf16 v[224:239], a[200:203], a[116:119], v[224:239]
ds_read_b128 a[132:135], v11 offset:3072
v_cvt_pk_bf16_f32 v60, v152, v153
v_mfma_f32_32x32x16_bf16 v[176:191], a[204:207], a[108:111], v[176:191]
ds_read_b128 a[136:139], v11 offset:4096
v_cvt_pk_bf16_f32 v61, v154, v155
v_mfma_f32_32x32x16_bf16 v[208:223], a[204:207], a[112:115], v[208:223]
ds_read_b128 a[140:143], v11 offset:5120
buffer_load_dwordx4 v6, s[4:7], s72 offen offset:3072  lds
v_cvt_pk_bf16_f32 v62, v156, v157
v_mfma_f32_32x32x16_bf16 v[240:255], a[204:207], a[116:119], v[240:255]
v_cvt_pk_bf16_f32 v63, v158, v159
s_waitcnt vmcnt(8) lgkmcnt(0)
v_mfma_f32_32x32x16_bf16 v[160:175], a[208:211], a[120:123], v[160:175]
v_add_u32 v10, s82, v1
ds_read_b64_tr_b16 a[192:193], v8 offset:8192
ds_read_b64_tr_b16 a[194:195], v8 offset:9216
s_cmp_lg_u32 s24, 0
s_cbranch_scc1 L_nobpf
s_load_dwordx2 s[12:13], s[0:1], 72
s_lshl_b32 s34, s27, 2
s_add_u32 s34, s34, s3
s_mul_i32 s34, s34, 9216
s_mul_i32 s35, s25, 589824
s_add_u32 s34, s34, s35
v_lshlrev_b32 v12, 6, v7
v_add_u32 v12, s34, v12
v_add_u32 v13, 4096, v12
s_waitcnt lgkmcnt(0)
global_load_dword v15, v12, s[12:13]
global_load_dword v15, v13, s[12:13]
global_load_dword v15, v13, s[12:13] offset:1024
L_nobpf:
v_mfma_f32_32x32x16_bf16 v[192:207], a[208:211], a[124:127], v[192:207]
ds_read_b64_tr_b16 a[196:197], v9 offset:8192
s_add_u32 m0, s38, 22528
s_nop 0
buffer_load_dwordx4 v3, s[4:7], s73 offen offset:0  lds
v_mfma_f32_32x32x16_bf16 v[224:239], a[208:211], a[128:131], v[224:239]
ds_read_b64_tr_b16 a[198:199], v9 offset:9216
v_mfma_f32_32x32x16_bf16 v[176:191], a[212:215], a[120:123], v[176:191]
ds_read_b128 a[96:99], v10 offset:0
ds_read_b128 a[100:103], v10 offset:1024
v_mfma_f32_32x32x16_bf16 v[208:223], a[212:215], a[124:127], v[208:223]
ds_read_b128 a[104:107], v10 offset:2048
buffer_load_dwordx4 v4, s[4:7], s73 offen offset:1024  lds
v_mfma_f32_32x32x16_bf16 v[240:255], a[212:215], a[128:131], v[240:255]
ds_read_b64_tr_b16 a[200:201], v8 offset:10240
v_mfma_f32_32x32x16_bf16 v[160:175], a[216:219], a[132:135], v[160:175]
ds_read_b64_tr_b16 a[202:203], v8 offset:11264
v_mfma_f32_32x32x16_bf16 v[192:207], a[216:219], a[136:139], v[192:207]
ds_read_b64_tr_b16 a[204:205], v9 offset:10240
ds_read_b64_tr_b16 a[206:207], v9 offset:11264
buffer_load_dwordx4 v5, s[4:7], s73 offen offset:2048  lds
v_mfma_f32_32x32x16_bf16 v[224:239], a[216:219], a[140:143], v[224:239]
ds_read_b128 a[108:111], v10 offset:3072
v_mfma_f32_32x32x16_bf16 v[176:191], a[220:223], a[132:135], v[176:191]
ds_read_b128 a[112:115], v10 offset:4096
v_mfma_f32_32x32x16_bf16 v[208:223], a[220:223], a[136:139], v[208:223]
ds_read_b128 a[116:119], v10 offset:5120
buffer_load_dwordx4 v6, s[4:7], s73 offen offset:3072  lds
v_mfma_f32_32x32x16_bf16 v[240:255], a[220:223], a[140:143], v[240:255]
s_waitcnt vmcnt(8) lgkmcnt(0)
v_mfma_f32_32x32x16_bf16 v[160:175], a[192:195], a[96:99], v[160:175]
v_add_u32 v11, s83, v1
ds_read_b64_tr_b16 a[208:209], v8 offset:12288
ds_read_b64_tr_b16 a[210:211], v8 offset:13312
v_mfma_f32_32x32x16_bf16 v[192:207], a[192:195], a[100:103], v[192:207]
ds_read_b64_tr_b16 a[212:213], v9 offset:12288
s_add_u32 m0, s38, 26624
s_nop 0
buffer_load_dwordx4 v3, s[4:7], s74 offen offset:0  lds
v_mfma_f32_32x32x16_bf16 v[224:239], a[192:195], a[104:107], v[224:239]
ds_read_b64_tr_b16 a[214:215], v9 offset:13312
v_mfma_f32_32x32x16_bf16 v[176:191], a[196:199], a[96:99], v[176:191]
ds_read_b128 a[120:123], v11 offset:0
ds_read_b128 a[124:127], v11 offset:1024
v_mfma_f32_32x32x16_bf16 v[208:223], a[196:199], a[100:103], v[208:223]
ds_read_b128 a[128:131], v11 offset:2048
buffer_load_dwordx4 v4, s[4:7], s74 offen offset:1024  lds
v_mfma_f32_32x32x16_bf16 v[240:255], a[196:199], a[104:107], v[240:255]
ds_read_b64_tr_b16 a[216:217], v8 offset:14336
v_mfma_f32_32x32x16_bf16 v[160:175], a[200:203], a[108:111], v[160:175]
ds_read_b64_tr_b16 a[218:219], v8 offset:15360
v_mfma_f32_32x32x16_bf16 v[192:207], a[200:203], a[112:115], v[192:207]
ds_read_b64_tr_b16 a[220:221], v9 offset:14336
ds_read_b64_tr_b16 a[222:223], v9 offset:15360
buffer_load_dwordx4 v5, s[4:7], s74 offen offset:2048  lds
v_mfma_f32_32x32x16_bf16 v[224:239], a[200:203], a[116:119], v[224:239]
ds_read_b128 a[132:135], v11 offset:3072
v_mfma_f32_32x32x16_bf16 v[176:191], a[204:207], a[108:111], v[176:191]
ds_read_b128 a[136:139], v11 offset:4096
v_mfma_f32_32x32x16_bf16 v[208:223], a[204:207], a[112:115], v[208:223]
ds_read_b128 a[140:143], v11 offset:5120
buffer_load_dwordx4 v6, s[4:7], s74 offen offset:3072  lds
v_mfma_f32_32x32x16_bf16 v[240:255], a[204:207], a[116:119], v[240:255]
s_waitcnt vmcnt(8) lgkmcnt(0)
v_mfma_f32_32x32x16_bf16 v[160:175], a[208:211], a[120:123], v[160:175]
v_add_u32 v10, s8, v1
ds_read_b64_tr_b16 a[192:193], v8 offset:0
ds_read_b64_tr_b16 a[194:195], v8 offset:1024
v_mfma_f32_32x32x16_bf16 v[192:207], a[208:211], a[124:127], v[192:207]
ds_read_b64_tr_b16 a[196:197], v9 offset:0
s_add_u32 m0, s38, 30720
s_nop 0
buffer_load_dwordx4 v3, s[4:7], s75 offen offset:0  lds
v_mfma_f32_32x32x16_bf16 v[224:239], a[208:211], a[128:131], v[224:239]
ds_read_b64_tr_b16 a[198:199], v9 offset:1024
v_mfma_f32_32x32x16_bf16 v[176:191], a[212:215], a[120:123], v[176:191]
ds_read_b128 a[96:99], v10 offset:0
ds_read_b128 a[100:103], v10 offset:1024
v_mfma_f32_32x32x16_bf16 v[208:223], a[212:215], a[124:127], v[208:223]
ds_read_b128 a[104:107], v10 offset:2048
buffer_load_dwordx4 v4, s[4:7], s75 offen offset:1024  lds
v_mfma_f32_32x32x16_bf16 v[240:255], a[212:215], a[128:131], v[240:255]
ds_read_b64_tr_b16 a[200:201], v8 offset:2048
v_mfma_f32_32x32x16_bf16 v[160:175], a[216:219], a[132:135], v[160:175]
ds_read_b64_tr_b16 a[202:203], v8 offset:3072
v_mfma_f32_32x32x16_bf16 v[192:207], a[216:219], a[136:139], v[192:207]
ds_read_b64_tr_b16 a[204:205], v9 offset:2048
ds_read_b64_tr_b16 a[206:207], v9 offset:3072
buffer_load_dwordx4 v5, s[4:7], s75 offen offset:2048  lds
v_mfma_f32_32x32x16_bf16 v[224:239], a[216:219], a[140:143], v[224:239]
ds_read_b128 a[108:111], v10 offset:3072
v_mfma_f32_32x32x16_bf16 v[176:191], a[220:223], a[132:135], v[176:191]
ds_read_b128 a[112:115], v10 offset:4096
v_mfma_f32_32x32x16_bf16 v[208:223], a[220:223], a[136:139], v[208:223]
ds_read_b128 a[116:119], v10 offset:5120
buffer_load_dwordx4 v6, s[4:7], s75 offen offset:3072  lds
v_mfma_f32_32x32x16_bf16 v[240:255], a[220:223], a[140:143], v[240:255]
s_waitcnt vmcnt(8) lgkmcnt(0)
v_mfma_f32_32x32x16_bf16 v[160:175], a[192:195], a[96:99], v[160:175]
v_add_u32 v11, s9, v1
ds_read_b64_tr_b16 a[208:209], v8 offset:4096
ds_read_b64_tr_b16 a[210:211], v8 offset:5120
v_mfma_f32_32x32x16_bf16 v[192:207], a[192:195], a[100:103], v[192:207]
ds_read_b64_tr_b16 a[212:213], v9 offset:4096
v_add_u32 v3, s44, v3
v_add_u32 v4, s44, v4
v_add_u32 v5, s44, v5
v_add_u32 v6, s44, v6
s_add_u32 m0, s38, 18432
s_add_u32 s36, s41, 0
buffer_load_dwordx4 v3, s[4:7], s36 offen offset:0  lds
v_mfma_f32_32x32x16_bf16 v[224:239], a[192:195], a[104:107], v[224:239]
ds_read_b64_tr_b16 a[214:215], v9 offset:5120
v_mfma_f32_32x32x16_bf16 v[176:191], a[196:199], a[96:99], v[176:191]
ds_read_b128 a[120:123], v11 offset:0
ds_read_b128 a[124:127], v11 offset:1024
v_mfma_f32_32x32x16_bf16 v[208:223], a[196:199], a[100:103], v[208:223]
ds_read_b128 a[128:131], v11 offset:2048
buffer_load_dwordx4 v4, s[4:7], s36 offen offset:1024  lds
v_mfma_f32_32x32x16_bf16 v[240:255], a[196:199], a[104:107], v[240:255]
ds_read_b64_tr_b16 a[216:217], v8 offset:6144
v_mfma_f32_32x32x16_bf16 v[160:175], a[200:203], a[108:111], v[160:175]
ds_read_b64_tr_b16 a[218:219], v8 offset:7168
v_mfma_f32_32x32x16_bf16 v[192:207], a[200:203], a[112:115], v[192:207]
ds_read_b64_tr_b16 a[220:221], v9 offset:6144
ds_read_b64_tr_b16 a[222:223], v9 offset:7168
buffer_load_dwordx4 v5, s[4:7], s36 offen offset:2048  lds
v_mfma_f32_32x32x16_bf16 v[224:239], a[200:203], a[116:119], v[224:239]
ds_read_b128 a[132:135], v11 offset:3072
v_mfma_f32_32x32x16_bf16 v[176:191], a[204:207], a[108:111], v[176:191]
ds_read_b128 a[136:139], v11 offset:4096
v_mfma_f32_32x32x16_bf16 v[208:223], a[204:207], a[112:115], v[208:223]
ds_read_b128 a[140:143], v11 offset:5120
buffer_load_dwordx4 v6, s[4:7], s36 offen offset:3072  lds
v_mfma_f32_32x32x16_bf16 v[240:255], a[204:207], a[116:119], v[240:255]
s_waitcnt vmcnt(8) lgkmcnt(0)
v_mfma_f32_32x32x16_bf16 v[160:175], a[208:211], a[120:123], v[160:175]
v_add_u32 v10, s10, v1
ds_read_b64_tr_b16 a[192:193], v8 offset:8192
ds_read_b64_tr_b16 a[194:195], v8 offset:9216
v_mfma_f32_32x32x16_bf16 v[192:207], a[208:211], a[124:127], v[192:207]
ds_read_b64_tr_b16 a[196:197], v9 offset:8192
s_add_u32 m0, s38, 22528
s_add_u32 s36, s41, 36864
buffer_load_dwordx4 v3, s[4:7], s36 offen offset:0  lds
v_mfma_f32_32x32x16_bf16 v[224:239], a[208:211], a[128:131], v[224:239]
ds_read_b64_tr_b16 a[198:199], v9 offset:9216
v_mfma_f32_32x32x16_bf16 v[176:191], a[212:215], a[120:123], v[176:191]
ds_read_b128 a[96:99], v10 offset:0
ds_read_b128 a[100:103], v10 offset:1024
v_mfma_f32_32x32x16_bf16 v[208:223], a[212:215], a[124:127], v[208:223]
ds_read_b128 a[104:107], v10 offset:2048
buffer_load_dwordx4 v4, s[4:7], s36 offen offset:1024  lds
v_mfma_f32_32x32x16_bf16 v[240:255], a[212:215], a[128:131], v[240:255]
ds_read_b64_tr_b16 a[200:201], v8 offset:10240
v_mfma_f32_32x32x16_bf16 v[160:175], a[216:219], a[132:135], v[160:175]
ds_read_b64_tr_b16 a[202:203], v8 offset:11264
v_mfma_f32_32x32x16_bf16 v[192:207], a[216:219], a[136:139], v[192:207]
ds_read_b64_tr_b16 a[204:205], v9 offset:10240
ds_read_b64_tr_b16 a[206:207], v9 offset:11264
buffer_load_dwordx4 v5, s[4:7], s36 offen offset:2048  lds
v_mfma_f32_32x32x16_bf16 v[224:239], a[216:219], a[140:143], v[224:239]
ds_read_b128 a[108:111], v10 offset:3072
v_mfma_f32_32x32x16_bf16 v[176:191], a[220:223], a[132:135], v[176:191]
ds_read_b128 a[112:115], v10 offset:4096
v_mfma_f32_32x32x16_bf16 v[208:223], a[220:223], a[136:139], v[208:223]
ds_read_b128 a[116:119], v10 offset:5120
buffer_load_dwordx4 v6, s[4:7], s36 offen offset:3072  lds
v_mfma_f32_32x32x16_bf16 v[240:255], a[220:223], a[140:143], v[240:255]
s_waitcnt vmcnt(8) lgkmcnt(0)
v_mfma_f32_32x32x16_bf16 v[160:175], a[192:195], a[96:99], v[160:175]
v_add_u32 v11, s11, v1
ds_read_b64_tr_b16 a[208:209], v8 offset:12288
ds_read_b64_tr_b16 a[210:211], v8 offset:13312
v_mfma_f32_32x32x16_bf16 v[192:207], a[192:195], a[100:103], v[192:207]
ds_read_b64_tr_b16 a[212:213], v9 offset:12288
s_add_u32 m0, s38, 26624
s_add_u32 s36, s41, 73728
buffer_load_dwordx4 v3, s[4:7], s36 offen offset:0  lds
v_mfma_f32_32x32x16_bf16 v[224:239], a[192:195], a[104:107], v[224:239]
ds_read_b64_tr_b16 a[214:215], v9 offset:13312
v_mfma_f32_32x32x16_bf16 v[176:191], a[196:199], a[96:99], v[176:191]
ds_read_b128 a[120:123], v11 offset:0
ds_read_b128 a[124:127], v11 offset:1024
v_mfma_f32_32x32x16_bf16 v[208:223], a[196:199], a[100:103], v[208:223]
ds_read_b128 a[128:131], v11 offset:2048
buffer_load_dwordx4 v4, s[4:7], s36 offen offset:1024  lds
v_mfma_f32_32x32x16_bf16 v[240:255], a[196:199], a[104:107], v[240:255]
ds_read_b64_tr_b16 a[216:217], v8 offset:14336
v_mfma_f32_32x32x16_bf16 v[160:175], a[200:203], a[108:111], v[160:175]
ds_read_b64_tr_b16 a[218:219], v8 offset:15360
v_mfma_f32_32x32x16_bf16 v[192:207], a[200:203], a[112:115], v[192:207]
ds_read_b64_tr_b16 a[220:221], v9 offset:14336
ds_read_b64_tr_b16 a[222:223], v9 offset:15360
buffer_load_dwordx4 v5, s[4:7], s36 offen offset:2048  lds
v_mfma_f32_32x32x16_bf16 v[224:239], a[200:203], a[116:119], v[224:239]
ds_read_b128 a[132:135], v11 offset:3072
v_mfma_f32_32x32x16_bf16 v[176:191], a[204:207], a[108:111], v[176:191]
ds_read_b128 a[136:139], v11 offset:4096
v_mfma_f32_32x32x16_bf16 v[208:223], a[204:207], a[112:115], v[208:223]
ds_read_b128 a[140:143], v11 offset:5120
buffer_load_dwordx4 v6, s[4:7], s36 offen offset:3072  lds
v_mfma_f32_32x32x16_bf16 v[240:255], a[204:207], a[116:119], v[240:255]
s_waitcnt vmcnt(8) lgkmcnt(0)
v_mfma_f32_32x32x16_bf16 v[160:175], a[208:211], a[120:123], v[160:175]
ds_read_b64_tr_b16 a[192:193], v8 offset:0
ds_read_b64_tr_b16 a[194:195], v8 offset:1024
v_mfma_f32_32x32x16_bf16 v[192:207], a[208:211], a[124:127], v[192:207]
ds_read_b64_tr_b16 a[196:197], v9 offset:0
s_add_u32 m0, s38, 30720
s_add_u32 s36, s41, 110592
buffer_load_dwordx4 v3, s[4:7], s36 offen offset:0  lds
v_mfma_f32_32x32x16_bf16 v[224:239], a[208:211], a[128:131], v[224:239]
ds_read_b64_tr_b16 a[198:199], v9 offset:1024
v_mfma_f32_32x32x16_bf16 v[176:191], a[212:215], a[120:123], v[176:191]
ds_read_b128 a[96:99], v2 offset:0
ds_read_b128 a[100:103], v2 offset:1024
v_mfma_f32_32x32x16_bf16 v[208:223], a[212:215], a[124:127], v[208:223]
ds_read_b128 a[104:107], v2 offset:2048
buffer_load_dwordx4 v4, s[4:7], s36 offen offset:1024  lds
v_mfma_f32_32x32x16_bf16 v[240:255], a[212:215], a[128:131], v[240:255]
ds_read_b64_tr_b16 a[200:201], v8 offset:2048
v_mfma_f32_32x32x16_bf16 v[160:175], a[216:219], a[132:135], v[160:175]
ds_read_b64_tr_b16 a[202:203], v8 offset:3072
v_mfma_f32_32x32x16_bf16 v[192:207], a[216:219], a[136:139], v[192:207]
ds_read_b64_tr_b16 a[204:205], v9 offset:2048
ds_read_b64_tr_b16 a[206:207], v9 offset:3072
buffer_load_dwordx4 v5, s[4:7], s36 offen offset:2048  lds
v_mfma_f32_32x32x16_bf16 v[224:239], a[216:219], a[140:143], v[224:239]
ds_read_b128 a[108:111], v2 offset:3072
v_mfma_f32_32x32x16_bf16 v[176:191], a[220:223], a[132:135], v[176:191]
ds_read_b128 a[112:115], v2 offset:4096
v_mfma_f32_32x32x16_bf16 v[208:223], a[220:223], a[136:139], v[208:223]
ds_read_b128 a[116:119], v2 offset:5120
buffer_load_dwordx4 v6, s[4:7], s36 offen offset:3072  lds
v_mfma_f32_32x32x16_bf16 v[240:255], a[220:223], a[140:143], v[240:255]
s_waitcnt vmcnt(8) lgkmcnt(0)
v_mfma_f32_32x32x16_bf16 v[64:79], a[192:195], a[96:99], 0
ds_read_b64_tr_b16 a[208:209], v8 offset:4096
ds_read_b64_tr_b16 a[210:211], v8 offset:5120
v_mfma_f32_32x32x16_bf16 v[96:111], a[192:195], a[100:103], 0
ds_read_b64_tr_b16 a[212:213], v9 offset:4096
s_add_u32 m0, s38, 18432
s_nop 0
buffer_load_dwordx4 v3, s[4:7], s64 offen offset:0  lds
v_mfma_f32_32x32x16_bf16 v[128:143], a[192:195], a[104:107], 0
ds_read_b64_tr_b16 a[214:215], v9 offset:5120
v_mfma_f32_32x32x16_bf16 v[80:95], a[196:199], a[96:99], 0
ds_read_b128 a[120:123], v2 offset:6144
ds_read_b128 a[124:127], v2 offset:7168
v_mfma_f32_32x32x16_bf16 v[112:127], a[196:199], a[100:103], 0
ds_read_b128 a[128:131], v2 offset:8192
buffer_load_dwordx4 v4, s[4:7], s64 offen offset:1024  lds
v_mfma_f32_32x32x16_bf16 v[144:159], a[196:199], a[104:107], 0
ds_read_b64_tr_b16 a[216:217], v8 offset:6144
v_mfma_f32_32x32x16_bf16 v[64:79], a[200:203], a[108:111], v[64:79]
ds_read_b64_tr_b16 a[218:219], v8 offset:7168
v_mfma_f32_32x32x16_bf16 v[96:111], a[200:203], a[112:115], v[96:111]
ds_read_b64_tr_b16 a[220:221], v9 offset:6144
ds_read_b64_tr_b16 a[222:223], v9 offset:7168
buffer_load_dwordx4 v5, s[4:7], s64 offen offset:2048  lds
v_mfma_f32_32x32x16_bf16 v[128:143], a[200:203], a[116:119], v[128:143]
ds_read_b128 a[132:135], v2 offset:9216
v_mfma_f32_32x32x16_bf16 v[80:95], a[204:207], a[108:111], v[80:95]
ds_read_b128 a[136:139], v2 offset:10240
v_mfma_f32_32x32x16_bf16 v[112:127], a[204:207], a[112:115], v[112:127]
ds_read_b128 a[140:143], v2 offset:11264
buffer_load_dwordx4 v6, s[4:7], s64 offen offset:3072  lds
v_mfma_f32_32x32x16_bf16 v[144:159], a[204:207], a[116:119], v[144:159]
s_waitcnt vmcnt(8) lgkmcnt(0)
v_mfma_f32_32x32x16_bf16 v[64:79], a[208:211], a[120:123], v[64:79]
ds_read_b64_tr_b16 a[192:193], v8 offset:8192
ds_read_b64_tr_b16 a[194:195], v8 offset:9216
v_cvt_pk_bf16_f32 v160, v160, v161
v_mfma_f32_32x32x16_bf16 v[96:111], a[208:211], a[124:127], v[96:111]
ds_read_b64_tr_b16 a[196:197], v9 offset:8192
s_add_u32 m0, s38, 22528
s_nop 0
buffer_load_dwordx4 v3, s[4:7], s65 offen offset:0  lds
v_cvt_pk_bf16_f32 v161, v162, v163
v_mfma_f32_32x32x16_bf16 v[128:143], a[208:211], a[128:131], v[128:143]
ds_read_b64_tr_b16 a[198:199], v9 offset:9216
v_cvt_pk_bf16_f32 v162, v164, v165
v_mfma_f32_32x32x16_bf16 v[80:95], a[212:215], a[120:123], v[80:95]
ds_read_b128 a[96:99], v2 offset:12288
ds_read_b128 a[100:103], v2 offset:13312
v_cvt_pk_bf16_f32 v163, v166, v167
v_mfma_f32_32x32x16_bf16 v[112:127], a[212:215], a[124:127], v[112:127]
ds_read_b128 a[104:107], v2 offset:14336
buffer_load_dwordx4 v4, s[4:7], s65 offen offset:1024  lds
v_cvt_pk_bf16_f32 v164, v168, v169
v_mfma_f32_32x32x16_bf16 v[144:159], a[212:215], a[128:131], v[144:159]
ds_read_b64_tr_b16 a[200:201], v8 offset:10240
v_cvt_pk_bf16_f32 v165, v170, v171
v_mfma_f32_32x32x16_bf16 v[64:79], a[216:219], a[132:135], v[64:79]
ds_read_b64_tr_b16 a[202:203], v8 offset:11264
v_cvt_pk_bf16_f32 v166, v172, v173
v_mfma_f32_32x32x16_bf16 v[96:111], a[216:219], a[136:139], v[96:111]
ds_read_b64_tr_b16 a[204:205], v9 offset:10240
ds_read_b64_tr_b16 a[206:207], v9 offset:11264
buffer_load_dwordx4 v5, s[4:7], s65 offen offset:2048  lds
v_cvt_pk_bf16_f32 v167, v174, v175
v_mfma_f32_32x32x16_bf16 v[128:143], a[216:219], a[140:143], v[128:143]
ds_read_b128 a[108:111], v2 offset:15360
v_cvt_pk_bf16_f32 v168, v176, v177
v_mfma_f32_32x32x16_bf16 v[80:95], a[220:223], a[132:135], v[80:95]
ds_read_b128 a[112:115], v2 offset:16384
v_cvt_pk_bf16_f32 v169, v178, v179
v_mfma_f32_32x32x16_bf16 v[112:127], a[220:223], a[136:139], v[112:127]
ds_read_b128 a[116:119], v2 offset:17408
buffer_load_dwordx4 v6, s[4:7], s65 offen offset:3072  lds
v_cvt_pk_bf16_f32 v170, v180, v181
v_mfma_f32_32x32x16_bf16 v[144:159], a[220:223], a[140:143], v[144:159]
v_cvt_pk_bf16_f32 v171, v182, v183
s_waitcnt vmcnt(8) lgkmcnt(0)
v_mfma_f32_32x32x16_bf16 v[64:79], a[192:195], a[96:99], v[64:79]
ds_read_b64_tr_b16 a[208:209], v8 offset:12288
ds_read_b64_tr_b16 a[210:211], v8 offset:13312
v_cvt_pk_bf16_f32 v172, v184, v185
v_mfma_f32_32x32x16_bf16 v[96:111], a[192:195], a[100:103], v[96:111]
ds_read_b64_tr_b16 a[212:213], v9 offset:12288
s_add_u32 m0, s38, 26624
s_nop 0
buffer_load_dwordx4 v3, s[4:7], s66 offen offset:0  lds
v_cvt_pk_bf16_f32 v173, v186, v187
v_mfma_f32_32x32x16_bf16 v[128:143], a[192:195], a[104:107], v[128:143]
ds_read_b64_tr_b16 a[214:215], v9 offset:13312
v_cvt_pk_bf16_f32 v174, v188, v189
v_mfma_f32_32x32x16_bf16 v[80:95], a[196:199], a[96:99], v[80:95]
ds_read_b128 a[120:123], v14 offset:0
ds_read_b128 a[124:127], v14 offset:1024
v_cvt_pk_bf16_f32 v175, v190, v191
v_mfma_f32_32x32x16_bf16 v[112:127], a[196:199], a[100:103], v[112:127]
ds_read_b128 a[128:131], v14 offset:2048
buffer_load_dwordx4 v4, s[4:7], s66 offen offset:1024  lds
v_cvt_pk_bf16_f32 v176, v192, v193
v_mfma_f32_32x32x16_bf16 v[144:159], a[196:199], a[104:107], v[144:159]
ds_read_b64_tr_b16 a[216:217], v8 offset:14336
v_cvt_pk_bf16_f32 v177, v194, v195
v_mfma_f32_32x32x16_bf16 v[64:79], a[200:203], a[108:111], v[64:79]
ds_read_b64_tr_b16 a[218:219], v8 offset:15360
v_cvt_pk_bf16_f32 v178, v196, v197
v_mfma_f32_32x32x16_bf16 v[96:111], a[200:203], a[112:115], v[96:111]
ds_read_b64_tr_b16 a[220:221], v9 offset:14336
ds_read_b64_tr_b16 a[222:223], v9 offset:15360
buffer_load_dwordx4 v5, s[4:7], s66 offen offset:2048  lds
v_cvt_pk_bf16_f32 v179, v198, v199
v_mfma_f32_32x32x16_bf16 v[128:143], a[200:203], a[116:119], v[128:143]
ds_read_b128 a[132:135], v14 offset:3072
v_cvt_pk_bf16_f32 v180, v200, v201
v_mfma_f32_32x32x16_bf16 v[80:95], a[204:207], a[108:111], v[80:95]
ds_read_b128 a[136:139], v14 offset:4096
v_cvt_pk_bf16_f32 v181, v202, v203
v_mfma_f32_32x32x16_bf16 v[112:127], a[204:207], a[112:115], v[112:127]
ds_read_b128 a[140:143], v14 offset:5120
buffer_load_dwordx4 v6, s[4:7], s66 offen offset:3072  lds
v_cvt_pk_bf16_f32 v182, v204, v205
v_mfma_f32_32x32x16_bf16 v[144:159], a[204:207], a[116:119], v[144:159]
v_cvt_pk_bf16_f32 v183, v206, v207
s_waitcnt vmcnt(8) lgkmcnt(0)
v_mfma_f32_32x32x16_bf16 v[64:79], a[208:211], a[120:123], v[64:79]
v_add_u32 v10, s76, v1
ds_read_b64_tr_b16 a[192:193], v8 offset:0
ds_read_b64_tr_b16 a[194:195], v8 offset:1024
v_cvt_pk_bf16_f32 v184, v208, v209
v_mfma_f32_32x32x16_bf16 v[96:111], a[208:211], a[124:127], v[96:111]
ds_read_b64_tr_b16 a[196:197], v9 offset:0
s_add_u32 m0, s38, 30720
s_nop 0
buffer_load_dwordx4 v3, s[4:7], s67 offen offset:0  lds
v_cvt_pk_bf16_f32 v185, v210, v211
v_mfma_f32_32x32x16_bf16 v[128:143], a[208:211], a[128:131], v[128:143]
ds_read_b64_tr_b16 a[198:199], v9 offset:1024
v_cvt_pk_bf16_f32 v186, v212, v213
v_mfma_f32_32x32x16_bf16 v[80:95], a[212:215], a[120:123], v[80:95]
ds_read_b128 a[96:99], v10 offset:0
ds_read_b128 a[100:103], v10 offset:1024
v_cvt_pk_bf16_f32 v187, v214, v215
v_mfma_f32_32x32x16_bf16 v[112:127], a[212:215], a[124:127], v[112:127]
ds_read_b128 a[104:107], v10 offset:2048
buffer_load_dwordx4 v4, s[4:7], s67 offen offset:1024  lds
v_cvt_pk_bf16_f32 v188, v216, v217
v_mfma_f32_32x32x16_bf16 v[144:159], a[212:215], a[128:131], v[144:159]
ds_read_b64_tr_b16 a[200:201], v8 offset:2048
v_cvt_pk_bf16_f32 v189, v218, v219
v_mfma_f32_32x32x16_bf16 v[64:79], a[216:219], a[132:135], v[64:79]
ds_read_b64_tr_b16 a[202:203], v8 offset:3072
v_cvt_pk_bf16_f32 v190, v220, v221
v_mfma_f32_32x32x16_bf16 v[96:111], a[216:219], a[136:139], v[96:111]
ds_read_b64_tr_b16 a[204:205], v9 offset:2048
ds_read_b64_tr_b16 a[206:207], v9 offset:3072
buffer_load_dwordx4 v5, s[4:7], s67 offen offset:2048  lds
v_cvt_pk_bf16_f32 v191, v222, v223
v_mfma_f32_32x32x16_bf16 v[128:143], a[216:219], a[140:143], v[128:143]
ds_read_b128 a[108:111], v10 offset:3072
v_cvt_pk_bf16_f32 v192, v224, v225
v_mfma_f32_32x32x16_bf16 v[80:95], a[220:223], a[132:135], v[80:95]
ds_read_b128 a[112:115], v10 offset:4096
v_cvt_pk_bf16_f32 v193, v226, v227
v_mfma_f32_32x32x16_bf16 v[112:127], a[220:223], a[136:139], v[112:127]
ds_read_b128 a[116:119], v10 offset:5120
buffer_load_dwordx4 v6, s[4:7], s67 offen offset:3072  lds
v_cvt_pk_bf16_f32 v194, v228, v229
v_mfma_f32_32x32x16_bf16 v[144:159], a[220:223], a[140:143], v[144:159]
v_cvt_pk_bf16_f32 v195, v230, v231
s_waitcnt vmcnt(8) lgkmcnt(0)
v_mfma_f32_32x32x16_bf16 v[64:79], a[192:195], a[96:99], v[64:79]
v_add_u32 v11, s77, v1
ds_read_b64_tr_b16 a[208:209], v8 offset:4096
ds_read_b64_tr_b16 a[210:211], v8 offset:5120
v_cvt_pk_bf16_f32 v196, v232, v233
v_mfma_f32_32x32x16_bf16 v[96:111], a[192:195], a[100:103], v[96:111]
ds_read_b64_tr_b16 a[212:213], v9 offset:4096
s_add_u32 m0, s38, 18432
s_nop 0
buffer_load_dwordx4 v3, s[4:7], s68 offen offset:0  lds
v_cvt_pk_bf16_f32 v197, v234, v235
v_mfma_f32_32x32x16_bf16 v[128:143], a[192:195], a[104:107], v[128:143]
ds_read_b64_tr_b16 a[214:215], v9 offset:5120
v_cvt_pk_bf16_f32 v198, v236, v237
v_mfma_f32_32x32x16_bf16 v[80:95], a[196:199], a[96:99], v[80:95]
ds_read_b128 a[120:123], v11 offset:0
ds_read_b128 a[124:127], v11 offset:1024
v_cvt_pk_bf16_f32 v199, v238, v239
v_mfma_f32_32x32x16_bf16 v[112:127], a[196:199], a[100:103], v[112:127]
ds_read_b128 a[128:131], v11 offset:2048
buffer_load_dwordx4 v4, s[4:7], s68 offen offset:1024  lds
v_cvt_pk_bf16_f32 v200, v240, v241
v_mfma_f32_32x32x16_bf16 v[144:159], a[196:199], a[104:107], v[144:159]
ds_read_b64_tr_b16 a[216:217], v8 offset:6144
v_cvt_pk_bf16_f32 v201, v242, v243
v_mfma_f32_32x32x16_bf16 v[64:79], a[200:203], a[108:111], v[64:79]
ds_read_b64_tr_b16 a[218:219], v8 offset:7168
v_cvt_pk_bf16_f32 v202, v244, v245
v_mfma_f32_32x32x16_bf16 v[96:111], a[200:203], a[112:115], v[96:111]
ds_read_b64_tr_b16 a[220:221], v9 offset:6144
ds_read_b64_tr_b16 a[222:223], v9 offset:7168
buffer_load_dwordx4 v5, s[4:7], s68 offen offset:2048  lds
v_cvt_pk_bf16_f32 v203, v246, v247
v_mfma_f32_32x32x16_bf16 v[128:143], a[200:203], a[116:119], v[128:143]
ds_read_b128 a[132:135], v11 offset:3072
v_cvt_pk_bf16_f32 v204, v248, v249
v_mfma_f32_32x32x16_bf16 v[80:95], a[204:207], a[108:111], v[80:95]
ds_read_b128 a[136:139], v11 offset:4096
v_cvt_pk_bf16_f32 v205, v250, v251
v_mfma_f32_32x32x16_bf16 v[112:127], a[204:207], a[112:115], v[112:127]
ds_read_b128 a[140:143], v11 offset:5120
buffer_load_dwordx4 v6, s[4:7], s68 offen offset:3072  lds
v_cvt_pk_bf16_f32 v206, v252, v253
v_mfma_f32_32x32x16_bf16 v[144:159], a[204:207], a[116:119], v[144:159]
v_cvt_pk_bf16_f32 v207, v254, v255
s_waitcnt vmcnt(8) lgkmcnt(0)
v_mfma_f32_32x32x16_bf16 v[64:79], a[208:211], a[120:123], v[64:79]
v_add_u32 v10, s78, v1
ds_read_b64_tr_b16 a[192:193], v8 offset:8192
ds_read_b64_tr_b16 a[194:195], v8 offset:9216
v_mfma_f32_32x32x16_bf16 v[96:111], a[208:211], a[124:127], v[96:111]
ds_read_b64_tr_b16 a[196:197], v9 offset:8192
s_add_u32 m0, s38, 22528
s_nop 0
buffer_load_dwordx4 v3, s[4:7], s69 offen offset:0  lds
v_mfma_f32_32x32x16_bf16 v[128:143], a[208:211], a[128:131], v[128:143]
ds_read_b64_tr_b16 a[198:199], v9 offset:9216
v_mfma_f32_32x32x16_bf16 v[80:95], a[212:215], a[120:123], v[80:95]
ds_read_b128 a[96:99], v10 offset:0
ds_read_b128 a[100:103], v10 offset:1024
v_mfma_f32_32x32x16_bf16 v[112:127], a[212:215], a[124:127], v[112:127]
ds_read_b128 a[104:107], v10 offset:2048
buffer_load_dwordx4 v4, s[4:7], s69 offen offset:1024  lds
v_mfma_f32_32x32x16_bf16 v[144:159], a[212:215], a[128:131], v[144:159]
ds_read_b64_tr_b16 a[200:201], v8 offset:10240
v_mfma_f32_32x32x16_bf16 v[64:79], a[216:219], a[132:135], v[64:79]
ds_read_b64_tr_b16 a[202:203], v8 offset:11264
v_mfma_f32_32x32x16_bf16 v[96:111], a[216:219], a[136:139], v[96:111]
ds_read_b64_tr_b16 a[204:205], v9 offset:10240
ds_read_b64_tr_b16 a[206:207], v9 offset:11264
buffer_load_dwordx4 v5, s[4:7], s69 offen offset:2048  lds
v_mfma_f32_32x32x16_bf16 v[128:143], a[216:219], a[140:143], v[128:143]
ds_read_b128 a[108:111], v10 offset:3072
v_mfma_f32_32x32x16_bf16 v[80:95], a[220:223], a[132:135], v[80:95]
ds_read_b128 a[112:115], v10 offset:4096
v_mfma_f32_32x32x16_bf16 v[112:127], a[220:223], a[136:139], v[112:127]
ds_read_b128 a[116:119], v10 offset:5120
buffer_load_dwordx4 v6, s[4:7], s69 offen offset:3072  lds
v_mfma_f32_32x32x16_bf16 v[144:159], a[220:223], a[140:143], v[144:159]
s_waitcnt vmcnt(8) lgkmcnt(0)
v_mfma_f32_32x32x16_bf16 v[64:79], a[192:195], a[96:99], v[64:79]
v_add_u32 v11, s79, v1
ds_read_b64_tr_b16 a[208:209], v8 offset:12288
ds_read_b64_tr_b16 a[210:211], v8 offset:13312
v_mfma_f32_32x32x16_bf16 v[96:111], a[192:195], a[100:103], v[96:111]
ds_read_b64_tr_b16 a[212:213], v9 offset:12288
s_add_u32 m0, s38, 26624
s_nop 0
buffer_load_dwordx4 v3, s[4:7], s70 offen offset:0  lds
v_mfma_f32_32x32x16_bf16 v[128:143], a[192:195], a[104:107], v[128:143]
ds_read_b64_tr_b16 a[214:215], v9 offset:13312
v_mfma_f32_32x32x16_bf16 v[80:95], a[196:199], a[96:99], v[80:95]
ds_read_b128 a[120:123], v11 offset:0
ds_read_b128 a[124:127], v11 offset:1024
v_mfma_f32_32x32x16_bf16 v[112:127], a[196:199], a[100:103], v[112:127]
ds_read_b128 a[128:131], v11 offset:2048
buffer_load_dwordx4 v4, s[4:7], s70 offen offset:1024  lds
v_mfma_f32_32x32x16_bf16 v[144:159], a[196:199], a[104:107], v[144:159]
ds_read_b64_tr_b16 a[216:217], v8 offset:14336
v_mfma_f32_32x32x16_bf16 v[64:79], a[200:203], a[108:111], v[64:79]
ds_read_b64_tr_b16 a[218:219], v8 offset:15360
v_mfma_f32_32x32x16_bf16 v[96:111], a[200:203], a[112:115], v[96:111]
ds_read_b64_tr_b16 a[220:221], v9 offset:14336
ds_read_b64_tr_b16 a[222:223], v9 offset:15360
buffer_load_dwordx4 v5, s[4:7], s70 offen offset:2048  lds
v_mfma_f32_32x32x16_bf16 v[128:143], a[200:203], a[116:119], v[128:143]
ds_read_b128 a[132:135], v11 offset:3072
v_mfma_f32_32x32x16_bf16 v[80:95], a[204:207], a[108:111], v[80:95]
ds_read_b128 a[136:139], v11 offset:4096
v_mfma_f32_32x32x16_bf16 v[112:127], a[204:207], a[112:115], v[112:127]
ds_read_b128 a[140:143], v11 offset:5120
buffer_load_dwordx4 v6, s[4:7], s70 offen offset:3072  lds
v_mfma_f32_32x32x16_bf16 v[144:159], a[204:207], a[116:119], v[144:159]
s_waitcnt vmcnt(8) lgkmcnt(0)
v_mfma_f32_32x32x16_bf16 v[64:79], a[208:211], a[120:123], v[64:79]
v_add_u32 v10, s80, v1
ds_read_b64_tr_b16 a[192:193], v8 offset:0
ds_read_b64_tr_b16 a[194:195], v8 offset:1024
v_mfma_f32_32x32x16_bf16 v[96:111], a[208:211], a[124:127], v[96:111]
ds_read_b64_tr_b16 a[196:197], v9 offset:0
s_add_u32 m0, s38, 30720
s_nop 0
buffer_load_dwordx4 v3, s[4:7], s71 offen offset:0  lds
v_mfma_f32_32x32x16_bf16 v[128:143], a[208:211], a[128:131], v[128:143]
ds_read_b64_tr_b16 a[198:199], v9 offset:1024
v_mfma_f32_32x32x16_bf16 v[80:95], a[212:215], a[120:123], v[80:95]
ds_read_b128 a[96:99], v10 offset:0
ds_read_b128 a[100:103], v10 offset:1024
v_mfma_f32_32x32x16_bf16 v[112:127], a[212:215], a[124:127], v[112:127]
ds_read_b128 a[104:107], v10 offset:2048
buffer_load_dwordx4 v4, s[4:7], s71 offen offset:1024  lds
v_mfma_f32_32x32x16_bf16 v[144:159], a[212:215], a[128:131], v[144:159]
ds_read_b64_tr_b16 a[200:201], v8 offset:2048
v_mfma_f32_32x32x16_bf16 v[64:79], a[216:219], a[132:135], v[64:79]
ds_read_b64_tr_b16 a[202:203], v8 offset:3072
v_mfma_f32_32x32x16_bf16 v[96:111], a[216:219], a[136:139], v[96:111]
ds_read_b64_tr_b16 a[204:205], v9 offset:2048
ds_read_b64_tr_b16 a[206:207], v9 offset:3072
buffer_load_dwordx4 v5, s[4:7], s71 offen offset:2048  lds
v_mfma_f32_32x32x16_bf16 v[128:143], a[216:219], a[140:143], v[128:143]
ds_read_b128 a[108:111], v10 offset:3072
v_mfma_f32_32x32x16_bf16 v[80:95], a[220:223], a[132:135], v[80:95]
ds_read_b128 a[112:115], v10 offset:4096
v_mfma_f32_32x32x16_bf16 v[112:127], a[220:223], a[136:139], v[112:127]
ds_read_b128 a[116:119], v10 offset:5120
buffer_load_dwordx4 v6, s[4:7], s71 offen offset:3072  lds
v_mfma_f32_32x32x16_bf16 v[144:159], a[220:223], a[140:143], v[144:159]
s_waitcnt vmcnt(8) lgkmcnt(0)
v_mfma_f32_32x32x16_bf16 v[64:79], a[192:195], a[96:99], v[64:79]
v_add_u32 v11, s81, v1
ds_read_b64_tr_b16 a[208:209], v8 offset:4096
ds_read_b64_tr_b16 a[210:211], v8 offset:5120
v_mfma_f32_32x32x16_bf16 v[96:111], a[192:195], a[100:103], v[96:111]
ds_read_b64_tr_b16 a[212:213], v9 offset:4096
s_add_u32 m0, s38, 18432
s_nop 0
buffer_load_dwordx4 v3, s[4:7], s72 offen offset:0  lds
v_mfma_f32_32x32x16_bf16 v[128:143], a[192:195], a[104:107], v[128:143]
ds_read_b64_tr_b16 a[214:215], v9 offset:5120
v_mfma_f32_32x32x16_bf16 v[80:95], a[196:199], a[96:99], v[80:95]
ds_read_b128 a[120:123], v11 offset:0
ds_read_b128 a[124:127], v11 offset:1024
v_mfma_f32_32x32x16_bf16 v[112:127], a[196:199], a[100:103], v[112:127]
ds_read_b128 a[128:131], v11 offset:2048
buffer_load_dwordx4 v4, s[4:7], s72 offen offset:1024  lds
v_mfma_f32_32x32x16_bf16 v[144:159], a[196:199], a[104:107], v[144:159]
ds_read_b64_tr_b16 a[216:217], v8 offset:6144
v_mfma_f32_32x32x16_bf16 v[64:79], a[200:203], a[108:111], v[64:79]
ds_read_b64_tr_b16 a[218:219], v8 offset:7168
v_mfma_f32_32x32x16_bf16 v[96:111], a[200:203], a[112:115], v[96:111]
ds_read_b64_tr_b16 a[220:221], v9 offset:6144
ds_read_b64_tr_b16 a[222:223], v9 offset:7168
buffer_load_dwordx4 v5, s[4:7], s72 offen offset:2048  lds
v_mfma_f32_32x32x16_bf16 v[128:143], a[200:203], a[116:119], v[128:143]
ds_read_b128 a[132:135], v11 offset:3072
v_mfma_f32_32x32x16_bf16 v[80:95], a[204:207], a[108:111], v[80:95]
ds_read_b128 a[136:139], v11 offset:4096
v_mfma_f32_32x32x16_bf16 v[112:127], a[204:207], a[112:115], v[112:127]
ds_read_b128 a[140:143], v11 offset:5120
buffer_load_dwordx4 v6, s[4:7], s72 offen offset:3072  lds
v_mfma_f32_32x32x16_bf16 v[144:159], a[204:207], a[116:119], v[144:159]
s_waitcnt vmcnt(8) lgkmcnt(0)
v_mfma_f32_32x32x16_bf16 v[64:79], a[208:211], a[120:123], v[64:79]
v_add_u32 v10, s82, v1
ds_read_b64_tr_b16 a[192:193], v8 offset:8192
ds_read_b64_tr_b16 a[194:195], v8 offset:9216
v_mfma_f32_32x32x16_bf16 v[96:111], a[208:211], a[124:127], v[96:111]
ds_read_b64_tr_b16 a[196:197], v9 offset:8192
s_add_u32 m0, s38, 22528
s_nop 0
buffer_load_dwordx4 v3, s[4:7], s73 offen offset:0  lds
v_mfma_f32_32x32x16_bf16 v[128:143], a[208:211], a[128:131], v[128:143]
ds_read_b64_tr_b16 a[198:199], v9 offset:9216
v_mfma_f32_32x32x16_bf16 v[80:95], a[212:215], a[120:123], v[80:95]
ds_read_b128 a[96:99], v10 offset:0
ds_read_b128 a[100:103], v10 offset:1024
v_mfma_f32_32x32x16_bf16 v[112:127], a[212:215], a[124:127], v[112:127]
ds_read_b128 a[104:107], v10 offset:2048
buffer_load_dwordx4 v4, s[4:7], s73 offen offset:1024  lds
v_mfma_f32_32x32x16_bf16 v[144:159], a[212:215], a[128:131], v[144:159]
ds_read_b64_tr_b16 a[200:201], v8 offset:10240
v_mfma_f32_32x32x16_bf16 v[64:79], a[216:219], a[132:135], v[64:79]
ds_read_b64_tr_b16 a[202:203], v8 offset:11264
v_mfma_f32_32x32x16_bf16 v[96:111], a[216:219], a[136:139], v[96:111]
ds_read_b64_tr_b16 a[204:205], v9 offset:10240
ds_read_b64_tr_b16 a[206:207], v9 offset:11264
buffer_load_dwordx4 v5, s[4:7], s73 offen offset:2048  lds
v_mfma_f32_32x32x16_bf16 v[128:143], a[216:219], a[140:143], v[128:143]
ds_read_b128 a[108:111], v10 offset:3072
v_mfma_f32_32x32x16_bf16 v[80:95], a[220:223], a[132:135], v[80:95]
ds_read_b128 a[112:115], v10 offset:4096
v_mfma_f32_32x32x16_bf16 v[112:127], a[220:223], a[136:139], v[112:127]
ds_read_b128 a[116:119], v10 offset:5120
buffer_load_dwordx4 v6, s[4:7], s73 offen offset:3072  lds
v_mfma_f32_32x32x16_bf16 v[144:159], a[220:223], a[140:143], v[144:159]
s_waitcnt vmcnt(8) lgkmcnt(0)
v_mfma_f32_32x32x16_bf16 v[64:79], a[192:195], a[96:99], v[64:79]
v_add_u32 v11, s83, v1
ds_read_b64_tr_b16 a[208:209], v8 offset:12288
ds_read_b64_tr_b16 a[210:211], v8 offset:13312
v_mfma_f32_32x32x16_bf16 v[96:111], a[192:195], a[100:103], v[96:111]
ds_read_b64_tr_b16 a[212:213], v9 offset:12288
s_add_u32 m0, s38, 26624
s_nop 0
buffer_load_dwordx4 v3, s[4:7], s74 offen offset:0  lds
v_mfma_f32_32x32x16_bf16 v[128:143], a[192:195], a[104:107], v[128:143]
ds_read_b64_tr_b16 a[214:215], v9 offset:13312
v_mfma_f32_32x32x16_bf16 v[80:95], a[196:199], a[96:99], v[80:95]
ds_read_b128 a[120:123], v11 offset:0
ds_read_b128 a[124:127], v11 offset:1024
v_mfma_f32_32x32x16_bf16 v[112:127], a[196:199], a[100:103], v[112:127]
ds_read_b128 a[128:131], v11 offset:2048
buffer_load_dwordx4 v4, s[4:7], s74 offen offset:1024  lds
v_mfma_f32_32x32x16_bf16 v[144:159], a[196:199], a[104:107], v[144:159]
ds_read_b64_tr_b16 a[216:217], v8 offset:14336
v_mfma_f32_32x32x16_bf16 v[64:79], a[200:203], a[108:111], v[64:79]
ds_read_b64_tr_b16 a[218:219], v8 offset:15360
v_mfma_f32_32x32x16_bf16 v[96:111], a[200:203], a[112:115], v[96:111]
ds_read_b64_tr_b16 a[220:221], v9 offset:14336
ds_read_b64_tr_b16 a[222:223], v9 offset:15360
buffer_load_dwordx4 v5, s[4:7], s74 offen offset:2048  lds
v_mfma_f32_32x32x16_bf16 v[128:143], a[200:203], a[116:119], v[128:143]
ds_read_b128 a[132:135], v11 offset:3072
v_mfma_f32_32x32x16_bf16 v[80:95], a[204:207], a[108:111], v[80:95]
ds_read_b128 a[136:139], v11 offset:4096
v_mfma_f32_32x32x16_bf16 v[112:127], a[204:207], a[112:115], v[112:127]
ds_read_b128 a[140:143], v11 offset:5120
buffer_load_dwordx4 v6, s[4:7], s74 offen offset:3072  lds
v_mfma_f32_32x32x16_bf16 v[144:159], a[204:207], a[116:119], v[144:159]
s_waitcnt vmcnt(8) lgkmcnt(0)
v_mfma_f32_32x32x16_bf16 v[64:79], a[208:211], a[120:123], v[64:79]
v_add_u32 v10, s8, v1
ds_read_b64_tr_b16 a[192:193], v8 offset:0
ds_read_b64_tr_b16 a[194:195], v8 offset:1024
v_mfma_f32_32x32x16_bf16 v[96:111], a[208:211], a[124:127], v[96:111]
ds_read_b64_tr_b16 a[196:197], v9 offset:0
s_add_u32 m0, s38, 30720
s_nop 0
buffer_load_dwordx4 v3, s[4:7], s75 offen offset:0  lds
v_mfma_f32_32x32x16_bf16 v[128:143], a[208:211], a[128:131], v[128:143]
ds_read_b64_tr_b16 a[198:199], v9 offset:1024
v_mfma_f32_32x32x16_bf16 v[80:95], a[212:215], a[120:123], v[80:95]
ds_read_b128 a[96:99], v10 offset:0
ds_read_b128 a[100:103], v10 offset:1024
v_mfma_f32_32x32x16_bf16 v[112:127], a[212:215], a[124:127], v[112:127]
ds_read_b128 a[104:107], v10 offset:2048
buffer_load_dwordx4 v4, s[4:7], s75 offen offset:1024  lds
v_mfma_f32_32x32x16_bf16 v[144:159], a[212:215], a[128:131], v[144:159]
ds_read_b64_tr_b16 a[200:201], v8 offset:2048
v_mfma_f32_32x32x16_bf16 v[64:79], a[216:219], a[132:135], v[64:79]
ds_read_b64_tr_b16 a[202:203], v8 offset:3072
v_mfma_f32_32x32x16_bf16 v[96:111], a[216:219], a[136:139], v[96:111]
ds_read_b64_tr_b16 a[204:205], v9 offset:2048
ds_read_b64_tr_b16 a[206:207], v9 offset:3072
buffer_load_dwordx4 v5, s[4:7], s75 offen offset:2048  lds
v_mfma_f32_32x32x16_bf16 v[128:143], a[216:219], a[140:143], v[128:143]
ds_read_b128 a[108:111], v10 offset:3072
v_mfma_f32_32x32x16_bf16 v[80:95], a[220:223], a[132:135], v[80:95]
ds_read_b128 a[112:115], v10 offset:4096
v_mfma_f32_32x32x16_bf16 v[112:127], a[220:223], a[136:139], v[112:127]
ds_read_b128 a[116:119], v10 offset:5120
buffer_load_dwordx4 v6, s[4:7], s75 offen offset:3072  lds
v_mfma_f32_32x32x16_bf16 v[144:159], a[220:223], a[140:143], v[144:159]
s_waitcnt vmcnt(8) lgkmcnt(0)
v_mfma_f32_32x32x16_bf16 v[64:79], a[192:195], a[96:99], v[64:79]
v_add_u32 v11, s9, v1
ds_read_b64_tr_b16 a[208:209], v8 offset:4096
ds_read_b64_tr_b16 a[210:211], v8 offset:5120
s_add_u32 s37, s50, 0
v_mfma_f32_32x32x16_bf16 v[96:111], a[192:195], a[100:103], v[96:111]
ds_read_b64_tr_b16 a[212:213], v9 offset:4096
ds_read_b64_tr_b16 a[214:215], v9 offset:5120
ds_write_b128 v2, v[16:19] offset:18432
buffer_store_dwordx4 v[160:163], v1, s[20:23], s37 offen offset:0 sc1
v_mfma_f32_32x32x16_bf16 v[128:143], a[192:195], a[104:107], v[128:143]
ds_read_b128 a[120:123], v11 offset:0
buffer_store_dwordx4 v[164:167], v1, s[20:23], s37 offen offset:1024 sc1
v_mfma_f32_32x32x16_bf16 v[80:95], a[196:199], a[96:99], v[80:95]
ds_read_b128 a[124:127], v11 offset:1024
ds_read_b128 a[128:131], v11 offset:2048
s_add_u32 s37, s50, 2048
v_mfma_f32_32x32x16_bf16 v[112:127], a[196:199], a[100:103], v[112:127]
ds_read_b64_tr_b16 a[216:217], v8 offset:6144
ds_write_b128 v2, v[20:23] offset:19456
buffer_store_dwordx4 v[168:171], v1, s[20:23], s37 offen offset:0 sc1
v_mfma_f32_32x32x16_bf16 v[144:159], a[196:199], a[104:107], v[144:159]
ds_read_b64_tr_b16 a[218:219], v8 offset:7168
ds_read_b64_tr_b16 a[220:221], v9 offset:6144
buffer_store_dwordx4 v[172:175], v1, s[20:23], s37 offen offset:1024 sc1
v_mfma_f32_32x32x16_bf16 v[64:79], a[200:203], a[108:111], v[64:79]
ds_read_b64_tr_b16 a[222:223], v9 offset:7168
s_add_u32 s37, s50, 8192
v_mfma_f32_32x32x16_bf16 v[96:111], a[200:203], a[112:115], v[96:111]
ds_read_b128 a[132:135], v11 offset:3072
ds_read_b128 a[136:139], v11 offset:4096
buffer_store_dwordx4 v[176:179], v1, s[20:23], s37 offen offset:0 sc1
v_mfma_f32_32x32x16_bf16 v[128:143], a[200:203], a[116:119], v[128:143]
ds_read_b128 a[140:143], v11 offset:5120
buffer_store_dwordx4 v[180:183], v1, s[20:23], s37 offen offset:1024 sc1
v_mfma_f32_32x32x16_bf16 v[80:95], a[204:207], a[108:111], v[80:95]
ds_write_b128 v2, v[24:27] offset:20480
s_add_u32 s37, s50, 10240
v_mfma_f32_32x32x16_bf16 v[112:127], a[204:207], a[112:115], v[112:127]
ds_write_b128 v2, v[28:31] offset:21504
buffer_store_dwordx4 v[184:187], v1, s[20:23], s37 offen offset:0 sc1
v_mfma_f32_32x32x16_bf16 v[144:159], a[204:207], a[116:119], v[144:159]
buffer_store_dwordx4 v[188:191], v1, s[20:23], s37 offen offset:1024 sc1
s_waitcnt vmcnt(12) lgkmcnt(2)
v_mfma_f32_32x32x16_bf16 v[64:79], a[208:211], a[120:123], v[64:79]
v_add_u32 v10, s10, v1
ds_read_b64_tr_b16 a[192:193], v8 offset:8192
ds_read_b64_tr_b16 a[194:195], v8 offset:9216
s_add_u32 s37, s50, 16384
v_mfma_f32_32x32x16_bf16 v[96:111], a[208:211], a[124:127], v[96:111]
ds_read_b64_tr_b16 a[196:197], v9 offset:8192
ds_read_b64_tr_b16 a[198:199], v9 offset:9216
ds_write_b128 v2, v[32:35] offset:22528
buffer_store_dwordx4 v[192:195], v1, s[20:23], s37 offen offset:0 sc1
v_mfma_f32_32x32x16_bf16 v[128:143], a[208:211], a[128:131], v[128:143]
ds_read_b128 a[96:99], v10 offset:0
buffer_store_dwordx4 v[196:199], v1, s[20:23], s37 offen offset:1024 sc1
v_mfma_f32_32x32x16_bf16 v[80:95], a[212:215], a[120:123], v[80:95]
ds_read_b128 a[100:103], v10 offset:1024
ds_read_b128 a[104:107], v10 offset:2048
s_add_u32 s37, s50, 18432
v_mfma_f32_32x32x16_bf16 v[112:127], a[212:215], a[124:127], v[112:127]
ds_read_b64_tr_b16 a[200:201], v8 offset:10240
ds_write_b128 v2, v[36:39] offset:23552
buffer_store_dwordx4 v[200:203], v1, s[20:23], s37 offen offset:0 sc1
v_mfma_f32_32x32x16_bf16 v[144:159], a[212:215], a[128:131], v[144:159]
ds_read_b64_tr_b16 a[202:203], v8 offset:11264
ds_read_b64_tr_b16 a[204:205], v9 offset:10240
buffer_store_dwordx4 v[204:207], v1, s[20:23], s37 offen offset:1024 sc1
v_mfma_f32_32x32x16_bf16 v[64:79], a[216:219], a[132:135], v[64:79]
ds_read_b64_tr_b16 a[206:207], v9 offset:11264
v_mfma_f32_32x32x16_bf16 v[96:111], a[216:219], a[136:139], v[96:111]
ds_read_b128 a[108:111], v10 offset:3072
ds_read_b128 a[112:115], v10 offset:4096
v_mfma_f32_32x32x16_bf16 v[128:143], a[216:219], a[140:143], v[128:143]
ds_read_b128 a[116:119], v10 offset:5120
v_mfma_f32_32x32x16_bf16 v[80:95], a[220:223], a[132:135], v[80:95]
ds_write_b128 v2, v[40:43] offset:24576
v_mfma_f32_32x32x16_bf16 v[112:127], a[220:223], a[136:139], v[112:127]
ds_write_b128 v2, v[44:47] offset:25600
v_mfma_f32_32x32x16_bf16 v[144:159], a[220:223], a[140:143], v[144:159]
s_waitcnt vmcnt(12) lgkmcnt(2)
v_mfma_f32_32x32x16_bf16 v[64:79], a[192:195], a[96:99], v[64:79]
v_add_u32 v11, s11, v1
ds_read_b64_tr_b16 a[208:209], v8 offset:12288
ds_read_b64_tr_b16 a[210:211], v8 offset:13312
ds_write_b128 v2, v[48:51] offset:26624
v_mfma_f32_32x32x16_bf16 v[96:111], a[192:195], a[100:103], v[96:111]
ds_read_b64_tr_b16 a[212:213], v9 offset:12288
v_mfma_f32_32x32x16_bf16 v[128:143], a[192:195], a[104:107], v[128:143]
ds_read_b64_tr_b16 a[214:215], v9 offset:13312
ds_write_b128 v2, v[52:55] offset:27648
v_mfma_f32_32x32x16_bf16 v[80:95], a[196:199], a[96:99], v[80:95]
ds_read_b128 a[120:123], v11 offset:0
ds_read_b128 a[124:127], v11 offset:1024
v_mfma_f32_32x32x16_bf16 v[112:127], a[196:199], a[100:103], v[112:127]
ds_read_b128 a[128:131], v11 offset:2048
ds_write_b128 v2, v[56:59] offset:28672
v_mfma_f32_32x32x16_bf16 v[144:159], a[196:199], a[104:107], v[144:159]
ds_read_b64_tr_b16 a[216:217], v8 offset:14336
v_mfma_f32_32x32x16_bf16 v[64:79], a[200:203], a[108:111], v[64:79]
ds_read_b64_tr_b16 a[218:219], v8 offset:15360
ds_write_b128 v2, v[60:63] offset:29696
v_mfma_f32_32x32x16_bf16 v[96:111], a[200:203], a[112:115], v[96:111]
ds_read_b64_tr_b16 a[220:221], v9 offset:14336
ds_read_b64_tr_b16 a[222:223], v9 offset:15360
v_mfma_f32_32x32x16_bf16 v[128:143], a[200:203], a[116:119], v[128:143]
ds_read_b128 a[132:135], v11 offset:3072
v_mfma_f32_32x32x16_bf16 v[80:95], a[204:207], a[108:111], v[80:95]
ds_read_b128 a[136:139], v11 offset:4096
v_mfma_f32_32x32x16_bf16 v[112:127], a[204:207], a[112:115], v[112:127]
ds_read_b128 a[140:143], v11 offset:5120
v_mfma_f32_32x32x16_bf16 v[144:159], a[204:207], a[116:119], v[144:159]
s_waitcnt lgkmcnt(0)
v_mfma_f32_32x32x16_bf16 v[64:79], a[208:211], a[120:123], v[64:79]
v_mfma_f32_32x32x16_bf16 v[96:111], a[208:211], a[124:127], v[96:111]
v_mfma_f32_32x32x16_bf16 v[128:143], a[208:211], a[128:131], v[128:143]
v_mfma_f32_32x32x16_bf16 v[80:95], a[212:215], a[120:123], v[80:95]
v_mfma_f32_32x32x16_bf16 v[112:127], a[212:215], a[124:127], v[112:127]
v_mfma_f32_32x32x16_bf16 v[144:159], a[212:215], a[128:131], v[144:159]
v_mfma_f32_32x32x16_bf16 v[64:79], a[216:219], a[132:135], v[64:79]
v_mfma_f32_32x32x16_bf16 v[96:111], a[216:219], a[136:139], v[96:111]
v_mfma_f32_32x32x16_bf16 v[128:143], a[216:219], a[140:143], v[128:143]
v_mfma_f32_32x32x16_bf16 v[80:95], a[220:223], a[132:135], v[80:95]
v_mfma_f32_32x32x16_bf16 v[112:127], a[220:223], a[136:139], v[112:127]
v_mfma_f32_32x32x16_bf16 v[144:159], a[220:223], a[140:143], v[144:159]
s_waitcnt vmcnt(0)
s_barrier
s_cmp_lg_u32 s3, 3
s_cbranch_scc1 L_nopush1
s_cmp_ge_u32 s40, 8
s_cbranch_scc1 L_initok
s_lshl_b32 s34, s95, 3
v_mov_b32 v12, s34
s_mov_b32 s35, 0
L_ipoll:
global_load_dword v13, v12, s[98:99] sc1
s_waitcnt vmcnt(0)
v_readfirstlane_b32 s40, v13
s_add_u32 s35, s35, 1
s_cmp_ge_u32 s40, 8
s_cbranch_scc1 L_initok
s_sleep 8
s_cmp_lt_u32 s35, 0x80000
s_cbranch_scc1 L_ipoll
L_initok:
s_lshl_b32 s34, s95, 11
s_lshl_b32 s35, s24, 6
s_add_u32 s34, s34, s35
s_lshl_b32 s35, s25, 2
s_add_u32 s34, s34, s35
s_add_u32 s34, s34, 50331648
v_lshlrev_b32 v12, 8, v7
v_add_u32 v12, s34, v12
v_mov_b32 v13, 1
s_mov_b64 exec, 0xff
global_store_dword v12, v13, s[96:97] sc1
s_mov_b64 exec, -1
L_nopush1:
s_mul_i32 s34, s3, 3072
s_add_u32 s34, s34, 18432
v_add_u32 v10, s34, v1
v_add_u32 v11, 69632, v10
s_mov_b32 s64, 0x3f80
s_mov_b32 s65, 0x3f800000
ds_read_b128 v[16:19], v10 offset:0
ds_read_b128 v[20:23], v10 offset:1024
ds_read_b128 v[24:27], v10 offset:2048
ds_read_b128 v[28:31], v10 offset:34816
ds_read_b128 v[32:35], v10 offset:35840
ds_read_b128 v[36:39], v10 offset:36864
ds_read_b128 v[40:43], v11 offset:0
ds_read_b128 v[44:47], v11 offset:1024
ds_read_b128 v[48:51], v11 offset:2048
ds_read_b128 v[52:55], v11 offset:34816
ds_read_b128 v[56:59], v11 offset:35840
ds_read_b128 v[60:63], v11 offset:36864
v_cvt_pk_bf16_f32 v208, v64, v65
v_cvt_pk_bf16_f32 v209, v66, v67
v_cvt_pk_bf16_f32 v210, v68, v69
v_cvt_pk_bf16_f32 v211, v70, v71
v_cvt_pk_bf16_f32 v212, v72, v73
v_cvt_pk_bf16_f32 v213, v74, v75
v_cvt_pk_bf16_f32 v214, v76, v77
v_cvt_pk_bf16_f32 v215, v78, v79
s_add_u32 s50, s50, s39
s_add_u32 s37, s50, 0
buffer_store_dwordx4 v[208:211], v1, s[20:23], s37 offen offset:0 sc1
buffer_store_dwordx4 v[212:215], v1, s[20:23], s37 offen offset:1024 sc1
v_cvt_pk_bf16_f32 v216, v96, v97
v_cvt_pk_bf16_f32 v217, v98, v99
v_cvt_pk_bf16_f32 v218, v100, v101
v_cvt_pk_bf16_f32 v219, v102, v103
v_cvt_pk_bf16_f32 v220, v104, v105
v_cvt_pk_bf16_f32 v221, v106, v107
v_cvt_pk_bf16_f32 v222, v108, v109
v_cvt_pk_bf16_f32 v223, v110, v111
s_add_u32 s37, s50, 8192
buffer_store_dwordx4 v[216:219], v1, s[20:23], s37 offen offset:0 sc1
buffer_store_dwordx4 v[220:223], v1, s[20:23], s37 offen offset:1024 sc1
v_cvt_pk_bf16_f32 v224, v128, v129
v_cvt_pk_bf16_f32 v225, v130, v131
v_cvt_pk_bf16_f32 v226, v132, v133
v_cvt_pk_bf16_f32 v227, v134, v135
v_cvt_pk_bf16_f32 v228, v136, v137
v_cvt_pk_bf16_f32 v229, v138, v139
v_cvt_pk_bf16_f32 v230, v140, v141
v_cvt_pk_bf16_f32 v231, v142, v143
s_add_u32 s37, s50, 16384
buffer_store_dwordx4 v[224:227], v1, s[20:23], s37 offen offset:0 sc1
buffer_store_dwordx4 v[228:231], v1, s[20:23], s37 offen offset:1024 sc1
v_cvt_pk_bf16_f32 v232, v80, v81
v_cvt_pk_bf16_f32 v233, v82, v83
v_cvt_pk_bf16_f32 v234, v84, v85
v_cvt_pk_bf16_f32 v235, v86, v87
v_cvt_pk_bf16_f32 v236, v88, v89
v_cvt_pk_bf16_f32 v237, v90, v91
v_cvt_pk_bf16_f32 v238, v92, v93
v_cvt_pk_bf16_f32 v239, v94, v95
s_add_u32 s37, s50, 2048
buffer_store_dwordx4 v[232:235], v1, s[20:23], s37 offen offset:0 sc1
buffer_store_dwordx4 v[236:239], v1, s[20:23], s37 offen offset:1024 sc1
v_cvt_pk_bf16_f32 v240, v112, v113
v_cvt_pk_bf16_f32 v241, v114, v115
v_cvt_pk_bf16_f32 v242, v116, v117
v_cvt_pk_bf16_f32 v243, v118, v119
v_cvt_pk_bf16_f32 v244, v120, v121
v_cvt_pk_bf16_f32 v245, v122, v123
v_cvt_pk_bf16_f32 v246, v124, v125
v_cvt_pk_bf16_f32 v247, v126, v127
s_add_u32 s37, s50, 10240
buffer_store_dwordx4 v[240:243], v1, s[20:23], s37 offen offset:0 sc1
buffer_store_dwordx4 v[244:247], v1, s[20:23], s37 offen offset:1024 sc1
v_cvt_pk_bf16_f32 v248, v144, v145
v_cvt_pk_bf16_f32 v249, v146, v147
v_cvt_pk_bf16_f32 v250, v148, v149
v_cvt_pk_bf16_f32 v251, v150, v151
v_cvt_pk_bf16_f32 v252, v152, v153
v_cvt_pk_bf16_f32 v253, v154, v155
v_cvt_pk_bf16_f32 v254, v156, v157
v_cvt_pk_bf16_f32 v255, v158, v159
s_add_u32 s37, s50, 18432
buffer_store_dwordx4 v[248:251], v1, s[20:23], s37 offen offset:0 sc1
buffer_store_dwordx4 v[252:255], v1, s[20:23], s37 offen offset:1024 sc1
s_waitcnt lgkmcnt(0)
v_dot2_f32_bf16 v64, v16, s64, 0
v_dot2_f32_bf16 v65, v16, s65, 0
v_dot2_f32_bf16 v66, v17, s64, 0
v_dot2_f32_bf16 v67, v17, s65, 0
v_dot2_f32_bf16 v68, v18, s64, 0
v_dot2_f32_bf16 v69, v18, s65, 0
v_dot2_f32_bf16 v70, v19, s64, 0
v_dot2_f32_bf16 v71, v19, s65, 0
v_dot2_f32_bf16 v72, v20, s64, 0
v_dot2_f32_bf16 v73, v20, s65, 0
v_dot2_f32_bf16 v74, v21, s64, 0
v_dot2_f32_bf16 v75, v21, s65, 0
v_dot2_f32_bf16 v76, v22, s64, 0
v_dot2_f32_bf16 v77, v22, s65, 0
v_dot2_f32_bf16 v78, v23, s64, 0
v_dot2_f32_bf16 v79, v23, s65, 0
v_dot2_f32_bf16 v80, v24, s64, 0
v_dot2_f32_bf16 v81, v24, s65, 0
v_dot2_f32_bf16 v82, v25, s64, 0
v_dot2_f32_bf16 v83, v25, s65, 0
v_dot2_f32_bf16 v84, v26, s64, 0
v_dot2_f32_bf16 v85, v26, s65, 0
v_dot2_f32_bf16 v86, v27, s64, 0
v_dot2_f32_bf16 v87, v27, s65, 0
v_dot2_f32_bf16 v64, v28, s64, v64
v_dot2_f32_bf16 v65, v28, s65, v65
v_dot2_f32_bf16 v66, v29, s64, v66
v_dot2_f32_bf16 v67, v29, s65, v67
v_dot2_f32_bf16 v68, v30, s64, v68
v_dot2_f32_bf16 v69, v30, s65, v69
v_dot2_f32_bf16 v70, v31, s64, v70
v_dot2_f32_bf16 v71, v31, s65, v71
v_dot2_f32_bf16 v72, v32, s64, v72
v_dot2_f32_bf16 v73, v32, s65, v73
v_dot2_f32_bf16 v74, v33, s64, v74
v_dot2_f32_bf16 v75, v33, s65, v75
v_dot2_f32_bf16 v76, v34, s64, v76
v_dot2_f32_bf16 v77, v34, s65, v77
v_dot2_f32_bf16 v78, v35, s64, v78
v_dot2_f32_bf16 v79, v35, s65, v79
v_dot2_f32_bf16 v80, v36, s64, v80
v_dot2_f32_bf16 v81, v36, s65, v81
v_dot2_f32_bf16 v82, v37, s64, v82
v_dot2_f32_bf16 v83, v37, s65, v83
v_dot2_f32_bf16 v84, v38, s64, v84
v_dot2_f32_bf16 v85, v38, s65, v85
v_dot2_f32_bf16 v86, v39, s64, v86
v_dot2_f32_bf16 v87, v39, s65, v87
v_dot2_f32_bf16 v64, v40, s64, v64
v_dot2_f32_bf16 v65, v40, s65, v65
v_dot2_f32_bf16 v66, v41, s64, v66
v_dot2_f32_bf16 v67, v41, s65, v67
v_dot2_f32_bf16 v68, v42, s64, v68
v_dot2_f32_bf16 v69, v42, s65, v69
v_dot2_f32_bf16 v70, v43, s64, v70
v_dot2_f32_bf16 v71, v43, s65, v71
v_dot2_f32_bf16 v72, v44, s64, v72
v_dot2_f32_bf16 v73, v44, s65, v73
v_dot2_f32_bf16 v74, v45, s64, v74
v_dot2_f32_bf16 v75, v45, s65, v75
v_dot2_f32_bf16 v76, v46, s64, v76
v_dot2_f32_bf16 v77, v46, s65, v77
v_dot2_f32_bf16 v78, v47, s64, v78
v_dot2_f32_bf16 v79, v47, s65, v79
v_dot2_f32_bf16 v80, v48, s64, v80
v_dot2_f32_bf16 v81, v48, s65, v81
v_dot2_f32_bf16 v82, v49, s64, v82
v_dot2_f32_bf16 v83, v49, s65, v83
v_dot2_f32_bf16 v84, v50, s64, v84
v_dot2_f32_bf16 v85, v50, s65, v85
v_dot2_f32_bf16 v86, v51, s64, v86
v_dot2_f32_bf16 v87, v51, s65, v87
v_dot2_f32_bf16 v64, v52, s64, v64
v_dot2_f32_bf16 v65, v52, s65, v65
v_dot2_f32_bf16 v66, v53, s64, v66
v_dot2_f32_bf16 v67, v53, s65, v67
v_dot2_f32_bf16 v68, v54, s64, v68
v_dot2_f32_bf16 v69, v54, s65, v69
v_dot2_f32_bf16 v70, v55, s64, v70
v_dot2_f32_bf16 v71, v55, s65, v71
v_dot2_f32_bf16 v72, v56, s64, v72
v_dot2_f32_bf16 v73, v56, s65, v73
v_dot2_f32_bf16 v74, v57, s64, v74
v_dot2_f32_bf16 v75, v57, s65, v75
v_dot2_f32_bf16 v76, v58, s64, v76
v_dot2_f32_bf16 v77, v58, s65, v77
v_dot2_f32_bf16 v78, v59, s64, v78
v_dot2_f32_bf16 v79, v59, s65, v79
v_dot2_f32_bf16 v80, v60, s64, v80
v_dot2_f32_bf16 v81, v60, s65, v81
v_dot2_f32_bf16 v82, v61, s64, v82
v_dot2_f32_bf16 v83, v61, s65, v83
v_dot2_f32_bf16 v84, v62, s64, v84
v_dot2_f32_bf16 v85, v62, s65, v85
v_dot2_f32_bf16 v86, v63, s64, v86
v_dot2_f32_bf16 v87, v63, s65, v87
s_nop 2
v_cvt_pk_bf16_f32 v96, v64, v65
v_cvt_pk_bf16_f32 v97, v66, v67
v_cvt_pk_bf16_f32 v98, v68, v69
v_cvt_pk_bf16_f32 v99, v70, v71
buffer_store_dwordx4 v[96:99], v1, s[20:23], s51 offen offset:0 sc1
v_cvt_pk_bf16_f32 v100, v72, v73
v_cvt_pk_bf16_f32 v101, v74, v75
v_cvt_pk_bf16_f32 v102, v76, v77
v_cvt_pk_bf16_f32 v103, v78, v79
buffer_store_dwordx4 v[100:103], v1, s[20:23], s51 offen offset:1024 sc1
v_cvt_pk_bf16_f32 v104, v80, v81
v_cvt_pk_bf16_f32 v105, v82, v83
v_cvt_pk_bf16_f32 v106, v84, v85
v_cvt_pk_bf16_f32 v107, v86, v87
buffer_store_dwordx4 v[104:107], v1, s[20:23], s51 offen offset:2048 sc1
s_waitcnt vmcnt(0)
s_barrier
s_cmp_lg_u32 s3, 3
s_cbranch_scc1 L_nopush
s_mov_b64 exec, 0xff
global_store_dword v12, v13, s[96:97] offset:32 sc1
s_mov_b64 exec, -1
L_nopush:
s_cmp_lg_u32 s24, 0
s_cbranch_scc1 L_fin
s_mov_b32 s8, s100
s_mov_b32 s9, s101
s_mov_b32 s10, 3538944
s_mov_b32 s11, 0x20000
s_mov_b32 s22, 15040512
s_lshl_b32 s34, s95, 3
s_add_u32 s34, s34, s25
s_lshl_b32 s34, s34, 8
s_add_u32 s34, s34, 50331648
s_lshl_b32 s35, s24, 6
s_add_u32 s34, s34, s35
v_and_b32 v2, 7, v7
v_lshlrev_b32 v2, 2, v2
v_add_u32 v2, s34, v2
v_and_b32 v3, 31, v7
v_lshrrev_b32 v5, 5, v7
v_mul_u32_u24 v4, 2304, v3
v_lshl_add_u32 v4, v5, 5, v4
s_mov_b32 s64, 0x3f80
s_mov_b32 s65, 0x3f800000
s_lshl_b32 s66, s24, 1
s_add_u32 s78, s66, 4
L_stage:
s_and_b32 s67, s66, 1
s_add_u32 s68, s67, 3
s_mul_i32 s68, s68, s25
s_add_u32 s68, s68, s3
s_add_u32 s69, s67, 2
s_cmp_gt_u32 s3, s69
s_cbranch_scc1 L_next
s_cmp_ge_u32 s68, 30
s_cbranch_scc1 L_next
s_and_b32 s69, s27, 1
s_xor_b32 s69, s69, s67
s_lshl_b32 s69, s69, 1
s_mul_i32 s70, s68, 43
s_lshr_b32 s70, s70, 8
s_mul_i32 s71, s70, 6
s_sub_u32 s71, s68, s71
s_lshr_b32 s72, s71, 1
s_and_b32 s73, s71, 1
s_cmp_eq_u32 s70, 4
s_cselect_b32 s69, 0, s69
s_cselect_b32 s74, 1, 2
s_add_u32 s73, s73, s69
s_lshl_b32 s74, s72, s74
s_add_u32 s74, s74, s73
s_mul_i32 s75, s70, 12
s_add_u32 s74, s74, s75
s_lshl_b32 s74, s74, 11
s_lshr_b32 s75, s66, 1
s_mul_i32 s76, s75, 14155776
s_add_u32 s74, s74, s76
s_mul_i32 s76, s27, 221184
s_mul_i32 s75, s75, 1152
s_add_u32 s76, s76, s75
s_lshl_b32 s75, s70, 8
s_add_u32 s76, s76, s75
s_mul_i32 s75, s72, 73728
s_add_u32 s76, s76, s75
s_lshl_b32 s75, s73, 6
s_add_u32 s76, s76, s75
s_mov_b32 s77, 0
L_poll:
global_load_dword v6, v2, s[96:97] sc1
s_waitcnt vmcnt(0)
v_cmp_ne_u32 vcc, 1, v6
s_add_u32 s77, s77, 1
s_cbranch_vccz L_go
s_sleep 4
s_cmp_lt_u32 s77, 0x80000
s_cbranch_scc1 L_poll
L_go:
buffer_load_dwordx4 v[32:35], v1, s[20:23], s74 offen offset:0 sc1
buffer_load_dwordx4 v[36:39], v1, s[20:23], s74 offen offset:1024 sc1
s_add_u32 s74, s74, 110592
buffer_load_dwordx4 v[40:43], v1, s[20:23], s74 offen offset:0 sc1
buffer_load_dwordx4 v[44:47], v1, s[20:23], s74 offen offset:1024 sc1
s_add_u32 s74, s74, 110592
buffer_load_dwordx4 v[48:51], v1, s[20:23], s74 offen offset:0 sc1
buffer_load_dwordx4 v[52:55], v1, s[20:23], s74 offen offset:1024 sc1
s_add_u32 s74, s74, 110592
buffer_load_dwordx4 v[56:59], v1, s[20:23], s74 offen offset:0 sc1
buffer_load_dwordx4 v[60:63], v1, s[20:23], s74 offen offset:1024 sc1
s_add_u32 s74, s74, 110592
buffer_load_dwordx4 v[64:67], v1, s[20:23], s74 offen offset:0 sc1
buffer_load_dwordx4 v[68:71], v1, s[20:23], s74 offen offset:1024 sc1
s_add_u32 s74, s74, 110592
buffer_load_dwordx4 v[72:75], v1, s[20:23], s74 offen offset:0 sc1
buffer_load_dwordx4 v[76:79], v1, s[20:23], s74 offen offset:1024 sc1
s_add_u32 s74, s74, 110592
buffer_load_dwordx4 v[80:83], v1, s[20:23], s74 offen offset:0 sc1
buffer_load_dwordx4 v[84:87], v1, s[20:23], s74 offen offset:1024 sc1
s_add_u32 s74, s74, 110592
buffer_load_dwordx4 v[88:91], v1, s[20:23], s74 offen offset:0 sc1
buffer_load_dwordx4 v[92:95], v1, s[20:23], s74 offen offset:1024 sc1
s_waitcnt vmcnt(14)
v_dot2_f32_bf16 v8, v32, s64, 0
v_dot2_f32_bf16 v9, v32, s65, 0
v_dot2_f32_bf16 v10, v33, s64, 0
v_dot2_f32_bf16 v11, v33, s65, 0
v_dot2_f32_bf16 v12, v34, s64, 0
v_dot2_f32_bf16 v13, v34, s65, 0
v_dot2_f32_bf16 v14, v35, s64, 0
v_dot2_f32_bf16 v15, v35, s65, 0
v_dot2_f32_bf16 v16, v36, s64, 0
v_dot2_f32_bf16 v17, v36, s65, 0
v_dot2_f32_bf16 v18, v37, s64, 0
v_dot2_f32_bf16 v19, v37, s65, 0
v_dot2_f32_bf16 v20, v38, s64, 0
v_dot2_f32_bf16 v21, v38, s65, 0
v_dot2_f32_bf16 v22, v39, s64, 0
v_dot2_f32_bf16 v23, v39, s65, 0
s_waitcnt vmcnt(12)
v_dot2_f32_bf16 v8, v40, s64, v8
v_dot2_f32_bf16 v9, v40, s65, v9
v_dot2_f32_bf16 v10, v41, s64, v10
v_dot2_f32_bf16 v11, v41, s65, v11
v_dot2_f32_bf16 v12, v42, s64, v12
v_dot2_f32_bf16 v13, v42, s65, v13
v_dot2_f32_bf16 v14, v43, s64, v14
v_dot2_f32_bf16 v15, v43, s65, v15
v_dot2_f32_bf16 v16, v44, s64, v16
v_dot2_f32_bf16 v17, v44, s65, v17
v_dot2_f32_bf16 v18, v45, s64, v18
v_dot2_f32_bf16 v19, v45, s65, v19
v_dot2_f32_bf16 v20, v46, s64, v20
v_dot2_f32_bf16 v21, v46, s65, v21
v_dot2_f32_bf16 v22, v47, s64, v22
v_dot2_f32_bf16 v23, v47, s65, v23
s_waitcnt vmcnt(10)
v_dot2_f32_bf16 v8, v48, s64, v8
v_dot2_f32_bf16 v9, v48, s65, v9
v_dot2_f32_bf16 v10, v49, s64, v10
v_dot2_f32_bf16 v11, v49, s65, v11
v_dot2_f32_bf16 v12, v50, s64, v12
v_dot2_f32_bf16 v13, v50, s65, v13
v_dot2_f32_bf16 v14, v51, s64, v14
v_dot2_f32_bf16 v15, v51, s65, v15
v_dot2_f32_bf16 v16, v52, s64, v16
v_dot2_f32_bf16 v17, v52, s65, v17
v_dot2_f32_bf16 v18, v53, s64, v18
v_dot2_f32_bf16 v19, v53, s65, v19
v_dot2_f32_bf16 v20, v54, s64, v20
v_dot2_f32_bf16 v21, v54, s65, v21
v_dot2_f32_bf16 v22, v55, s64, v22
v_dot2_f32_bf16 v23, v55, s65, v23
s_waitcnt vmcnt(8)
v_dot2_f32_bf16 v8, v56, s64, v8
v_dot2_f32_bf16 v9, v56, s65, v9
v_dot2_f32_bf16 v10, v57, s64, v10
v_dot2_f32_bf16 v11, v57, s65, v11
v_dot2_f32_bf16 v12, v58, s64, v12
v_dot2_f32_bf16 v13, v58, s65, v13
v_dot2_f32_bf16 v14, v59, s64, v14
v_dot2_f32_bf16 v15, v59, s65, v15
v_dot2_f32_bf16 v16, v60, s64, v16
v_dot2_f32_bf16 v17, v60, s65, v17
v_dot2_f32_bf16 v18, v61, s64, v18
v_dot2_f32_bf16 v19, v61, s65, v19
v_dot2_f32_bf16 v20, v62, s64, v20
v_dot2_f32_bf16 v21, v62, s65, v21
v_dot2_f32_bf16 v22, v63, s64, v22
v_dot2_f32_bf16 v23, v63, s65, v23
s_waitcnt vmcnt(6)
v_dot2_f32_bf16 v8, v64, s64, v8
v_dot2_f32_bf16 v9, v64, s65, v9
v_dot2_f32_bf16 v10, v65, s64, v10
v_dot2_f32_bf16 v11, v65, s65, v11
v_dot2_f32_bf16 v12, v66, s64, v12
v_dot2_f32_bf16 v13, v66, s65, v13
v_dot2_f32_bf16 v14, v67, s64, v14
v_dot2_f32_bf16 v15, v67, s65, v15
v_dot2_f32_bf16 v16, v68, s64, v16
v_dot2_f32_bf16 v17, v68, s65, v17
v_dot2_f32_bf16 v18, v69, s64, v18
v_dot2_f32_bf16 v19, v69, s65, v19
v_dot2_f32_bf16 v20, v70, s64, v20
v_dot2_f32_bf16 v21, v70, s65, v21
v_dot2_f32_bf16 v22, v71, s64, v22
v_dot2_f32_bf16 v23, v71, s65, v23
s_waitcnt vmcnt(4)
v_dot2_f32_bf16 v8, v72, s64, v8
v_dot2_f32_bf16 v9, v72, s65, v9
v_dot2_f32_bf16 v10, v73, s64, v10
v_dot2_f32_bf16 v11, v73, s65, v11
v_dot2_f32_bf16 v12, v74, s64, v12
v_dot2_f32_bf16 v13, v74, s65, v13
v_dot2_f32_bf16 v14, v75, s64, v14
v_dot2_f32_bf16 v15, v75, s65, v15
v_dot2_f32_bf16 v16, v76, s64, v16
v_dot2_f32_bf16 v17, v76, s65, v17
v_dot2_f32_bf16 v18, v77, s64, v18
v_dot2_f32_bf16 v19, v77, s65, v19
v_dot2_f32_bf16 v20, v78, s64, v20
v_dot2_f32_bf16 v21, v78, s65, v21
v_dot2_f32_bf16 v22, v79, s64, v22
v_dot2_f32_bf16 v23, v79, s65, v23
s_waitcnt vmcnt(2)
v_dot2_f32_bf16 v8, v80, s64, v8
v_dot2_f32_bf16 v9, v80, s65, v9
v_dot2_f32_bf16 v10, v81, s64, v10
v_dot2_f32_bf16 v11, v81, s65, v11
v_dot2_f32_bf16 v12, v82, s64, v12
v_dot2_f32_bf16 v13, v82, s65, v13
v_dot2_f32_bf16 v14, v83, s64, v14
v_dot2_f32_bf16 v15, v83, s65, v15
v_dot2_f32_bf16 v16, v84, s64, v16
v_dot2_f32_bf16 v17, v84, s65, v17
v_dot2_f32_bf16 v18, v85, s64, v18
v_dot2_f32_bf16 v19, v85, s65, v19
v_dot2_f32_bf16 v20, v86, s64, v20
v_dot2_f32_bf16 v21, v86, s65, v21
v_dot2_f32_bf16 v22, v87, s64, v22
v_dot2_f32_bf16 v23, v87, s65, v23
s_waitcnt vmcnt(0)
v_dot2_f32_bf16 v8, v88, s64, v8
v_dot2_f32_bf16 v9, v88, s65, v9
v_dot2_f32_bf16 v10, v89, s64, v10
v_dot2_f32_bf16 v11, v89, s65, v11
v_dot2_f32_bf16 v12, v90, s64, v12
v_dot2_f32_bf16 v13, v90, s65, v13
v_dot2_f32_bf16 v14, v91, s64, v14
v_dot2_f32_bf16 v15, v91, s65, v15
v_dot2_f32_bf16 v16, v92, s64, v16
v_dot2_f32_bf16 v17, v92, s65, v17
v_dot2_f32_bf16 v18, v93, s64, v18
v_dot2_f32_bf16 v19, v93, s65, v19
v_dot2_f32_bf16 v20, v94, s64, v20
v_dot2_f32_bf16 v21, v94, s65, v21
v_dot2_f32_bf16 v22, v95, s64, v22
v_dot2_f32_bf16 v23, v95, s65, v23
s_nop 2
v_cvt_pk_bf16_f32 v24, v8, v9
v_cvt_pk_bf16_f32 v25, v10, v11
v_cvt_pk_bf16_f32 v26, v12, v13
v_cvt_pk_bf16_f32 v27, v14, v15
buffer_store_dwordx4 v[24:27], v4, s[8:11], s76 offen offset:0
v_cvt_pk_bf16_f32 v28, v16, v17
v_cvt_pk_bf16_f32 v29, v18, v19
v_cvt_pk_bf16_f32 v30, v20, v21
v_cvt_pk_bf16_f32 v31, v22, v23
buffer_store_dwordx4 v[28:31], v4, s[8:11], s76 offen offset:16
L_next:
v_add_u32 v2, 32, v2
s_add_u32 s66, s66, 1
s_cmp_lt_u32 s66, s78
s_cbranch_scc1 L_stage
L_fin:
L_end:
s_endpgm
L_tramp_As0a:
s_call_b64 s[52:53], L_rare_0
s_branch L_back_As0a
L_tramp_As0b:
s_call_b64 s[52:53], L_rare_1
s_branch L_back_As0b
L_tramp_As0c:
s_call_b64 s[52:53], L_rare_2
s_branch L_back_As0c
L_tramp_As1a:
s_call_b64 s[52:53], L_rare_0
s_branch L_back_As1a
L_tramp_As1b:
s_call_b64 s[52:53], L_rare_1
s_branch L_back_As1b
L_tramp_As1c:
s_call_b64 s[52:53], L_rare_2
s_branch L_back_As1c
L_tramp_Ap0a:
s_call_b64 s[52:53], L_rare_0
s_branch L_back_Ap0a
L_tramp_Ap0b:
s_call_b64 s[52:53], L_rare_1
s_branch L_back_Ap0b
L_tramp_Ap0c:
s_call_b64 s[52:53], L_rare_2
s_branch L_back_Ap0c
L_tramp_Ap1a:
s_call_b64 s[52:53], L_rare_0
s_branch L_back_Ap1a
L_tramp_Ap1b:
s_call_b64 s[52:53], L_rare_1
s_branch L_back_Ap1b
L_tramp_Ap1c:
s_call_b64 s[52:53], L_rare_2
s_branch L_back_Ap1c
L_tramp_Bs0a:
s_call_b64 s[52:53], L_rare_0
s_branch L_back_Bs0a
L_tramp_Bs0b:
s_call_b64 s[52:53], L_rare_1
s_branch L_back_Bs0b
L_tramp_Bs0c:
s_call_b64 s[52:53], L_rare_2
s_branch L_back_Bs0c
L_tramp_Bs1a:
s_call_b64 s[52:53], L_rare_0
s_branch L_back_Bs1a
L_tramp_Bs1b:
s_call_b64 s[52:53], L_rare_1
s_branch L_back_Bs1b
L_tramp_Bs1c:
s_call_b64 s[52:53], L_rare_2
s_branch L_back_Bs1c
L_tramp_BTs0a:
s_call_b64 s[52:53], L_rare_0
s_branch L_back_BTs0a
L_tramp_BTs0b:
s_call_b64 s[52:53], L_rare_1
s_branch L_back_BTs0b
L_tramp_BTs0c:
s_call_b64 s[52:53], L_rare_2
s_branch L_back_BTs0c
L_tramp_BTs1a:
s_call_b64 s[52:53], L_rare_0
s_branch L_back_BTs1a
L_tramp_BTs1b:
s_call_b64 s[52:53], L_rare_1
s_branch L_back_BTs1b
L_tramp_BTs1c:
s_call_b64 s[52:53], L_rare_2
s_branch L_back_BTs1c
L_tramp_Bp0a:
s_call_b64 s[52:53], L_rare_0
s_branch L_back_Bp0a
L_tramp_Bp0b:
s_call_b64 s[52:53], L_rare_1
s_branch L_back_Bp0b
L_tramp_Bp0c:
s_call_b64 s[52:53], L_rare_2
s_branch L_back_Bp0c
L_tramp_Bp1a:
s_call_b64 s[52:53], L_rare_0
s_branch L_back_Bp1a
L_tramp_Bp1b:
s_call_b64 s[52:53], L_rare_1
s_branch L_back_Bp1b
L_tramp_Bp1c:
s_call_b64 s[52:53], L_rare_2
s_branch L_back_Bp1c
L_rare_0:
v_max3_f32 v148, v16, v17, v18
v_max3_f32 v148, v148, v19, v20
v_max3_f32 v148, v148, v21, v22
v_max3_f32 v148, v148, v23, v24
v_max3_f32 v148, v148, v25, v26
v_max3_f32 v148, v148, v27, v28
v_max3_f32 v148, v148, v29, v30
v_max_f32 v148, v148, v31
v_mov_b32 v149, v148
s_nop 1
v_permlane32_swap_b32 v148, v149
s_nop 1
v_max_f32 v148, v148, v149
v_max_f32 v148, 0, v148
v_exp_f32 v149, -v148
v_sub_f32 v64, v64, v148
v_sub_f32 v65, v65, v148
v_sub_f32 v66, v66, v148
v_sub_f32 v67, v67, v148
v_sub_f32 v68, v68, v148
v_sub_f32 v69, v69, v148
v_sub_f32 v70, v70, v148
v_sub_f32 v71, v71, v148
v_sub_f32 v72, v72, v148
v_sub_f32 v73, v73, v148
v_sub_f32 v74, v74, v148
v_sub_f32 v75, v75, v148
v_sub_f32 v76, v76, v148
v_sub_f32 v77, v77, v148
v_sub_f32 v78, v78, v148
v_sub_f32 v79, v79, v148
v_mul_f32 v144, v144, v149
v_accvgpr_read_b32 v150, a0
v_mul_f32 v150, v150, v149
v_accvgpr_write_b32 a0, v150
v_accvgpr_read_b32 v151, a1
v_mul_f32 v151, v151, v149
v_accvgpr_write_b32 a1, v151
v_accvgpr_read_b32 v152, a2
v_mul_f32 v152, v152, v149
v_accvgpr_write_b32 a2, v152
v_accvgpr_read_b32 v153, a3
v_mul_f32 v153, v153, v149
v_accvgpr_write_b32 a3, v153
v_accvgpr_read_b32 v150, a4
v_mul_f32 v150, v150, v149
v_accvgpr_write_b32 a4, v150
v_accvgpr_read_b32 v151, a5
v_mul_f32 v151, v151, v149
v_accvgpr_write_b32 a5, v151
v_accvgpr_read_b32 v152, a6
v_mul_f32 v152, v152, v149
v_accvgpr_write_b32 a6, v152
v_accvgpr_read_b32 v153, a7
v_mul_f32 v153, v153, v149
v_accvgpr_write_b32 a7, v153
v_accvgpr_read_b32 v150, a8
v_mul_f32 v150, v150, v149
v_accvgpr_write_b32 a8, v150
v_accvgpr_read_b32 v151, a9
v_mul_f32 v151, v151, v149
v_accvgpr_write_b32 a9, v151
v_accvgpr_read_b32 v152, a10
v_mul_f32 v152, v152, v149
v_accvgpr_write_b32 a10, v152
v_accvgpr_read_b32 v153, a11
v_mul_f32 v153, v153, v149
v_accvgpr_write_b32 a11, v153
v_accvgpr_read_b32 v150, a12
v_mul_f32 v150, v150, v149
v_accvgpr_write_b32 a12, v150
v_accvgpr_read_b32 v151, a13
v_mul_f32 v151, v151, v149
v_accvgpr_write_b32 a13, v151
v_accvgpr_read_b32 v152, a14
v_mul_f32 v152, v152, v149
v_accvgpr_write_b32 a14, v152
v_accvgpr_read_b32 v153, a15
v_mul_f32 v153, v153, v149
v_accvgpr_write_b32 a15, v153
v_accvgpr_read_b32 v150, a16
v_mul_f32 v150, v150, v149
v_accvgpr_write_b32 a16, v150
v_accvgpr_read_b32 v151, a17
v_mul_f32 v151, v151, v149
v_accvgpr_write_b32 a17, v151
v_accvgpr_read_b32 v152, a18
v_mul_f32 v152, v152, v149
v_accvgpr_write_b32 a18, v152
v_accvgpr_read_b32 v153, a19
v_mul_f32 v153, v153, v149
v_accvgpr_write_b32 a19, v153
v_accvgpr_read_b32 v150, a20
v_mul_f32 v150, v150, v149
v_accvgpr_write_b32 a20, v150
v_accvgpr_read_b32 v151, a21
v_mul_f32 v151, v151, v149
v_accvgpr_write_b32 a21, v151
v_accvgpr_read_b32 v152, a22
v_mul_f32 v152, v152, v149
v_accvgpr_write_b32 a22, v152
v_accvgpr_read_b32 v153, a23
v_mul_f32 v153, v153, v149
v_accvgpr_write_b32 a23, v153
v_accvgpr_read_b32 v150, a24
v_mul_f32 v150, v150, v149
v_accvgpr_write_b32 a24, v150
v_accvgpr_read_b32 v151, a25
v_mul_f32 v151, v151, v149
v_accvgpr_write_b32 a25, v151
v_accvgpr_read_b32 v152, a26
v_mul_f32 v152, v152, v149
v_accvgpr_write_b32 a26, v152
v_accvgpr_read_b32 v153, a27
v_mul_f32 v153, v153, v149
v_accvgpr_write_b32 a27, v153
v_accvgpr_read_b32 v150, a28
v_mul_f32 v150, v150, v149
v_accvgpr_write_b32 a28, v150
v_accvgpr_read_b32 v151, a29
v_mul_f32 v151, v151, v149
v_accvgpr_write_b32 a29, v151
v_accvgpr_read_b32 v152, a30
v_mul_f32 v152, v152, v149
v_accvgpr_write_b32 a30, v152
v_accvgpr_read_b32 v153, a31
v_mul_f32 v153, v153, v149
v_accvgpr_write_b32 a31, v153
v_accvgpr_read_b32 v150, a32
v_mul_f32 v150, v150, v149
v_accvgpr_write_b32 a32, v150
v_accvgpr_read_b32 v151, a33
v_mul_f32 v151, v151, v149
v_accvgpr_write_b32 a33, v151
v_accvgpr_read_b32 v152, a34
v_mul_f32 v152, v152, v149
v_accvgpr_write_b32 a34, v152
v_accvgpr_read_b32 v153, a35
v_mul_f32 v153, v153, v149
v_accvgpr_write_b32 a35, v153
v_accvgpr_read_b32 v150, a36
v_mul_f32 v150, v150, v149
v_accvgpr_write_b32 a36, v150
v_accvgpr_read_b32 v151, a37
v_mul_f32 v151, v151, v149
v_accvgpr_write_b32 a37, v151
v_accvgpr_read_b32 v152, a38
v_mul_f32 v152, v152, v149
v_accvgpr_write_b32 a38, v152
v_accvgpr_read_b32 v153, a39
v_mul_f32 v153, v153, v149
v_accvgpr_write_b32 a39, v153
v_accvgpr_read_b32 v150, a40
v_mul_f32 v150, v150, v149
v_accvgpr_write_b32 a40, v150
v_accvgpr_read_b32 v151, a41
v_mul_f32 v151, v151, v149
v_accvgpr_write_b32 a41, v151
v_accvgpr_read_b32 v152, a42
v_mul_f32 v152, v152, v149
v_accvgpr_write_b32 a42, v152
v_accvgpr_read_b32 v153, a43
v_mul_f32 v153, v153, v149
v_accvgpr_write_b32 a43, v153
v_accvgpr_read_b32 v150, a44
v_mul_f32 v150, v150, v149
v_accvgpr_write_b32 a44, v150
v_accvgpr_read_b32 v151, a45
v_mul_f32 v151, v151, v149
v_accvgpr_write_b32 a45, v151
v_accvgpr_read_b32 v152, a46
v_mul_f32 v152, v152, v149
v_accvgpr_write_b32 a46, v152
v_accvgpr_read_b32 v153, a47
v_mul_f32 v153, v153, v149
v_accvgpr_write_b32 a47, v153
v_accvgpr_read_b32 v150, a48
v_mul_f32 v150, v150, v149
v_accvgpr_write_b32 a48, v150
v_accvgpr_read_b32 v151, a49
v_mul_f32 v151, v151, v149
v_accvgpr_write_b32 a49, v151
v_accvgpr_read_b32 v152, a50
v_mul_f32 v152, v152, v149
v_accvgpr_write_b32 a50, v152
v_accvgpr_read_b32 v153, a51
v_mul_f32 v153, v153, v149
v_accvgpr_write_b32 a51, v153
v_accvgpr_read_b32 v150, a52
v_mul_f32 v150, v150, v149
v_accvgpr_write_b32 a52, v150
v_accvgpr_read_b32 v151, a53
v_mul_f32 v151, v151, v149
v_accvgpr_write_b32 a53, v151
v_accvgpr_read_b32 v152, a54
v_mul_f32 v152, v152, v149
v_accvgpr_write_b32 a54, v152
v_accvgpr_read_b32 v153, a55
v_mul_f32 v153, v153, v149
v_accvgpr_write_b32 a55, v153
v_accvgpr_read_b32 v150, a56
v_mul_f32 v150, v150, v149
v_accvgpr_write_b32 a56, v150
v_accvgpr_read_b32 v151, a57
v_mul_f32 v151, v151, v149
v_accvgpr_write_b32 a57, v151
v_accvgpr_read_b32 v152, a58
v_mul_f32 v152, v152, v149
v_accvgpr_write_b32 a58, v152
v_accvgpr_read_b32 v153, a59
v_mul_f32 v153, v153, v149
v_accvgpr_write_b32 a59, v153
v_accvgpr_read_b32 v150, a60
v_mul_f32 v150, v150, v149
v_accvgpr_write_b32 a60, v150
v_accvgpr_read_b32 v151, a61
v_mul_f32 v151, v151, v149
v_accvgpr_write_b32 a61, v151
v_accvgpr_read_b32 v152, a62
v_mul_f32 v152, v152, v149
v_accvgpr_write_b32 a62, v152
v_accvgpr_read_b32 v153, a63
v_mul_f32 v153, v153, v149
v_accvgpr_write_b32 a63, v153
v_mov_b32 v147, 0
v_sub_f32 v136, v16, v148
v_sub_f32 v137, v17, v148
v_exp_f32 v136, v136
v_exp_f32 v137, v137
s_nop 0
v_add_f32 v147, v147, v136
v_add_f32 v147, v147, v137
v_cvt_pk_bf16_f32 v112, v136, v137
v_sub_f32 v136, v18, v148
v_sub_f32 v137, v19, v148
v_exp_f32 v136, v136
v_exp_f32 v137, v137
s_nop 0
v_add_f32 v147, v147, v136
v_add_f32 v147, v147, v137
v_cvt_pk_bf16_f32 v113, v136, v137
v_sub_f32 v136, v20, v148
v_sub_f32 v137, v21, v148
v_exp_f32 v136, v136
v_exp_f32 v137, v137
s_nop 0
v_add_f32 v147, v147, v136
v_add_f32 v147, v147, v137
v_cvt_pk_bf16_f32 v114, v136, v137
v_sub_f32 v136, v22, v148
v_sub_f32 v137, v23, v148
v_exp_f32 v136, v136
v_exp_f32 v137, v137
s_nop 0
v_add_f32 v147, v147, v136
v_add_f32 v147, v147, v137
v_cvt_pk_bf16_f32 v115, v136, v137
v_sub_f32 v136, v24, v148
v_sub_f32 v137, v25, v148
v_exp_f32 v136, v136
v_exp_f32 v137, v137
s_nop 0
v_add_f32 v147, v147, v136
v_add_f32 v147, v147, v137
v_cvt_pk_bf16_f32 v116, v136, v137
v_sub_f32 v136, v26, v148
v_sub_f32 v137, v27, v148
v_exp_f32 v136, v136
v_exp_f32 v137, v137
s_nop 0
v_add_f32 v147, v147, v136
v_add_f32 v147, v147, v137
v_cvt_pk_bf16_f32 v117, v136, v137
v_sub_f32 v136, v28, v148
v_sub_f32 v137, v29, v148
v_exp_f32 v136, v136
v_exp_f32 v137, v137
s_nop 0
v_add_f32 v147, v147, v136
v_add_f32 v147, v147, v137
v_cvt_pk_bf16_f32 v118, v136, v137
v_sub_f32 v136, v30, v148
v_sub_f32 v137, v31, v148
v_exp_f32 v136, v136
v_exp_f32 v137, v137
s_nop 0
v_add_f32 v147, v147, v136
v_add_f32 v147, v147, v137
v_cvt_pk_bf16_f32 v119, v136, v137
s_nop 1
s_setpc_b64 s[52:53]
L_rare_1:
v_max3_f32 v148, v32, v33, v34
v_max3_f32 v148, v148, v35, v36
v_max3_f32 v148, v148, v37, v38
v_max3_f32 v148, v148, v39, v40
v_max3_f32 v148, v148, v41, v42
v_max3_f32 v148, v148, v43, v44
v_max3_f32 v148, v148, v45, v46
v_max_f32 v148, v148, v47
v_mov_b32 v149, v148
s_nop 1
v_permlane32_swap_b32 v148, v149
s_nop 1
v_max_f32 v148, v148, v149
v_max_f32 v148, 0, v148
v_exp_f32 v149, -v148
v_sub_f32 v80, v80, v148
v_sub_f32 v81, v81, v148
v_sub_f32 v82, v82, v148
v_sub_f32 v83, v83, v148
v_sub_f32 v84, v84, v148
v_sub_f32 v85, v85, v148
v_sub_f32 v86, v86, v148
v_sub_f32 v87, v87, v148
v_sub_f32 v88, v88, v148
v_sub_f32 v89, v89, v148
v_sub_f32 v90, v90, v148
v_sub_f32 v91, v91, v148
v_sub_f32 v92, v92, v148
v_sub_f32 v93, v93, v148
v_sub_f32 v94, v94, v148
v_sub_f32 v95, v95, v148
v_mul_f32 v145, v145, v149
v_accvgpr_read_b32 v150, a64
v_mul_f32 v150, v150, v149
v_accvgpr_write_b32 a64, v150
v_accvgpr_read_b32 v151, a65
v_mul_f32 v151, v151, v149
v_accvgpr_write_b32 a65, v151
v_accvgpr_read_b32 v152, a66
v_mul_f32 v152, v152, v149
v_accvgpr_write_b32 a66, v152
v_accvgpr_read_b32 v153, a67
v_mul_f32 v153, v153, v149
v_accvgpr_write_b32 a67, v153
v_accvgpr_read_b32 v150, a68
v_mul_f32 v150, v150, v149
v_accvgpr_write_b32 a68, v150
v_accvgpr_read_b32 v151, a69
v_mul_f32 v151, v151, v149
v_accvgpr_write_b32 a69, v151
v_accvgpr_read_b32 v152, a70
v_mul_f32 v152, v152, v149
v_accvgpr_write_b32 a70, v152
v_accvgpr_read_b32 v153, a71
v_mul_f32 v153, v153, v149
v_accvgpr_write_b32 a71, v153
v_accvgpr_read_b32 v150, a72
v_mul_f32 v150, v150, v149
v_accvgpr_write_b32 a72, v150
v_accvgpr_read_b32 v151, a73
v_mul_f32 v151, v151, v149
v_accvgpr_write_b32 a73, v151
v_accvgpr_read_b32 v152, a74
v_mul_f32 v152, v152, v149
v_accvgpr_write_b32 a74, v152
v_accvgpr_read_b32 v153, a75
v_mul_f32 v153, v153, v149
v_accvgpr_write_b32 a75, v153
v_accvgpr_read_b32 v150, a76
v_mul_f32 v150, v150, v149
v_accvgpr_write_b32 a76, v150
v_accvgpr_read_b32 v151, a77
v_mul_f32 v151, v151, v149
v_accvgpr_write_b32 a77, v151
v_accvgpr_read_b32 v152, a78
v_mul_f32 v152, v152, v149
v_accvgpr_write_b32 a78, v152
v_accvgpr_read_b32 v153, a79
v_mul_f32 v153, v153, v149
v_accvgpr_write_b32 a79, v153
v_accvgpr_read_b32 v150, a80
v_mul_f32 v150, v150, v149
v_accvgpr_write_b32 a80, v150
v_accvgpr_read_b32 v151, a81
v_mul_f32 v151, v151, v149
v_accvgpr_write_b32 a81, v151
v_accvgpr_read_b32 v152, a82
v_mul_f32 v152, v152, v149
v_accvgpr_write_b32 a82, v152
v_accvgpr_read_b32 v153, a83
v_mul_f32 v153, v153, v149
v_accvgpr_write_b32 a83, v153
v_accvgpr_read_b32 v150, a84
v_mul_f32 v150, v150, v149
v_accvgpr_write_b32 a84, v150
v_accvgpr_read_b32 v151, a85
v_mul_f32 v151, v151, v149
v_accvgpr_write_b32 a85, v151
v_accvgpr_read_b32 v152, a86
v_mul_f32 v152, v152, v149
v_accvgpr_write_b32 a86, v152
v_accvgpr_read_b32 v153, a87
v_mul_f32 v153, v153, v149
v_accvgpr_write_b32 a87, v153
v_accvgpr_read_b32 v150, a88
v_mul_f32 v150, v150, v149
v_accvgpr_write_b32 a88, v150
v_accvgpr_read_b32 v151, a89
v_mul_f32 v151, v151, v149
v_accvgpr_write_b32 a89, v151
v_accvgpr_read_b32 v152, a90
v_mul_f32 v152, v152, v149
v_accvgpr_write_b32 a90, v152
v_accvgpr_read_b32 v153, a91
v_mul_f32 v153, v153, v149
v_accvgpr_write_b32 a91, v153
v_accvgpr_read_b32 v150, a92
v_mul_f32 v150, v150, v149
v_accvgpr_write_b32 a92, v150
v_accvgpr_read_b32 v151, a93
v_mul_f32 v151, v151, v149
v_accvgpr_write_b32 a93, v151
v_accvgpr_read_b32 v152, a94
v_mul_f32 v152, v152, v149
v_accvgpr_write_b32 a94, v152
v_accvgpr_read_b32 v153, a95
v_mul_f32 v153, v153, v149
v_accvgpr_write_b32 a95, v153
v_accvgpr_read_b32 v150, a96
v_mul_f32 v150, v150, v149
v_accvgpr_write_b32 a96, v150
v_accvgpr_read_b32 v151, a97
v_mul_f32 v151, v151, v149
v_accvgpr_write_b32 a97, v151
v_accvgpr_read_b32 v152, a98
v_mul_f32 v152, v152, v149
v_accvgpr_write_b32 a98, v152
v_accvgpr_read_b32 v153, a99
v_mul_f32 v153, v153, v149
v_accvgpr_write_b32 a99, v153
v_accvgpr_read_b32 v150, a100
v_mul_f32 v150, v150, v149
v_accvgpr_write_b32 a100, v150
v_accvgpr_read_b32 v151, a101
v_mul_f32 v151, v151, v149
v_accvgpr_write_b32 a101, v151
v_accvgpr_read_b32 v152, a102
v_mul_f32 v152, v152, v149
v_accvgpr_write_b32 a102, v152
v_accvgpr_read_b32 v153, a103
v_mul_f32 v153, v153, v149
v_accvgpr_write_b32 a103, v153
v_accvgpr_read_b32 v150, a104
v_mul_f32 v150, v150, v149
v_accvgpr_write_b32 a104, v150
v_accvgpr_read_b32 v151, a105
v_mul_f32 v151, v151, v149
v_accvgpr_write_b32 a105, v151
v_accvgpr_read_b32 v152, a106
v_mul_f32 v152, v152, v149
v_accvgpr_write_b32 a106, v152
v_accvgpr_read_b32 v153, a107
v_mul_f32 v153, v153, v149
v_accvgpr_write_b32 a107, v153
v_accvgpr_read_b32 v150, a108
v_mul_f32 v150, v150, v149
v_accvgpr_write_b32 a108, v150
v_accvgpr_read_b32 v151, a109
v_mul_f32 v151, v151, v149
v_accvgpr_write_b32 a109, v151
v_accvgpr_read_b32 v152, a110
v_mul_f32 v152, v152, v149
v_accvgpr_write_b32 a110, v152
v_accvgpr_read_b32 v153, a111
v_mul_f32 v153, v153, v149
v_accvgpr_write_b32 a111, v153
v_accvgpr_read_b32 v150, a112
v_mul_f32 v150, v150, v149
v_accvgpr_write_b32 a112, v150
v_accvgpr_read_b32 v151, a113
v_mul_f32 v151, v151, v149
v_accvgpr_write_b32 a113, v151
v_accvgpr_read_b32 v152, a114
v_mul_f32 v152, v152, v149
v_accvgpr_write_b32 a114, v152
v_accvgpr_read_b32 v153, a115
v_mul_f32 v153, v153, v149
v_accvgpr_write_b32 a115, v153
v_accvgpr_read_b32 v150, a116
v_mul_f32 v150, v150, v149
v_accvgpr_write_b32 a116, v150
v_accvgpr_read_b32 v151, a117
v_mul_f32 v151, v151, v149
v_accvgpr_write_b32 a117, v151
v_accvgpr_read_b32 v152, a118
v_mul_f32 v152, v152, v149
v_accvgpr_write_b32 a118, v152
v_accvgpr_read_b32 v153, a119
v_mul_f32 v153, v153, v149
v_accvgpr_write_b32 a119, v153
v_accvgpr_read_b32 v150, a120
v_mul_f32 v150, v150, v149
v_accvgpr_write_b32 a120, v150
v_accvgpr_read_b32 v151, a121
v_mul_f32 v151, v151, v149
v_accvgpr_write_b32 a121, v151
v_accvgpr_read_b32 v152, a122
v_mul_f32 v152, v152, v149
v_accvgpr_write_b32 a122, v152
v_accvgpr_read_b32 v153, a123
v_mul_f32 v153, v153, v149
v_accvgpr_write_b32 a123, v153
v_accvgpr_read_b32 v150, a124
v_mul_f32 v150, v150, v149
v_accvgpr_write_b32 a124, v150
v_accvgpr_read_b32 v151, a125
v_mul_f32 v151, v151, v149
v_accvgpr_write_b32 a125, v151
v_accvgpr_read_b32 v152, a126
v_mul_f32 v152, v152, v149
v_accvgpr_write_b32 a126, v152
v_accvgpr_read_b32 v153, a127
v_mul_f32 v153, v153, v149
v_accvgpr_write_b32 a127, v153
v_mov_b32 v147, 0
v_sub_f32 v136, v32, v148
v_sub_f32 v137, v33, v148
v_exp_f32 v136, v136
v_exp_f32 v137, v137
s_nop 0
v_add_f32 v147, v147, v136
v_add_f32 v147, v147, v137
v_cvt_pk_bf16_f32 v120, v136, v137
v_sub_f32 v136, v34, v148
v_sub_f32 v137, v35, v148
v_exp_f32 v136, v136
v_exp_f32 v137, v137
s_nop 0
v_add_f32 v147, v147, v136
v_add_f32 v147, v147, v137
v_cvt_pk_bf16_f32 v121, v136, v137
v_sub_f32 v136, v36, v148
v_sub_f32 v137, v37, v148
v_exp_f32 v136, v136
v_exp_f32 v137, v137
s_nop 0
v_add_f32 v147, v147, v136
v_add_f32 v147, v147, v137
v_cvt_pk_bf16_f32 v122, v136, v137
v_sub_f32 v136, v38, v148
v_sub_f32 v137, v39, v148
v_exp_f32 v136, v136
v_exp_f32 v137, v137
s_nop 0
v_add_f32 v147, v147, v136
v_add_f32 v147, v147, v137
v_cvt_pk_bf16_f32 v123, v136, v137
v_sub_f32 v136, v40, v148
v_sub_f32 v137, v41, v148
v_exp_f32 v136, v136
v_exp_f32 v137, v137
s_nop 0
v_add_f32 v147, v147, v136
v_add_f32 v147, v147, v137
v_cvt_pk_bf16_f32 v124, v136, v137
v_sub_f32 v136, v42, v148
v_sub_f32 v137, v43, v148
v_exp_f32 v136, v136
v_exp_f32 v137, v137
s_nop 0
v_add_f32 v147, v147, v136
v_add_f32 v147, v147, v137
v_cvt_pk_bf16_f32 v125, v136, v137
v_sub_f32 v136, v44, v148
v_sub_f32 v137, v45, v148
v_exp_f32 v136, v136
v_exp_f32 v137, v137
s_nop 0
v_add_f32 v147, v147, v136
v_add_f32 v147, v147, v137
v_cvt_pk_bf16_f32 v126, v136, v137
v_sub_f32 v136, v46, v148
v_sub_f32 v137, v47, v148
v_exp_f32 v136, v136
v_exp_f32 v137, v137
s_nop 0
v_add_f32 v147, v147, v136
v_add_f32 v147, v147, v137
v_cvt_pk_bf16_f32 v127, v136, v137
s_nop 1
s_setpc_b64 s[52:53]
L_rare_2:
v_max3_f32 v148, v48, v49, v50
v_max3_f32 v148, v148, v51, v52
v_max3_f32 v148, v148, v53, v54
v_max3_f32 v148, v148, v55, v56
v_max3_f32 v148, v148, v57, v58
v_max3_f32 v148, v148, v59, v60
v_max3_f32 v148, v148, v61, v62
v_max_f32 v148, v148, v63
v_mov_b32 v149, v148
s_nop 1
v_permlane32_swap_b32 v148, v149
s_nop 1
v_max_f32 v148, v148, v149
v_max_f32 v148, 0, v148
v_exp_f32 v149, -v148
v_sub_f32 v96, v96, v148
v_sub_f32 v97, v97, v148
v_sub_f32 v98, v98, v148
v_sub_f32 v99, v99, v148
v_sub_f32 v100, v100, v148
v_sub_f32 v101, v101, v148
v_sub_f32 v102, v102, v148
v_sub_f32 v103, v103, v148
v_sub_f32 v104, v104, v148
v_sub_f32 v105, v105, v148
v_sub_f32 v106, v106, v148
v_sub_f32 v107, v107, v148
v_sub_f32 v108, v108, v148
v_sub_f32 v109, v109, v148
v_sub_f32 v110, v110, v148
v_sub_f32 v111, v111, v148
v_mul_f32 v146, v146, v149
v_accvgpr_read_b32 v150, a128
v_mul_f32 v150, v150, v149
v_accvgpr_write_b32 a128, v150
v_accvgpr_read_b32 v151, a129
v_mul_f32 v151, v151, v149
v_accvgpr_write_b32 a129, v151
v_accvgpr_read_b32 v152, a130
v_mul_f32 v152, v152, v149
v_accvgpr_write_b32 a130, v152
v_accvgpr_read_b32 v153, a131
v_mul_f32 v153, v153, v149
v_accvgpr_write_b32 a131, v153
v_accvgpr_read_b32 v150, a132
v_mul_f32 v150, v150, v149
v_accvgpr_write_b32 a132, v150
v_accvgpr_read_b32 v151, a133
v_mul_f32 v151, v151, v149
v_accvgpr_write_b32 a133, v151
v_accvgpr_read_b32 v152, a134
v_mul_f32 v152, v152, v149
v_accvgpr_write_b32 a134, v152
v_accvgpr_read_b32 v153, a135
v_mul_f32 v153, v153, v149
v_accvgpr_write_b32 a135, v153
v_accvgpr_read_b32 v150, a136
v_mul_f32 v150, v150, v149
v_accvgpr_write_b32 a136, v150
v_accvgpr_read_b32 v151, a137
v_mul_f32 v151, v151, v149
v_accvgpr_write_b32 a137, v151
v_accvgpr_read_b32 v152, a138
v_mul_f32 v152, v152, v149
v_accvgpr_write_b32 a138, v152
v_accvgpr_read_b32 v153, a139
v_mul_f32 v153, v153, v149
v_accvgpr_write_b32 a139, v153
v_accvgpr_read_b32 v150, a140
v_mul_f32 v150, v150, v149
v_accvgpr_write_b32 a140, v150
v_accvgpr_read_b32 v151, a141
v_mul_f32 v151, v151, v149
v_accvgpr_write_b32 a141, v151
v_accvgpr_read_b32 v152, a142
v_mul_f32 v152, v152, v149
v_accvgpr_write_b32 a142, v152
v_accvgpr_read_b32 v153, a143
v_mul_f32 v153, v153, v149
v_accvgpr_write_b32 a143, v153
v_accvgpr_read_b32 v150, a144
v_mul_f32 v150, v150, v149
v_accvgpr_write_b32 a144, v150
v_accvgpr_read_b32 v151, a145
v_mul_f32 v151, v151, v149
v_accvgpr_write_b32 a145, v151
v_accvgpr_read_b32 v152, a146
v_mul_f32 v152, v152, v149
v_accvgpr_write_b32 a146, v152
v_accvgpr_read_b32 v153, a147
v_mul_f32 v153, v153, v149
v_accvgpr_write_b32 a147, v153
v_accvgpr_read_b32 v150, a148
v_mul_f32 v150, v150, v149
v_accvgpr_write_b32 a148, v150
v_accvgpr_read_b32 v151, a149
v_mul_f32 v151, v151, v149
v_accvgpr_write_b32 a149, v151
v_accvgpr_read_b32 v152, a150
v_mul_f32 v152, v152, v149
v_accvgpr_write_b32 a150, v152
v_accvgpr_read_b32 v153, a151
v_mul_f32 v153, v153, v149
v_accvgpr_write_b32 a151, v153
v_accvgpr_read_b32 v150, a152
v_mul_f32 v150, v150, v149
v_accvgpr_write_b32 a152, v150
v_accvgpr_read_b32 v151, a153
v_mul_f32 v151, v151, v149
v_accvgpr_write_b32 a153, v151
v_accvgpr_read_b32 v152, a154
v_mul_f32 v152, v152, v149
v_accvgpr_write_b32 a154, v152
v_accvgpr_read_b32 v153, a155
v_mul_f32 v153, v153, v149
v_accvgpr_write_b32 a155, v153
v_accvgpr_read_b32 v150, a156
v_mul_f32 v150, v150, v149
v_accvgpr_write_b32 a156, v150
v_accvgpr_read_b32 v151, a157
v_mul_f32 v151, v151, v149
v_accvgpr_write_b32 a157, v151
v_accvgpr_read_b32 v152, a158
v_mul_f32 v152, v152, v149
v_accvgpr_write_b32 a158, v152
v_accvgpr_read_b32 v153, a159
v_mul_f32 v153, v153, v149
v_accvgpr_write_b32 a159, v153
v_accvgpr_read_b32 v150, a160
v_mul_f32 v150, v150, v149
v_accvgpr_write_b32 a160, v150
v_accvgpr_read_b32 v151, a161
v_mul_f32 v151, v151, v149
v_accvgpr_write_b32 a161, v151
v_accvgpr_read_b32 v152, a162
v_mul_f32 v152, v152, v149
v_accvgpr_write_b32 a162, v152
v_accvgpr_read_b32 v153, a163
v_mul_f32 v153, v153, v149
v_accvgpr_write_b32 a163, v153
v_accvgpr_read_b32 v150, a164
v_mul_f32 v150, v150, v149
v_accvgpr_write_b32 a164, v150
v_accvgpr_read_b32 v151, a165
v_mul_f32 v151, v151, v149
v_accvgpr_write_b32 a165, v151
v_accvgpr_read_b32 v152, a166
v_mul_f32 v152, v152, v149
v_accvgpr_write_b32 a166, v152
v_accvgpr_read_b32 v153, a167
v_mul_f32 v153, v153, v149
v_accvgpr_write_b32 a167, v153
v_accvgpr_read_b32 v150, a168
v_mul_f32 v150, v150, v149
v_accvgpr_write_b32 a168, v150
v_accvgpr_read_b32 v151, a169
v_mul_f32 v151, v151, v149
v_accvgpr_write_b32 a169, v151
v_accvgpr_read_b32 v152, a170
v_mul_f32 v152, v152, v149
v_accvgpr_write_b32 a170, v152
v_accvgpr_read_b32 v153, a171
v_mul_f32 v153, v153, v149
v_accvgpr_write_b32 a171, v153
v_accvgpr_read_b32 v150, a172
v_mul_f32 v150, v150, v149
v_accvgpr_write_b32 a172, v150
v_accvgpr_read_b32 v151, a173
v_mul_f32 v151, v151, v149
v_accvgpr_write_b32 a173, v151
v_accvgpr_read_b32 v152, a174
v_mul_f32 v152, v152, v149
v_accvgpr_write_b32 a174, v152
v_accvgpr_read_b32 v153, a175
v_mul_f32 v153, v153, v149
v_accvgpr_write_b32 a175, v153
v_accvgpr_read_b32 v150, a176
v_mul_f32 v150, v150, v149
v_accvgpr_write_b32 a176, v150
v_accvgpr_read_b32 v151, a177
v_mul_f32 v151, v151, v149
v_accvgpr_write_b32 a177, v151
v_accvgpr_read_b32 v152, a178
v_mul_f32 v152, v152, v149
v_accvgpr_write_b32 a178, v152
v_accvgpr_read_b32 v153, a179
v_mul_f32 v153, v153, v149
v_accvgpr_write_b32 a179, v153
v_accvgpr_read_b32 v150, a180
v_mul_f32 v150, v150, v149
v_accvgpr_write_b32 a180, v150
v_accvgpr_read_b32 v151, a181
v_mul_f32 v151, v151, v149
v_accvgpr_write_b32 a181, v151
v_accvgpr_read_b32 v152, a182
v_mul_f32 v152, v152, v149
v_accvgpr_write_b32 a182, v152
v_accvgpr_read_b32 v153, a183
v_mul_f32 v153, v153, v149
v_accvgpr_write_b32 a183, v153
v_accvgpr_read_b32 v150, a184
v_mul_f32 v150, v150, v149
v_accvgpr_write_b32 a184, v150
v_accvgpr_read_b32 v151, a185
v_mul_f32 v151, v151, v149
v_accvgpr_write_b32 a185, v151
v_accvgpr_read_b32 v152, a186
v_mul_f32 v152, v152, v149
v_accvgpr_write_b32 a186, v152
v_accvgpr_read_b32 v153, a187
v_mul_f32 v153, v153, v149
v_accvgpr_write_b32 a187, v153
v_accvgpr_read_b32 v150, a188
v_mul_f32 v150, v150, v149
v_accvgpr_write_b32 a188, v150
v_accvgpr_read_b32 v151, a189
v_mul_f32 v151, v151, v149
v_accvgpr_write_b32 a189, v151
v_accvgpr_read_b32 v152, a190
v_mul_f32 v152, v152, v149
v_accvgpr_write_b32 a190, v152
v_accvgpr_read_b32 v153, a191
v_mul_f32 v153, v153, v149
v_accvgpr_write_b32 a191, v153
v_mov_b32 v147, 0
v_sub_f32 v136, v48, v148
v_sub_f32 v137, v49, v148
v_exp_f32 v136, v136
v_exp_f32 v137, v137
s_nop 0
v_add_f32 v147, v147, v136
v_add_f32 v147, v147, v137
v_cvt_pk_bf16_f32 v128, v136, v137
v_sub_f32 v136, v50, v148
v_sub_f32 v137, v51, v148
v_exp_f32 v136, v136
v_exp_f32 v137, v137
s_nop 0
v_add_f32 v147, v147, v136
v_add_f32 v147, v147, v137
v_cvt_pk_bf16_f32 v129, v136, v137
v_sub_f32 v136, v52, v148
v_sub_f32 v137, v53, v148
v_exp_f32 v136, v136
v_exp_f32 v137, v137
s_nop 0
v_add_f32 v147, v147, v136
v_add_f32 v147, v147, v137
v_cvt_pk_bf16_f32 v130, v136, v137
v_sub_f32 v136, v54, v148
v_sub_f32 v137, v55, v148
v_exp_f32 v136, v136
v_exp_f32 v137, v137
s_nop 0
v_add_f32 v147, v147, v136
v_add_f32 v147, v147, v137
v_cvt_pk_bf16_f32 v131, v136, v137
v_sub_f32 v136, v56, v148
v_sub_f32 v137, v57, v148
v_exp_f32 v136, v136
v_exp_f32 v137, v137
s_nop 0
v_add_f32 v147, v147, v136
v_add_f32 v147, v147, v137
v_cvt_pk_bf16_f32 v132, v136, v137
v_sub_f32 v136, v58, v148
v_sub_f32 v137, v59, v148
v_exp_f32 v136, v136
v_exp_f32 v137, v137
s_nop 0
v_add_f32 v147, v147, v136
v_add_f32 v147, v147, v137
v_cvt_pk_bf16_f32 v133, v136, v137
v_sub_f32 v136, v60, v148
v_sub_f32 v137, v61, v148
v_exp_f32 v136, v136
v_exp_f32 v137, v137
s_nop 0
v_add_f32 v147, v147, v136
v_add_f32 v147, v147, v137
v_cvt_pk_bf16_f32 v134, v136, v137
v_sub_f32 v136, v62, v148
v_sub_f32 v137, v63, v148
v_exp_f32 v136, v136
v_exp_f32 v137, v137
s_nop 0
v_add_f32 v147, v147, v136
v_add_f32 v147, v147, v137
v_cvt_pk_bf16_f32 v135, v136, v137
s_nop 1
s_setpc_b64 s[52:53]
L_helpA:
s_lshl_b32 s34, s29, 19
s_add_u32 s34, s34, s32
s_add_u32 s34, s34, 262144
v_lshrrev_b32 v48, 1, v7
v_lshlrev_b32 v48, 13, v48
v_and_b32 v49, 1, v7
v_lshl_add_u32 v48, v49, 7, v48
v_add_u32 v57, s34, v48
global_load_dword v50, v57, s[80:81]
v_and_b32 v48, 31, v7
v_min_u32 v48, 23, v48
v_mul_u32_u24 v48, 1152, v48
v_add_u32 v48, s33, v48
v_lshrrev_b32 v49, 5, v7
v_add_u32 v49, s43, v49
v_add_u32 v51, 1, v49
v_subrev_u32 v56, 9, v51
v_min_u32 v51, v51, v56
v_lshl_add_u32 v51, v51, 7, v48
global_load_dword v50, v51, s[74:75]
v_add_u32 v51, 3, v49
v_subrev_u32 v56, 9, v51
v_min_u32 v51, v51, v56
v_lshl_add_u32 v51, v51, 7, v48
global_load_dword v50, v51, s[74:75]
s_getpc_b64 s[86:87]
L_pc:
s_sub_u32 s86, s86, L_pc-L_noapf
s_subb_u32 s87, s87, 0
s_lshl_b32 s34, s27, 2
s_add_u32 s34, s34, s3
s_lshl_b32 s34, s34, 7
v_lshlrev_b32 v63, 13, v7
v_add_u32 v63, s34, v63
v_cmp_gt_u32 vcc, L_helpA-L_noapf-4, v63
s_and_saveexec_b64 s[88:89], vcc
global_load_dword v62, v63, s[86:87]
s_mov_b64 exec, -1
s_lshl_b32 s35, s27, 5
s_add_u32 s35, s35, s28
s_lshl_b32 s34, s35, 18
s_add_u32 s20, s76, s34
s_addc_u32 s21, s77, 0
s_mov_b32 s22, 0x40000
s_mov_b32 s23, 0x20000
s_add_u32 s52, s78, s34
s_addc_u32 s53, s79, 0
s_mov_b32 s54, 0x40000
s_mov_b32 s55, 0x20000
s_and_b32 s34, s27, 0
s_mul_i32 s34, s34, 2
s_add_u32 s35, s35, s34
s_add_u32 s35, s35, 0
s_add_u32 s35, s35, s27
v_lshlrev_b32 v48, 4, v7
s_mov_b32 s40, 1
L_apf:
s_and_b32 s34, s35, 63
s_lshl_b32 s34, s34, 12
s_add_u32 s37, s34, 4096
s_and_b32 s37, s37, 0x3ffff
buffer_load_dwordx4 v[64:67], v48, s[20:23], s34 offen offset:0
s_waitcnt vmcnt(2)
buffer_load_dwordx4 v[68:71], v48, s[20:23], s34 offen offset:1024
s_waitcnt vmcnt(2)
buffer_load_dwordx4 v[72:75], v48, s[20:23], s34 offen offset:2048
s_waitcnt vmcnt(2)
buffer_load_dwordx4 v[76:79], v48, s[20:23], s34 offen offset:3072
s_waitcnt vmcnt(2)
buffer_load_dwordx4 v[80:83], v48, s[20:23], s37 offen offset:0
s_waitcnt vmcnt(2)
buffer_load_dwordx4 v[84:87], v48, s[20:23], s37 offen offset:1024
s_waitcnt vmcnt(2)
buffer_load_dwordx4 v[88:91], v48, s[20:23], s37 offen offset:2048
s_waitcnt vmcnt(2)
buffer_load_dwordx4 v[92:95], v48, s[20:23], s37 offen offset:3072
s_waitcnt vmcnt(2)
buffer_load_dwordx4 v[96:99], v48, s[52:55], s34 offen offset:0
s_waitcnt vmcnt(2)
buffer_load_dwordx4 v[100:103], v48, s[52:55], s34 offen offset:1024
s_waitcnt vmcnt(2)
buffer_load_dwordx4 v[104:107], v48, s[52:55], s34 offen offset:2048
s_waitcnt vmcnt(2)
buffer_load_dwordx4 v[108:111], v48, s[52:55], s34 offen offset:3072
s_waitcnt vmcnt(2)
buffer_load_dwordx4 v[112:115], v48, s[52:55], s37 offen offset:0
s_waitcnt vmcnt(2)
buffer_load_dwordx4 v[116:119], v48, s[52:55], s37 offen offset:1024
s_waitcnt vmcnt(2)
buffer_load_dwordx4 v[120:123], v48, s[52:55], s37 offen offset:2048
s_waitcnt vmcnt(2)
buffer_load_dwordx4 v[124:127], v48, s[52:55], s37 offen offset:3072
s_waitcnt vmcnt(2)
s_add_u32 s35, s35, 2
s_sub_u32 s40, s40, 1
s_cmp_lg_u32 s40, 0
s_cbranch_scc1 L_apf
s_branch L_noapf
L_code_end:
s_endpgm
.section .rodata,"a"
.p2align 6
.amdhsa_kernel concat_heads__gqa_block_cached__mha_block_cached__near_ridge_kernel
.amdhsa_next_free_vgpr 512
.amdhsa_next_free_sgpr 102
.amdhsa_accum_offset 256
.amdhsa_group_segment_fixed_size 0
.amdhsa_kernarg_size 104
.amdhsa_user_sgpr_count 2
.amdhsa_user_sgpr_kernarg_segment_ptr 1
.amdhsa_system_sgpr_workgroup_id_x 1
.end_amdhsa_kernel
```
